```python
import torch

def _softmax(x, axis=-1):
    return torch.softmax(x, dim=axis)
def _gelu(x):
    return torch.nn.functional.gelu(x, approximate="tanh")
def _silu(x):
    return torch.nn.functional.silu(x)
def _sigmoid(x):
    return torch.sigmoid(x)
def _layernorm(x, axis=-1, eps=1e-5):
    m = x.mean(dim=axis, keepdim=True)
    v = x.var(dim=axis, keepdim=True, unbiased=False)
    return (x - m) / torch.sqrt(v + eps)
def _scatter_add(tgt, idx, src, axis=0):
    return tgt.clone().index_add_(axis, idx, src)
def _segment_sum(src, seg, n):
    out = torch.zeros((n,) + src.shape[1:], dtype=src.dtype)
    return out.index_add_(0, seg, src)
def _pad(x, pw):
    flat = tuple(v for pair in reversed(pw) for v in pair)
    return torch.nn.functional.pad(x, flat)

kernel_name = 'concat_heads__mha_block_cached__gqa_block_cached__near_ridge'

def setup_inputs():

    _w = (lambda a: (lambda t: t.to(torch.bfloat16) if t.is_floating_point() else t)(torch.as_tensor(a)))
    def _A_setup():
        B, Sq, D = 8, 112, 512
        H, Sk, Dh = 32, 512, 128
        return {
            "x": _w((lambda *s: torch.randn(*s, dtype=torch.bfloat16) * 0.8)(B, Sq, D)),
            "k_cache": _w((lambda *s: torch.randn(*s, dtype=torch.bfloat16) * 0.8)(B, H, Sk, Dh)),
            "v_cache": _w((lambda *s: torch.randn(*s, dtype=torch.bfloat16) * 0.05)(B, H, Sk, Dh)),
            "wq": _w((lambda *s: torch.randn(*s, dtype=torch.bfloat16) * 0.8)(D, H * Dh) * (D ** -0.5)),
            "wo": _w((lambda *s: torch.randn(*s, dtype=torch.bfloat16) * 0.05)(H * Dh, D) * ((H * Dh) ** -0.5)),
        }
    _A_in = _A_setup()

    def _B_setup():
        B, Sq, D = 8, 112, 512
        Hq, Hkv, Sk, Dh = 32, 32, 512, 128
        assert Hq % Hkv == 0, (Hq, Hkv)
        return {
            "x": _w((lambda *s: torch.randn(*s, dtype=torch.bfloat16) * 0.8)(B, Sq, D)),
            "k_cache": _w((lambda *s: torch.randn(*s, dtype=torch.bfloat16) * 0.8)(B, Hkv, Sk, Dh)),
            "v_cache": _w((lambda *s: torch.randn(*s, dtype=torch.bfloat16) * 0.05)(B, Hkv, Sk, Dh)),
            "wq": _w((lambda *s: torch.randn(*s, dtype=torch.bfloat16) * 0.8)(D, Hq * Dh) * (D ** -0.5)),
            "wo": _w((lambda *s: torch.randn(*s, dtype=torch.bfloat16) * 0.05)(Hq * Dh, D) * ((Hq * Dh) ** -0.5)),
        }
    _B_in = _B_setup()

    return {
        "A_x": _A_in["x"],
        "A_k_cache": _A_in["k_cache"],
        "A_v_cache": _A_in["v_cache"],
        "A_wq": _A_in["wq"],
        "A_wo": _A_in["wo"],
        "B_x": _B_in["x"],
        "B_k_cache": _B_in["k_cache"],
        "B_v_cache": _B_in["v_cache"],
        "B_wq": _B_in["wq"],
        "B_wo": _B_in["wo"],
    }

def reference(A_x, A_k_cache, A_v_cache, A_wq, A_wo, B_x, B_k_cache, B_v_cache, B_wq, B_wo):
    def _A_ref(x, k_cache, v_cache, wq, wo):
        B, Sq, D = x.shape
        H, Dh = 32, 128
        q = (lambda x, *d: x.permute(*d))((x @ wq).reshape(B, Sq, H, Dh), 0, 2, 1, 3)
        scores = torch.einsum("bhqd,bhkd->bhqk", q, k_cache) * (Dh ** -0.5)
        p = _softmax(scores, axis=-1)
        o = torch.einsum("bhqk,bhkd->bhqd", p, v_cache)
        return (lambda x, *d: x.permute(*d))(o, 0, 2, 1, 3).reshape(B, Sq, H * Dh) @ wo

    def _B_ref(x, k_cache, v_cache, wq, wo):
        B, Sq, D = x.shape
        Hq, Dh = 32, 128
        Hkv = k_cache.shape[1]
        rep = Hq // Hkv
        q = (lambda x, *d: x.permute(*d))((x @ wq).reshape(B, Sq, Hq, Dh), 0, 2, 1, 3)
        k = (lambda x, n, axis: torch.repeat_interleave(x, n, dim=axis))(k_cache, rep, axis=1)
        v = (lambda x, n, axis: torch.repeat_interleave(x, n, dim=axis))(v_cache, rep, axis=1)
        scores = torch.einsum("bhqd,bhkd->bhqk", q, k) * (Dh ** -0.5)
        p = _softmax(scores, axis=-1)
        o = torch.einsum("bhqk,bhkd->bhqd", p, v)
        return (lambda x, *d: x.permute(*d))(o, 0, 2, 1, 3).reshape(B, Sq, Hq * Dh) @ wo

    a = _A_ref(A_x, A_k_cache, A_v_cache, A_wq, A_wo)
    b = _B_ref(B_x, B_k_cache, B_v_cache, B_wq, B_wo)
    return torch.concatenate([a, b], axis=-1)
```

```asm
; @launch grid=(256,1,1) block=(512,1,1) lds=163840
.amdgcn_target "amdgcn-amd-amdhsa--gfx950"
.text
.globl concat_heads__mha_block_cached__gqa_block_cached__near_ridge_kernel
.p2align 8
.type concat_heads__mha_block_cached__gqa_block_cached__near_ridge_kernel,@function
concat_heads__mha_block_cached__gqa_block_cached__near_ridge_kernel:
    s_cmp_ge_u32 s2, 256
    s_cbranch_scc1 k_end
    s_load_dwordx16 s[36:51], s[0:1], 0
    s_load_dwordx8 s[52:59], s[0:1], 64
    s_load_dwordx2 s[60:61], s[0:1], 96
    v_lshrrev_b32 v1, 6, v0
    s_nop 0
    v_readfirstlane_b32 s62, v1
    v_and_b32 v0, 63, v0
    s_cmp_lg_u32 s62, 0
    s_cbranch_scc1 ct_skip
    s_getpc_b64 s[74:75]
ct_pc:
    s_lshl_b32 s76, s2, 10
    s_and_b32 s76, s76, 0xe000
    v_lshlrev_b32 v2, 7, v0
    v_add_u32 v2, s76, v2
    v_min_u32 v2, code_end-ct_pc-4, v2
    global_load_dword v255, v2, s[74:75]
ct_skip:
    s_and_b32 s74, s2, 7
    s_lshr_b32 s75, s2, 3
    s_and_b32 s63, s75, 7
    s_lshr_b32 s66, s75, 3
    s_lshr_b32 s64, s74, 2
    s_and_b32 s67, s74, 3
    s_lshl_b32 s65, s67, 2
    s_add_u32 s65, s65, s66
    s_and_b32 s68, s62, 3
    s_lshl_b32 s69, s68, 12
    s_lshl_b32 s78, s64, 3
    s_add_u32 s78, s78, s63
    s_lshl_b32 s74, s63, 5
    s_add_u32 s74, s74, s65
    s_lshl_b32 s70, s74, 17
    s_and_b32 s77, s67, 1
    s_lshl_b32 s75, s77, 21
    s_add_u32 s70, s70, s75
    s_xor_b32 s74, s65, s63
    s_and_b32 s74, s74, 7
    s_bfe_u32 s75, s74, 65536
    s_lshl_b32 s75, s75, 10
    s_add_u32 s70, s70, s75
    s_bfe_u32 s75, s74, 65537
    s_lshl_b32 s75, s75, 11
    s_add_u32 s70, s70, s75
    s_bfe_u32 s75, s74, 65538
    s_lshl_b32 s75, s75, 12
    s_add_u32 s70, s70, s75
    s_xor_b32 s71, s70, 2228224
    s_lshl_b32 s72, s65, 8
    s_lshl_b32 s75, s77, 12
    s_add_u32 s72, s72, s75
    s_xor_b32 s73, s72, 4352
    s_mov_b32 s18, 917504
    s_mov_b32 s19, 0x20000
    s_mov_b32 s6, 33554432
    s_mov_b32 s7, 0x20000
    s_mov_b32 s10, 33554432
    s_mov_b32 s11, 0x20000
    s_mov_b32 s14, 4194304
    s_mov_b32 s15, 0x20000
    s_mov_b32 s26, 4194304
    s_mov_b32 s27, 0x20000
    s_mov_b32 s22, 268435456
    s_mov_b32 s23, 0x20000
    s_mov_b32 s30, 1835008
    s_mov_b32 s31, 0x20000
    s_mov_b32 s34, 256
    s_mov_b32 s35, 0x20000
    v_lshrrev_b32 v2, 4, v0
    v_bfe_u32 v3, v0, 2, 2
    v_and_b32 v4, 3, v0
    s_cmp_eq_u32 s64, 0
    s_waitcnt lgkmcnt(0)
    s_cselect_b32 s12, s42, s52
    s_cselect_b32 s13, s43, s53
    s_cselect_b32 s16, s36, s46
    s_cselect_b32 s17, s37, s47
    s_cselect_b32 s4, s38, s48
    s_cselect_b32 s5, s39, s49
    s_cselect_b32 s8, s40, s50
    s_cselect_b32 s9, s41, s51
    s_cselect_b32 s24, s44, s54
    s_cselect_b32 s25, s45, s55
    s_mov_b32 s20, s60
    s_mov_b32 s21, s61
    s_mov_b32 s28, s56
    s_mov_b32 s29, s57
    s_mov_b32 s32, s58
    s_mov_b32 s33, s59
    s_cmp_lt_u32 s62, 4
    s_cbranch_scc0 g_wave
a_wave:
    v_lshlrev_b32 v22, 8, v3
    v_lshl_add_u32 v22, v2, 6, v22
    s_and_b32 s74, s68, 1
    s_lshl_b32 s74, s74, 15
    s_lshr_b32 s75, s68, 1
    s_lshl_b32 s75, s75, 16
    s_add_u32 s74, s74, s75
    v_add_u32 v22, s74, v22
    v_xor_b32 v5, 0, v4
    v_lshl_add_u32 v5, v5, 4, v22
    v_xor_b32 v6, 1, v4
    v_lshl_add_u32 v6, v6, 4, v22
    v_xor_b32 v7, 2, v4
    v_lshl_add_u32 v7, v7, 4, v22
    v_xor_b32 v8, 3, v4
    v_lshl_add_u32 v8, v8, 4, v22
    s_lshr_b32 s43, s2, 3
    v_and_b32 v160, 31, v0
    v_min_u32 v160, 27, v160
    v_lshrrev_b32 v162, 5, v0
    v_lshlrev_b32 v160, 10, v160
    v_lshl_add_u32 v160, v162, 7, v160
    s_mul_i32 s76, s63, 114688
    s_mul_i32 s41, s66, 28672
    s_add_u32 s76, s76, s41
    s_lshl_b32 s41, s68, 8
    s_add_u32 s76, s76, s41
    v_bfe_u32 v161, v0, 3, 1
    v_lshl_add_u32 v161, v162, 6, v161
    v_and_b32 v22, 7, v0
    v_lshlrev_b32 v22, 7, v22
    v_lshl_add_u32 v161, v161, 13, v22
    s_lshl_b32 s74, s68, 6
    s_add_u32 s74, s74, s43
    s_lshl_b32 s74, s74, 14
    s_lshl_b32 s41, s67, 10
    s_add_u32 s74, s74, s41
    s_lshl_b32 s41, s77, 12
    s_add_u32 s74, s74, s41
    s_mov_b32 s41, s68
a_dly:
    s_sub_u32 s41, s41, 1
    s_cbranch_scc1 a_dly_end
    s_sleep 6
    s_branch a_dly
a_dly_end:
    buffer_load_dword v4, v160, s[16:19], s76 offen offset:0
    buffer_load_dword v4, v161, s[12:15], s74 offen offset:0
    s_and_b32 s74, s68, 1
    s_lshl_b32 s75, s43, 1
    s_add_u32 s74, s74, s75
    s_lshr_b32 s75, s68, 1
    s_xor_b32 s75, s75, s77
    s_lshl_b32 s75, s75, 2
    s_add_u32 s75, s75, s67
    s_lshl_b32 s76, s74, 16
    s_lshl_b32 s41, s75, 10
    s_add_u32 s43, s76, s41
    s_lshl_b32 s75, s75, 19
    s_lshl_b32 s74, s74, 13
    s_add_u32 s40, s74, s75
    s_lshl_b32 s74, s68, 4
    v_add_u32 v101, s74, v3
    v_lshlrev_b32 v102, 4, v4
    v_lshl_add_u32 v96, v2, 6, v102
    v_lshl_add_u32 v96, v101, 13, v96
    s_lshl_b32 s74, s68, 5
    s_mul_i32 s53, s63, 114688
    v_lshrrev_b32 v101, 3, v0
    v_xor_b32 v102, v101, v0
    v_and_b32 v102, 7, v102
    v_lshlrev_b32 v102, 4, v102
    v_add_u32 v101, s74, v101
    v_min_u32 v97, 111, v101
    v_lshl_add_u32 v97, v97, 10, v102
    v_add_u32 v98, 8, v101
    v_min_u32 v98, 111, v98
    v_subrev_u32 v98, 1, v98
    v_lshl_add_u32 v98, v98, 10, v102
    v_add_u32 v99, 16, v101
    v_min_u32 v99, 111, v99
    v_subrev_u32 v99, 2, v99
    v_lshl_add_u32 v99, v99, 10, v102
    v_add_u32 v100, 24, v101
    v_min_u32 v100, 111, v100
    v_subrev_u32 v100, 3, v100
    v_lshl_add_u32 v100, v100, 10, v102
    s_add_u32 m0, s69, 65536
    s_add_u32 s41, s53, 256
    buffer_load_dwordx4 v97, s[16:19], s41 offen offset:0 lds
    buffer_load_dwordx4 v98, s[16:19], s41 offen offset:1024 lds
    buffer_load_dwordx4 v99, s[16:19], s41 offen offset:2048 lds
    buffer_load_dwordx4 v100, s[16:19], s41 offen offset:3072 lds
    s_add_u32 m0, s69, 81920
    s_add_u32 s41, s72, 1048576
    buffer_load_dwordx4 v96, s[12:15], s41 offen offset:0 lds
    s_add_u32 s41, s72, 1080320
    buffer_load_dwordx4 v96, s[12:15], s41 offen offset:1024 lds
    s_add_u32 s41, s72, 1112064
    buffer_load_dwordx4 v96, s[12:15], s41 offen offset:2048 lds
    s_add_u32 s41, s72, 1143808
    buffer_load_dwordx4 v96, s[12:15], s41 offen offset:3072 lds
    s_add_u32 m0, s69, 98304
    s_xor_b32 s41, s70, 0
    buffer_load_dwordx4 v5, s[4:7], s41 offen offset:0 nt lds
    s_add_u32 s41, s41, 7168
    buffer_load_dwordx4 v6, s[4:7], s41 offen offset:1024 nt lds
    s_add_u32 s41, s41, 7168
    buffer_load_dwordx4 v7, s[4:7], s41 offen offset:2048 nt lds
    s_add_u32 s41, s41, 7168
    buffer_load_dwordx4 v8, s[4:7], s41 offen offset:3072 nt lds
    s_branch a_main
g_wave:
    s_lshl_b32 s74, s68, 4
    v_add_u32 v9, s74, v3
    v_lshlrev_b32 v10, 4, v4
    v_lshl_add_u32 v5, v2, 6, v10
    v_lshl_add_u32 v5, v9, 13, v5
    s_lshl_b32 s74, s68, 5
    s_mul_i32 s40, s63, 114688
    v_lshrrev_b32 v30, 3, v0
    v_xor_b32 v31, v30, v0
    v_and_b32 v31, 7, v31
    v_lshlrev_b32 v31, 4, v31
    v_add_u32 v30, s74, v30
    v_min_u32 v22, 111, v30
    v_lshl_add_u32 v22, v22, 10, v31
    v_add_u32 v23, 8, v30
    v_min_u32 v23, 111, v23
    v_subrev_u32 v23, 1, v23
    v_lshl_add_u32 v23, v23, 10, v31
    v_add_u32 v24, 16, v30
    v_min_u32 v24, 111, v24
    v_subrev_u32 v24, 2, v24
    v_lshl_add_u32 v24, v24, 10, v31
    v_add_u32 v25, 24, v30
    v_min_u32 v25, 111, v25
    v_subrev_u32 v25, 3, v25
    v_lshl_add_u32 v25, v25, 10, v31
    s_add_u32 m0, s69, 0
    s_add_u32 s41, s40, 0
    buffer_load_dwordx4 v22, s[16:19], s41 offen offset:0 lds
    buffer_load_dwordx4 v23, s[16:19], s41 offen offset:1024 lds
    buffer_load_dwordx4 v24, s[16:19], s41 offen offset:2048 lds
    buffer_load_dwordx4 v25, s[16:19], s41 offen offset:3072 lds
    s_add_u32 m0, s69, 16384
    s_add_u32 s41, s72, 0
    buffer_load_dwordx4 v5, s[12:15], s41 offen offset:0 lds
    s_add_u32 s41, s72, 31744
    buffer_load_dwordx4 v5, s[12:15], s41 offen offset:1024 lds
    s_add_u32 s41, s72, 63488
    buffer_load_dwordx4 v5, s[12:15], s41 offen offset:2048 lds
    s_add_u32 s41, s72, 95232
    buffer_load_dwordx4 v5, s[12:15], s41 offen offset:3072 lds
    s_add_u32 m0, s69, 32768
    s_add_u32 s41, s40, 128
    buffer_load_dwordx4 v22, s[16:19], s41 offen offset:0 lds
    buffer_load_dwordx4 v23, s[16:19], s41 offen offset:1024 lds
    buffer_load_dwordx4 v24, s[16:19], s41 offen offset:2048 lds
    buffer_load_dwordx4 v25, s[16:19], s41 offen offset:3072 lds
    s_add_u32 m0, s69, 49152
    s_add_u32 s41, s72, 524288
    buffer_load_dwordx4 v5, s[12:15], s41 offen offset:0 lds
    s_add_u32 s41, s72, 556032
    buffer_load_dwordx4 v5, s[12:15], s41 offen offset:1024 lds
    s_add_u32 s41, s72, 587776
    buffer_load_dwordx4 v5, s[12:15], s41 offen offset:2048 lds
    s_add_u32 s41, s72, 619520
    buffer_load_dwordx4 v5, s[12:15], s41 offen offset:3072 lds
    v_and_b32 v7, 31, v0
    v_add_u32 v14, s74, v7
    v_lshrrev_b32 v8, 5, v0
    v_and_b32 v30, 7, v0
    v_xor_b32 v30, v30, v8
    v_lshlrev_b32 v30, 4, v30
    v_lshl_add_u32 v30, v7, 7, v30
    v_add_u32 v26, s69, v30
    v_xor_b32 v27, 32, v26
    v_xor_b32 v28, 64, v26
    v_xor_b32 v29, 96, v26
    v_lshlrev_b32 v8, 4, v8
    s_setprio 0
    s_lshl_b32 s74, s78, 5
    s_add_u32 s75, s74, s65
    s_lshl_b32 s75, s75, 2
    s_add_u32 s75, s75, s68
    s_lshl_b32 s79, s75, 13
    s_xor_b32 s80, s79, 557056
    s_xor_b32 s75, s66, 2
    s_lshl_b32 s75, s75, 8
    s_lshl_b32 s76, s65, 17
    s_add_u32 s85, s75, s76
    s_lshl_b32 s75, s77, 21
    s_add_u32 s85, s85, s75
    s_xor_b32 s54, s85, 2097152
    s_xor_b32 s55, s85, 2228224
    s_xor_b32 s56, s85, 2359296
    s_xor_b32 s57, s85, 2490368
    s_mov_b32 s81, s79
    s_xor_b32 s86, s85, 131072
    s_xor_b32 s82, s79, 32768
    s_xor_b32 s87, s85, 262144
    s_xor_b32 s83, s79, 65536
    s_xor_b32 s88, s85, 393216
    s_xor_b32 s84, s79, 98304
    s_lshl_b32 s74, s78, 2
    s_add_u32 s74, s74, s66
    s_lshl_b32 s74, s74, 2
    s_add_u32 s75, s74, s67
    s_lshl_b32 s75, s75, 16
    s_add_u32 s75, s75, s69
    s_add_u32 s92, s75, 16777216
    s_add_u32 s75, s67, 1
    s_and_b32 s75, s75, 3
    s_add_u32 s75, s75, s74
    s_lshl_b32 s75, s75, 16
    s_add_u32 s75, s75, s69
    s_add_u32 s89, s75, 16826368
    s_add_u32 s75, s67, 2
    s_and_b32 s75, s75, 3
    s_add_u32 s75, s75, s74
    s_lshl_b32 s75, s75, 16
    s_add_u32 s75, s75, s69
    s_add_u32 s90, s75, 16809984
    s_add_u32 s75, s67, 3
    s_and_b32 s75, s75, 3
    s_add_u32 s75, s75, s74
    s_lshl_b32 s75, s75, 16
    s_add_u32 s75, s75, s69
    s_add_u32 s91, s75, 16793600
    s_lshl_b32 s96, 1, s65
    s_lshl_b32 s74, s67, 2
    s_lshl_b32 s94, 15, s74
    s_lshl_b32 s95, 0x1111, s66
    s_lshl_b32 s97, s78, 4
    s_mul_i32 s98, s63, 229376
    s_lshl_b32 s74, s64, 10
    s_add_u32 s98, s98, s74
    s_xor_b32 s74, s66, 2
    s_lshl_b32 s74, s74, 8
    s_add_u32 s98, s98, s74
    s_lshl_b32 s74, s67, 6
    s_add_u32 s98, s98, s74
    s_mov_b32 s99, 100000
    s_cmp_eq_u32 s68, 3
    s_cselect_b32 s46, 0xffff, -1
    s_mov_b32 s47, s46
    s_and_b32 s48, s46, -1
    s_mov_b32 s49, s48
    v_add_u32 v6, s67, v2
    v_and_b32 v6, 3, v6
    v_lshl_add_u32 v6, v6, 6, v10
    v_lshl_add_u32 v6, v9, 10, v6
    v_lshl_add_u32 v14, v14, 11, v8
    v_lshlrev_b32 v8, 4, v0
    v_lshrrev_b32 v9, 5, v0
    v_lshlrev_b32 v11, 11, v9
    v_bfe_u32 v9, v0, 2, 2
    v_lshl_add_u32 v11, v9, 6, v11
    v_bfe_u32 v9, v0, 4, 1
    v_lshl_add_u32 v11, v9, 5, v11
    v_and_b32 v9, 3, v0
    v_lshl_add_u32 v11, v9, 3, v11
    v_add_u32 v12, 65536, v11
    v_add_u32 v13, 131072, v11
    s_waitcnt vmcnt(8)
    s_barrier
    ds_read_b128 v[128:131], v26 offset:0
    ds_read_b128 v[132:135], v27 offset:0
    ds_read_b128 v[136:139], v28 offset:0
    ds_read_b128 v[140:143], v29 offset:0
    ds_read_b64_tr_b16 v[32:33], v11 offset:16384
    ds_read_b64_tr_b16 v[34:35], v11 offset:17408
    ds_read_b64_tr_b16 v[36:37], v11 offset:16640
    ds_read_b64_tr_b16 v[38:39], v11 offset:17664
    ds_read_b64_tr_b16 v[40:41], v11 offset:16896
    ds_read_b64_tr_b16 v[42:43], v11 offset:17920
    ds_read_b64_tr_b16 v[44:45], v11 offset:17152
    ds_read_b64_tr_b16 v[46:47], v11 offset:18176
    ds_read_b64_tr_b16 v[48:49], v11 offset:20480
    ds_read_b64_tr_b16 v[50:51], v11 offset:21504
    ds_read_b64_tr_b16 v[52:53], v11 offset:20736
    ds_read_b64_tr_b16 v[54:55], v11 offset:21760
    s_waitcnt lgkmcnt(15)
    s_waitcnt lgkmcnt(10)
    v_mfma_f32_32x32x16_bf16 v[64:79], v[32:35], v[128:131], 0
    ds_read_b64_tr_b16 v[56:57], v11 offset:20992
    ds_read_b64_tr_b16 v[58:59], v11 offset:22016
    s_waitcnt lgkmcnt(10)
    v_mfma_f32_32x32x16_bf16 v[80:95], v[36:39], v[128:131], 0
    ds_read_b64_tr_b16 v[60:61], v11 offset:21248
    ds_read_b64_tr_b16 v[62:63], v11 offset:22272
    s_waitcnt lgkmcnt(10)
    v_mfma_f32_32x32x16_bf16 v[96:111], v[40:43], v[128:131], 0
    ds_read_b64_tr_b16 v[32:33], v11 offset:24576
    ds_read_b64_tr_b16 v[34:35], v11 offset:25600
    s_waitcnt lgkmcnt(10)
    v_mfma_f32_32x32x16_bf16 v[112:127], v[44:47], v[128:131], 0
    ds_read_b64_tr_b16 v[36:37], v11 offset:24832
    ds_read_b64_tr_b16 v[38:39], v11 offset:25856
    s_waitcnt lgkmcnt(10)
    v_mfma_f32_32x32x16_bf16 v[64:79], v[48:51], v[132:135], v[64:79]
    ds_read_b64_tr_b16 v[40:41], v11 offset:25088
    ds_read_b64_tr_b16 v[42:43], v11 offset:26112
    s_waitcnt lgkmcnt(10)
    v_mfma_f32_32x32x16_bf16 v[80:95], v[52:55], v[132:135], v[80:95]
    ds_read_b64_tr_b16 v[44:45], v11 offset:25344
    ds_read_b64_tr_b16 v[46:47], v11 offset:26368
    s_waitcnt lgkmcnt(10)
    v_mfma_f32_32x32x16_bf16 v[96:111], v[56:59], v[132:135], v[96:111]
    ds_read_b64_tr_b16 v[48:49], v11 offset:28672
    ds_read_b64_tr_b16 v[50:51], v11 offset:29696
    s_waitcnt lgkmcnt(10)
    v_mfma_f32_32x32x16_bf16 v[112:127], v[60:63], v[132:135], v[112:127]
    ds_read_b64_tr_b16 v[52:53], v11 offset:28928
    ds_read_b64_tr_b16 v[54:55], v11 offset:29952
    s_waitcnt lgkmcnt(10)
    v_mfma_f32_32x32x16_bf16 v[64:79], v[32:35], v[136:139], v[64:79]
    ds_read_b64_tr_b16 v[56:57], v11 offset:29184
    ds_read_b64_tr_b16 v[58:59], v11 offset:30208
    s_waitcnt lgkmcnt(10)
    v_mfma_f32_32x32x16_bf16 v[80:95], v[36:39], v[136:139], v[80:95]
    ds_read_b64_tr_b16 v[60:61], v11 offset:29440
    ds_read_b64_tr_b16 v[62:63], v11 offset:30464
    s_waitcnt lgkmcnt(10)
    v_mfma_f32_32x32x16_bf16 v[96:111], v[40:43], v[136:139], v[96:111]
    s_waitcnt lgkmcnt(8)
    v_mfma_f32_32x32x16_bf16 v[112:127], v[44:47], v[136:139], v[112:127]
    s_waitcnt lgkmcnt(6)
    v_mfma_f32_32x32x16_bf16 v[64:79], v[48:51], v[140:143], v[64:79]
    s_waitcnt lgkmcnt(4)
    v_mfma_f32_32x32x16_bf16 v[80:95], v[52:55], v[140:143], v[80:95]
    s_waitcnt lgkmcnt(2)
    v_mfma_f32_32x32x16_bf16 v[96:111], v[56:59], v[140:143], v[96:111]
    s_waitcnt lgkmcnt(0)
    v_mfma_f32_32x32x16_bf16 v[112:127], v[60:63], v[140:143], v[112:127]
    s_waitcnt vmcnt(0)
    s_barrier
    ds_read_b128 v[144:147], v26 offset:32768
    ds_read_b128 v[148:151], v27 offset:32768
    ds_read_b128 v[152:155], v28 offset:32768
    ds_read_b128 v[156:159], v29 offset:32768
    ds_read_b64_tr_b16 v[32:33], v11 offset:49152
    ds_read_b64_tr_b16 v[34:35], v11 offset:50176
    ds_read_b64_tr_b16 v[36:37], v11 offset:49408
    ds_read_b64_tr_b16 v[38:39], v11 offset:50432
    ds_read_b64_tr_b16 v[40:41], v11 offset:49664
    ds_read_b64_tr_b16 v[42:43], v11 offset:50688
    ds_read_b64_tr_b16 v[44:45], v11 offset:49920
    ds_read_b64_tr_b16 v[46:47], v11 offset:50944
    ds_read_b64_tr_b16 v[48:49], v11 offset:53248
    ds_read_b64_tr_b16 v[50:51], v11 offset:54272
    ds_read_b64_tr_b16 v[52:53], v11 offset:53504
    ds_read_b64_tr_b16 v[54:55], v11 offset:54528
    s_waitcnt lgkmcnt(15)
    s_waitcnt lgkmcnt(10)
    v_mfma_f32_32x32x16_bf16 v[64:79], v[32:35], v[144:147], v[64:79]
    ds_read_b64_tr_b16 v[56:57], v11 offset:53760
    ds_read_b64_tr_b16 v[58:59], v11 offset:54784
    s_waitcnt lgkmcnt(10)
    v_mfma_f32_32x32x16_bf16 v[80:95], v[36:39], v[144:147], v[80:95]
    ds_read_b64_tr_b16 v[60:61], v11 offset:54016
    ds_read_b64_tr_b16 v[62:63], v11 offset:55040
    s_waitcnt lgkmcnt(10)
    v_mfma_f32_32x32x16_bf16 v[96:111], v[40:43], v[144:147], v[96:111]
    ds_read_b64_tr_b16 v[32:33], v11 offset:57344
    ds_read_b64_tr_b16 v[34:35], v11 offset:58368
    s_waitcnt lgkmcnt(10)
    v_mfma_f32_32x32x16_bf16 v[112:127], v[44:47], v[144:147], v[112:127]
    ds_read_b64_tr_b16 v[36:37], v11 offset:57600
    ds_read_b64_tr_b16 v[38:39], v11 offset:58624
    s_waitcnt lgkmcnt(10)
    v_mfma_f32_32x32x16_bf16 v[64:79], v[48:51], v[148:151], v[64:79]
    ds_read_b64_tr_b16 v[40:41], v11 offset:57856
    ds_read_b64_tr_b16 v[42:43], v11 offset:58880
    s_waitcnt lgkmcnt(10)
    v_mfma_f32_32x32x16_bf16 v[80:95], v[52:55], v[148:151], v[80:95]
    ds_read_b64_tr_b16 v[44:45], v11 offset:58112
    ds_read_b64_tr_b16 v[46:47], v11 offset:59136
    s_waitcnt lgkmcnt(10)
    v_mfma_f32_32x32x16_bf16 v[96:111], v[56:59], v[148:151], v[96:111]
    ds_read_b64_tr_b16 v[48:49], v11 offset:61440
    ds_read_b64_tr_b16 v[50:51], v11 offset:62464
    s_waitcnt lgkmcnt(10)
    v_mfma_f32_32x32x16_bf16 v[112:127], v[60:63], v[148:151], v[112:127]
    ds_read_b64_tr_b16 v[52:53], v11 offset:61696
    ds_read_b64_tr_b16 v[54:55], v11 offset:62720
    s_waitcnt lgkmcnt(10)
    v_mfma_f32_32x32x16_bf16 v[64:79], v[32:35], v[152:155], v[64:79]
    ds_read_b64_tr_b16 v[56:57], v11 offset:61952
    ds_read_b64_tr_b16 v[58:59], v11 offset:62976
    v_add_u32 v30, 65536, v26
    ds_read_b128 v[160:163], v30 offset:0
    v_add_u32 v31, 65536, v27
    ds_read_b128 v[164:167], v31 offset:0
    v_add_u32 v30, 65536, v28
    ds_read_b128 v[168:171], v30 offset:0
    v_add_u32 v31, 65536, v29
    ds_read_b128 v[172:175], v31 offset:0
    s_waitcnt lgkmcnt(14)
    v_mfma_f32_32x32x16_bf16 v[80:95], v[36:39], v[152:155], v[80:95]
    ds_read_b64_tr_b16 v[60:61], v11 offset:62208
    ds_read_b64_tr_b16 v[62:63], v11 offset:63232
    s_waitcnt lgkmcnt(14)
    v_mfma_f32_32x32x16_bf16 v[96:111], v[40:43], v[152:155], v[96:111]
    ds_read_b64_tr_b16 v[32:33], v12 offset:16384
    ds_read_b64_tr_b16 v[34:35], v12 offset:17408
    s_waitcnt lgkmcnt(14)
    v_mfma_f32_32x32x16_bf16 v[112:127], v[44:47], v[152:155], v[112:127]
    ds_read_b64_tr_b16 v[36:37], v12 offset:16640
    ds_read_b64_tr_b16 v[38:39], v12 offset:17664
    s_waitcnt lgkmcnt(14)
    v_mfma_f32_32x32x16_bf16 v[64:79], v[48:51], v[156:159], v[64:79]
    ds_read_b64_tr_b16 v[40:41], v12 offset:16896
    ds_read_b64_tr_b16 v[42:43], v12 offset:17920
    s_waitcnt lgkmcnt(14)
    v_mfma_f32_32x32x16_bf16 v[80:95], v[52:55], v[156:159], v[80:95]
    ds_read_b64_tr_b16 v[44:45], v12 offset:17152
    ds_read_b64_tr_b16 v[46:47], v12 offset:18176
    s_waitcnt lgkmcnt(14)
    v_mfma_f32_32x32x16_bf16 v[96:111], v[56:59], v[156:159], v[96:111]
    ds_read_b64_tr_b16 v[48:49], v12 offset:20480
    ds_read_b64_tr_b16 v[50:51], v12 offset:21504
    s_waitcnt lgkmcnt(10)
    v_mfma_f32_32x32x16_bf16 v[112:127], v[60:63], v[156:159], v[112:127]
    ds_read_b64_tr_b16 v[52:53], v12 offset:20736
    ds_read_b64_tr_b16 v[54:55], v12 offset:21760
    s_barrier
    s_waitcnt lgkmcnt(10)
    v_mfma_f32_32x32x16_bf16 v[64:79], v[32:35], v[160:163], v[64:79]
    ds_read_b64_tr_b16 v[56:57], v12 offset:20992
    ds_read_b64_tr_b16 v[58:59], v12 offset:22016
    s_waitcnt lgkmcnt(10)
    v_mfma_f32_32x32x16_bf16 v[80:95], v[36:39], v[160:163], v[80:95]
    ds_read_b64_tr_b16 v[60:61], v12 offset:21248
    ds_read_b64_tr_b16 v[62:63], v12 offset:22272
    s_waitcnt lgkmcnt(10)
    v_mfma_f32_32x32x16_bf16 v[96:111], v[40:43], v[160:163], v[96:111]
    ds_read_b64_tr_b16 v[32:33], v12 offset:24576
    ds_read_b64_tr_b16 v[34:35], v12 offset:25600
    s_waitcnt lgkmcnt(10)
    v_mfma_f32_32x32x16_bf16 v[112:127], v[44:47], v[160:163], v[112:127]
    ds_read_b64_tr_b16 v[36:37], v12 offset:24832
    ds_read_b64_tr_b16 v[38:39], v12 offset:25856
    s_waitcnt lgkmcnt(10)
    v_mfma_f32_32x32x16_bf16 v[64:79], v[48:51], v[164:167], v[64:79]
    ds_read_b64_tr_b16 v[40:41], v12 offset:25088
    ds_read_b64_tr_b16 v[42:43], v12 offset:26112
    s_waitcnt lgkmcnt(10)
    v_mfma_f32_32x32x16_bf16 v[80:95], v[52:55], v[164:167], v[80:95]
    ds_read_b64_tr_b16 v[44:45], v12 offset:25344
    ds_read_b64_tr_b16 v[46:47], v12 offset:26368
    s_waitcnt lgkmcnt(10)
    v_mfma_f32_32x32x16_bf16 v[96:111], v[56:59], v[164:167], v[96:111]
    ds_read_b64_tr_b16 v[48:49], v12 offset:28672
    ds_read_b64_tr_b16 v[50:51], v12 offset:29696
    s_waitcnt lgkmcnt(10)
    v_mfma_f32_32x32x16_bf16 v[112:127], v[60:63], v[164:167], v[112:127]
    ds_read_b64_tr_b16 v[52:53], v12 offset:28928
    ds_read_b64_tr_b16 v[54:55], v12 offset:29952
    s_waitcnt lgkmcnt(10)
    v_mfma_f32_32x32x16_bf16 v[64:79], v[32:35], v[168:171], v[64:79]
    ds_read_b64_tr_b16 v[56:57], v12 offset:29184
    ds_read_b64_tr_b16 v[58:59], v12 offset:30208
    v_add_u32 v30, 65536, v26
    ds_read_b128 v[176:179], v30 offset:49152
    v_add_u32 v31, 65536, v27
    ds_read_b128 v[180:183], v31 offset:49152
    v_add_u32 v30, 65536, v28
    ds_read_b128 v[184:187], v30 offset:49152
    v_add_u32 v31, 65536, v29
    ds_read_b128 v[188:191], v31 offset:49152
    s_waitcnt lgkmcnt(14)
    v_mfma_f32_32x32x16_bf16 v[80:95], v[36:39], v[168:171], v[80:95]
    ds_read_b64_tr_b16 v[60:61], v12 offset:29440
    ds_read_b64_tr_b16 v[62:63], v12 offset:30464
    s_waitcnt lgkmcnt(14)
    v_mfma_f32_32x32x16_bf16 v[96:111], v[40:43], v[168:171], v[96:111]
    ds_read_b64_tr_b16 v[32:33], v13 offset:0
    ds_read_b64_tr_b16 v[34:35], v13 offset:1024
    s_waitcnt lgkmcnt(14)
    v_mfma_f32_32x32x16_bf16 v[112:127], v[44:47], v[168:171], v[112:127]
    ds_read_b64_tr_b16 v[36:37], v13 offset:256
    ds_read_b64_tr_b16 v[38:39], v13 offset:1280
    s_waitcnt lgkmcnt(14)
    v_mfma_f32_32x32x16_bf16 v[64:79], v[48:51], v[172:175], v[64:79]
    ds_read_b64_tr_b16 v[40:41], v13 offset:512
    ds_read_b64_tr_b16 v[42:43], v13 offset:1536
    s_waitcnt lgkmcnt(14)
    v_mfma_f32_32x32x16_bf16 v[80:95], v[52:55], v[172:175], v[80:95]
    ds_read_b64_tr_b16 v[44:45], v13 offset:768
    ds_read_b64_tr_b16 v[46:47], v13 offset:1792
    s_waitcnt lgkmcnt(14)
    v_mfma_f32_32x32x16_bf16 v[96:111], v[56:59], v[172:175], v[96:111]
    ds_read_b64_tr_b16 v[48:49], v13 offset:4096
    ds_read_b64_tr_b16 v[50:51], v13 offset:5120
    s_waitcnt lgkmcnt(10)
    v_mfma_f32_32x32x16_bf16 v[112:127], v[60:63], v[172:175], v[112:127]
    ds_read_b64_tr_b16 v[52:53], v13 offset:4352
    ds_read_b64_tr_b16 v[54:55], v13 offset:5376
    s_barrier
    s_waitcnt lgkmcnt(10)
    v_mfma_f32_32x32x16_bf16 v[64:79], v[32:35], v[176:179], v[64:79]
    ds_read_b64_tr_b16 v[56:57], v13 offset:4608
    ds_read_b64_tr_b16 v[58:59], v13 offset:5632
    s_waitcnt lgkmcnt(10)
    v_mfma_f32_32x32x16_bf16 v[80:95], v[36:39], v[176:179], v[80:95]
    ds_read_b64_tr_b16 v[60:61], v13 offset:4864
    ds_read_b64_tr_b16 v[62:63], v13 offset:5888
    s_waitcnt lgkmcnt(10)
    v_mfma_f32_32x32x16_bf16 v[96:111], v[40:43], v[176:179], v[96:111]
    ds_read_b64_tr_b16 v[32:33], v13 offset:8192
    ds_read_b64_tr_b16 v[34:35], v13 offset:9216
    s_waitcnt lgkmcnt(10)
    v_mfma_f32_32x32x16_bf16 v[112:127], v[44:47], v[176:179], v[112:127]
    ds_read_b64_tr_b16 v[36:37], v13 offset:8448
    ds_read_b64_tr_b16 v[38:39], v13 offset:9472
    s_waitcnt lgkmcnt(10)
    v_mfma_f32_32x32x16_bf16 v[64:79], v[48:51], v[180:183], v[64:79]
    ds_read_b64_tr_b16 v[40:41], v13 offset:8704
    ds_read_b64_tr_b16 v[42:43], v13 offset:9728
    s_waitcnt lgkmcnt(10)
    v_mfma_f32_32x32x16_bf16 v[80:95], v[52:55], v[180:183], v[80:95]
    ds_read_b64_tr_b16 v[44:45], v13 offset:8960
    ds_read_b64_tr_b16 v[46:47], v13 offset:9984
    s_waitcnt lgkmcnt(10)
    v_mfma_f32_32x32x16_bf16 v[96:111], v[56:59], v[180:183], v[96:111]
    ds_read_b64_tr_b16 v[48:49], v13 offset:12288
    ds_read_b64_tr_b16 v[50:51], v13 offset:13312
    s_waitcnt lgkmcnt(10)
    v_mfma_f32_32x32x16_bf16 v[112:127], v[60:63], v[180:183], v[112:127]
    ds_read_b64_tr_b16 v[52:53], v13 offset:12544
    ds_read_b64_tr_b16 v[54:55], v13 offset:13568
    s_waitcnt lgkmcnt(10)
    v_mfma_f32_32x32x16_bf16 v[64:79], v[32:35], v[184:187], v[64:79]
    ds_read_b64_tr_b16 v[56:57], v13 offset:12800
    ds_read_b64_tr_b16 v[58:59], v13 offset:13824
    ds_read_b128 v[192:195], v26 offset:0
    ds_read_b128 v[196:199], v27 offset:0
    ds_read_b128 v[200:203], v28 offset:0
    ds_read_b128 v[204:207], v29 offset:0
    s_waitcnt lgkmcnt(14)
    v_mfma_f32_32x32x16_bf16 v[80:95], v[36:39], v[184:187], v[80:95]
    ds_read_b64_tr_b16 v[60:61], v13 offset:13056
    ds_read_b64_tr_b16 v[62:63], v13 offset:14080
    s_waitcnt lgkmcnt(14)
    v_mfma_f32_32x32x16_bf16 v[96:111], v[40:43], v[184:187], v[96:111]
    ds_read_b64_tr_b16 v[32:33], v11 offset:16384
    ds_read_b64_tr_b16 v[34:35], v11 offset:17408
    s_waitcnt lgkmcnt(14)
    v_mfma_f32_32x32x16_bf16 v[112:127], v[44:47], v[184:187], v[112:127]
    ds_read_b64_tr_b16 v[36:37], v11 offset:16640
    ds_read_b64_tr_b16 v[38:39], v11 offset:17664
    s_waitcnt lgkmcnt(14)
    v_mfma_f32_32x32x16_bf16 v[64:79], v[48:51], v[188:191], v[64:79]
    ds_read_b64_tr_b16 v[40:41], v11 offset:16896
    ds_read_b64_tr_b16 v[42:43], v11 offset:17920
    s_waitcnt lgkmcnt(14)
    v_mfma_f32_32x32x16_bf16 v[80:95], v[52:55], v[188:191], v[80:95]
    ds_read_b64_tr_b16 v[44:45], v11 offset:17152
    ds_read_b64_tr_b16 v[46:47], v11 offset:18176
    s_waitcnt lgkmcnt(14)
    v_mfma_f32_32x32x16_bf16 v[96:111], v[56:59], v[188:191], v[96:111]
    ds_read_b64_tr_b16 v[48:49], v11 offset:20480
    ds_read_b64_tr_b16 v[50:51], v11 offset:21504
    s_waitcnt lgkmcnt(10)
    v_mfma_f32_32x32x16_bf16 v[112:127], v[60:63], v[188:191], v[112:127]
    ds_read_b64_tr_b16 v[52:53], v11 offset:20736
    ds_read_b64_tr_b16 v[54:55], v11 offset:21760
    s_barrier
    s_waitcnt lgkmcnt(10)
    v_mfma_f32_32x32x16_bf16 v[64:79], v[32:35], v[192:195], v[64:79]
    ds_read_b64_tr_b16 v[56:57], v11 offset:20992
    ds_read_b64_tr_b16 v[58:59], v11 offset:22016
    s_waitcnt lgkmcnt(10)
    v_mfma_f32_32x32x16_bf16 v[80:95], v[36:39], v[192:195], v[80:95]
    ds_read_b64_tr_b16 v[60:61], v11 offset:21248
    ds_read_b64_tr_b16 v[62:63], v11 offset:22272
    s_waitcnt lgkmcnt(10)
    v_mfma_f32_32x32x16_bf16 v[96:111], v[40:43], v[192:195], v[96:111]
    ds_read_b64_tr_b16 v[32:33], v11 offset:24576
    ds_read_b64_tr_b16 v[34:35], v11 offset:25600
    s_waitcnt lgkmcnt(10)
    v_mfma_f32_32x32x16_bf16 v[112:127], v[44:47], v[192:195], v[112:127]
    ds_read_b64_tr_b16 v[36:37], v11 offset:24832
    ds_read_b64_tr_b16 v[38:39], v11 offset:25856
    s_waitcnt lgkmcnt(10)
    v_mfma_f32_32x32x16_bf16 v[64:79], v[48:51], v[196:199], v[64:79]
    ds_read_b64_tr_b16 v[40:41], v11 offset:25088
    ds_read_b64_tr_b16 v[42:43], v11 offset:26112
    s_waitcnt lgkmcnt(10)
    v_mfma_f32_32x32x16_bf16 v[80:95], v[52:55], v[196:199], v[80:95]
    ds_read_b64_tr_b16 v[44:45], v11 offset:25344
    ds_read_b64_tr_b16 v[46:47], v11 offset:26368
    s_waitcnt lgkmcnt(10)
    v_mfma_f32_32x32x16_bf16 v[96:111], v[56:59], v[196:199], v[96:111]
    ds_read_b64_tr_b16 v[48:49], v11 offset:28672
    ds_read_b64_tr_b16 v[50:51], v11 offset:29696
    s_waitcnt lgkmcnt(10)
    v_mfma_f32_32x32x16_bf16 v[112:127], v[60:63], v[196:199], v[112:127]
    ds_read_b64_tr_b16 v[52:53], v11 offset:28928
    ds_read_b64_tr_b16 v[54:55], v11 offset:29952
    s_waitcnt lgkmcnt(10)
    v_mfma_f32_32x32x16_bf16 v[64:79], v[32:35], v[200:203], v[64:79]
    ds_read_b64_tr_b16 v[56:57], v11 offset:29184
    ds_read_b64_tr_b16 v[58:59], v11 offset:30208
    ds_read_b128 v[208:211], v26 offset:32768
    ds_read_b128 v[212:215], v27 offset:32768
    ds_read_b128 v[216:219], v28 offset:32768
    ds_read_b128 v[220:223], v29 offset:32768
    s_waitcnt lgkmcnt(14)
    v_mfma_f32_32x32x16_bf16 v[80:95], v[36:39], v[200:203], v[80:95]
    ds_read_b64_tr_b16 v[60:61], v11 offset:29440
    ds_read_b64_tr_b16 v[62:63], v11 offset:30464
    s_waitcnt lgkmcnt(14)
    v_mfma_f32_32x32x16_bf16 v[96:111], v[40:43], v[200:203], v[96:111]
    ds_read_b64_tr_b16 v[32:33], v11 offset:49152
    ds_read_b64_tr_b16 v[34:35], v11 offset:50176
    s_waitcnt lgkmcnt(14)
    v_mfma_f32_32x32x16_bf16 v[112:127], v[44:47], v[200:203], v[112:127]
    ds_read_b64_tr_b16 v[36:37], v11 offset:49408
    ds_read_b64_tr_b16 v[38:39], v11 offset:50432
    s_waitcnt lgkmcnt(14)
    v_mfma_f32_32x32x16_bf16 v[64:79], v[48:51], v[204:207], v[64:79]
    ds_read_b64_tr_b16 v[40:41], v11 offset:49664
    ds_read_b64_tr_b16 v[42:43], v11 offset:50688
    s_waitcnt lgkmcnt(14)
    v_mfma_f32_32x32x16_bf16 v[80:95], v[52:55], v[204:207], v[80:95]
    ds_read_b64_tr_b16 v[44:45], v11 offset:49920
    ds_read_b64_tr_b16 v[46:47], v11 offset:50944
    s_waitcnt lgkmcnt(14)
    v_mfma_f32_32x32x16_bf16 v[96:111], v[56:59], v[204:207], v[96:111]
    ds_read_b64_tr_b16 v[48:49], v11 offset:53248
    ds_read_b64_tr_b16 v[50:51], v11 offset:54272
    s_waitcnt lgkmcnt(10)
    v_mfma_f32_32x32x16_bf16 v[112:127], v[60:63], v[204:207], v[112:127]
    ds_read_b64_tr_b16 v[52:53], v11 offset:53504
    ds_read_b64_tr_b16 v[54:55], v11 offset:54528
    s_barrier
    s_waitcnt lgkmcnt(10)
    v_mfma_f32_32x32x16_bf16 v[64:79], v[32:35], v[208:211], v[64:79]
    ds_read_b64_tr_b16 v[56:57], v11 offset:53760
    ds_read_b64_tr_b16 v[58:59], v11 offset:54784
    s_waitcnt lgkmcnt(10)
    v_mfma_f32_32x32x16_bf16 v[80:95], v[36:39], v[208:211], v[80:95]
    ds_read_b64_tr_b16 v[60:61], v11 offset:54016
    ds_read_b64_tr_b16 v[62:63], v11 offset:55040
    s_waitcnt lgkmcnt(10)
    v_mfma_f32_32x32x16_bf16 v[96:111], v[40:43], v[208:211], v[96:111]
    ds_read_b64_tr_b16 v[32:33], v11 offset:57344
    ds_read_b64_tr_b16 v[34:35], v11 offset:58368
    s_waitcnt lgkmcnt(10)
    v_mfma_f32_32x32x16_bf16 v[112:127], v[44:47], v[208:211], v[112:127]
    ds_read_b64_tr_b16 v[36:37], v11 offset:57600
    ds_read_b64_tr_b16 v[38:39], v11 offset:58624
    s_waitcnt lgkmcnt(10)
    v_mfma_f32_32x32x16_bf16 v[64:79], v[48:51], v[212:215], v[64:79]
    ds_read_b64_tr_b16 v[40:41], v11 offset:57856
    ds_read_b64_tr_b16 v[42:43], v11 offset:58880
    s_waitcnt lgkmcnt(10)
    v_mfma_f32_32x32x16_bf16 v[80:95], v[52:55], v[212:215], v[80:95]
    ds_read_b64_tr_b16 v[44:45], v11 offset:58112
    ds_read_b64_tr_b16 v[46:47], v11 offset:59136
    s_waitcnt lgkmcnt(10)
    v_mfma_f32_32x32x16_bf16 v[96:111], v[56:59], v[212:215], v[96:111]
    ds_read_b64_tr_b16 v[48:49], v11 offset:61440
    ds_read_b64_tr_b16 v[50:51], v11 offset:62464
    s_waitcnt lgkmcnt(10)
    v_mfma_f32_32x32x16_bf16 v[112:127], v[60:63], v[212:215], v[112:127]
    ds_read_b64_tr_b16 v[52:53], v11 offset:61696
    ds_read_b64_tr_b16 v[54:55], v11 offset:62720
    s_waitcnt lgkmcnt(10)
    v_mfma_f32_32x32x16_bf16 v[64:79], v[32:35], v[216:219], v[64:79]
    ds_read_b64_tr_b16 v[56:57], v11 offset:61952
    ds_read_b64_tr_b16 v[58:59], v11 offset:62976
    v_add_u32 v30, 65536, v26
    ds_read_b128 v[224:227], v30 offset:0
    v_add_u32 v31, 65536, v27
    ds_read_b128 v[228:231], v31 offset:0
    v_add_u32 v30, 65536, v28
    ds_read_b128 v[232:235], v30 offset:0
    v_add_u32 v31, 65536, v29
    ds_read_b128 v[236:239], v31 offset:0
    s_waitcnt lgkmcnt(14)
    v_mfma_f32_32x32x16_bf16 v[80:95], v[36:39], v[216:219], v[80:95]
    ds_read_b64_tr_b16 v[60:61], v11 offset:62208
    ds_read_b64_tr_b16 v[62:63], v11 offset:63232
    s_waitcnt lgkmcnt(14)
    v_mfma_f32_32x32x16_bf16 v[96:111], v[40:43], v[216:219], v[96:111]
    ds_read_b64_tr_b16 v[32:33], v12 offset:16384
    ds_read_b64_tr_b16 v[34:35], v12 offset:17408
    s_waitcnt lgkmcnt(14)
    v_mfma_f32_32x32x16_bf16 v[112:127], v[44:47], v[216:219], v[112:127]
    ds_read_b64_tr_b16 v[36:37], v12 offset:16640
    ds_read_b64_tr_b16 v[38:39], v12 offset:17664
    s_waitcnt lgkmcnt(14)
    v_mfma_f32_32x32x16_bf16 v[64:79], v[48:51], v[220:223], v[64:79]
    ds_read_b64_tr_b16 v[40:41], v12 offset:16896
    ds_read_b64_tr_b16 v[42:43], v12 offset:17920
    s_waitcnt lgkmcnt(14)
    v_mfma_f32_32x32x16_bf16 v[80:95], v[52:55], v[220:223], v[80:95]
    ds_read_b64_tr_b16 v[44:45], v12 offset:17152
    ds_read_b64_tr_b16 v[46:47], v12 offset:18176
    s_waitcnt lgkmcnt(14)
    v_mfma_f32_32x32x16_bf16 v[96:111], v[56:59], v[220:223], v[96:111]
    ds_read_b64_tr_b16 v[48:49], v12 offset:20480
    ds_read_b64_tr_b16 v[50:51], v12 offset:21504
    s_waitcnt lgkmcnt(10)
    v_mfma_f32_32x32x16_bf16 v[112:127], v[60:63], v[220:223], v[112:127]
    ds_read_b64_tr_b16 v[52:53], v12 offset:20736
    ds_read_b64_tr_b16 v[54:55], v12 offset:21760
    s_barrier
    s_add_u32 m0, s69, 65536
    s_add_u32 s41, s73, 0
    buffer_load_dwordx4 v5, s[12:15], s41 offen offset:0 lds
    s_add_u32 s41, s73, 31744
    buffer_load_dwordx4 v5, s[12:15], s41 offen offset:1024 lds
    s_add_u32 s41, s73, 63488
    buffer_load_dwordx4 v5, s[12:15], s41 offen offset:2048 lds
    s_add_u32 s41, s73, 95232
    buffer_load_dwordx4 v5, s[12:15], s41 offen offset:3072 lds
    s_waitcnt lgkmcnt(10)
    v_mfma_f32_32x32x16_bf16 v[64:79], v[32:35], v[224:227], v[64:79]
    ds_read_b64_tr_b16 v[56:57], v12 offset:20992
    ds_read_b64_tr_b16 v[58:59], v12 offset:22016
    s_waitcnt lgkmcnt(10)
    v_mfma_f32_32x32x16_bf16 v[80:95], v[36:39], v[224:227], v[80:95]
    ds_read_b64_tr_b16 v[60:61], v12 offset:21248
    ds_read_b64_tr_b16 v[62:63], v12 offset:22272
    s_waitcnt lgkmcnt(10)
    v_mfma_f32_32x32x16_bf16 v[96:111], v[40:43], v[224:227], v[96:111]
    ds_read_b64_tr_b16 v[32:33], v12 offset:24576
    ds_read_b64_tr_b16 v[34:35], v12 offset:25600
    s_waitcnt lgkmcnt(10)
    v_mfma_f32_32x32x16_bf16 v[112:127], v[44:47], v[224:227], v[112:127]
    ds_read_b64_tr_b16 v[36:37], v12 offset:24832
    ds_read_b64_tr_b16 v[38:39], v12 offset:25856
    s_waitcnt lgkmcnt(10)
    v_mfma_f32_32x32x16_bf16 v[64:79], v[48:51], v[228:231], v[64:79]
    ds_read_b64_tr_b16 v[40:41], v12 offset:25088
    ds_read_b64_tr_b16 v[42:43], v12 offset:26112
    s_waitcnt lgkmcnt(10)
    v_mfma_f32_32x32x16_bf16 v[80:95], v[52:55], v[228:231], v[80:95]
    ds_read_b64_tr_b16 v[44:45], v12 offset:25344
    ds_read_b64_tr_b16 v[46:47], v12 offset:26368
    s_waitcnt lgkmcnt(10)
    v_mfma_f32_32x32x16_bf16 v[96:111], v[56:59], v[228:231], v[96:111]
    ds_read_b64_tr_b16 v[48:49], v12 offset:28672
    ds_read_b64_tr_b16 v[50:51], v12 offset:29696
    s_waitcnt lgkmcnt(10)
    v_mfma_f32_32x32x16_bf16 v[112:127], v[60:63], v[228:231], v[112:127]
    ds_read_b64_tr_b16 v[52:53], v12 offset:28928
    ds_read_b64_tr_b16 v[54:55], v12 offset:29952
    s_waitcnt lgkmcnt(10)
    v_mfma_f32_32x32x16_bf16 v[64:79], v[32:35], v[232:235], v[64:79]
    ds_read_b64_tr_b16 v[56:57], v12 offset:29184
    ds_read_b64_tr_b16 v[58:59], v12 offset:30208
    ds_read_b128 v[240:243], v26 offset:0
    ds_read_b128 v[244:247], v27 offset:0
    ds_read_b128 v[248:251], v28 offset:0
    ds_read_b128 v[252:255], v29 offset:0
    s_waitcnt lgkmcnt(14)
    v_mfma_f32_32x32x16_bf16 v[80:95], v[36:39], v[232:235], v[80:95]
    ds_read_b64_tr_b16 v[60:61], v12 offset:29440
    ds_read_b64_tr_b16 v[62:63], v12 offset:30464
    s_waitcnt lgkmcnt(14)
    v_mfma_f32_32x32x16_bf16 v[96:111], v[40:43], v[232:235], v[96:111]
    ds_read_b64_tr_b16 v[32:33], v12 offset:49152
    ds_read_b64_tr_b16 v[34:35], v12 offset:50176
    s_waitcnt lgkmcnt(14)
    v_mfma_f32_32x32x16_bf16 v[112:127], v[44:47], v[232:235], v[112:127]
    ds_read_b64_tr_b16 v[36:37], v12 offset:53248
    ds_read_b64_tr_b16 v[38:39], v12 offset:54272
    s_waitcnt lgkmcnt(14)
    v_mfma_f32_32x32x16_bf16 v[64:79], v[48:51], v[236:239], v[64:79]
    ds_read_b64_tr_b16 v[40:41], v12 offset:57344
    ds_read_b64_tr_b16 v[42:43], v12 offset:58368
    s_waitcnt lgkmcnt(14)
    v_mfma_f32_32x32x16_bf16 v[80:95], v[52:55], v[236:239], v[80:95]
    ds_read_b64_tr_b16 v[44:45], v12 offset:61440
    ds_read_b64_tr_b16 v[46:47], v12 offset:62464
    s_waitcnt lgkmcnt(14)
    v_mfma_f32_32x32x16_bf16 v[96:111], v[56:59], v[236:239], v[96:111]
    ds_read_b64_tr_b16 v[48:49], v12 offset:49408
    ds_read_b64_tr_b16 v[50:51], v12 offset:50432
    s_waitcnt lgkmcnt(10)
    v_mfma_f32_32x32x16_bf16 v[112:127], v[60:63], v[236:239], v[112:127]
    ds_read_b64_tr_b16 v[52:53], v12 offset:53504
    ds_read_b64_tr_b16 v[54:55], v12 offset:54528
    s_barrier
    s_add_u32 m0, s69, 81920
    s_add_u32 s41, s73, 524288
    buffer_load_dwordx4 v5, s[12:15], s41 offen offset:0 lds
    s_add_u32 s41, s73, 556032
    buffer_load_dwordx4 v5, s[12:15], s41 offen offset:1024 lds
    s_add_u32 s41, s73, 587776
    buffer_load_dwordx4 v5, s[12:15], s41 offen offset:2048 lds
    s_add_u32 s41, s73, 619520
    buffer_load_dwordx4 v5, s[12:15], s41 offen offset:3072 lds
    s_waitcnt lgkmcnt(10)
    v_mfma_f32_32x32x16_bf16 v[64:79], v[32:35], v[240:243], v[64:79]
    ds_read_b64_tr_b16 v[56:57], v12 offset:57600
    ds_read_b64_tr_b16 v[58:59], v12 offset:58624
    s_cmp_lt_u32 s68, 2
    s_cselect_b32 s93, 6, 0
    s_and_b32 s74, s68, 1
    s_add_u32 s93, s93, s74
    s_lshl_b32 s93, s93, 13
    v_add_u32 v20, s93, v8
    s_waitcnt lgkmcnt(10)
    v_mfma_f32_32x32x16_bf16 v[64:79], v[36:39], v[244:247], v[64:79]
    ds_read_b64_tr_b16 v[60:61], v12 offset:61696
    ds_read_b64_tr_b16 v[62:63], v12 offset:62720
    s_waitcnt lgkmcnt(10)
    v_mfma_f32_32x32x16_bf16 v[64:79], v[40:43], v[248:251], v[64:79]
    ds_read_b64_tr_b16 v[32:33], v12 offset:49664
    ds_read_b64_tr_b16 v[34:35], v12 offset:50688
    s_waitcnt lgkmcnt(10)
    v_mfma_f32_32x32x16_bf16 v[64:79], v[44:47], v[252:255], v[64:79]
    ds_read_b64_tr_b16 v[36:37], v12 offset:53760
    ds_read_b64_tr_b16 v[38:39], v12 offset:54784
    s_waitcnt lgkmcnt(10)
    v_mfma_f32_32x32x16_bf16 v[80:95], v[48:51], v[240:243], v[80:95]
    ds_read_b64_tr_b16 v[40:41], v12 offset:57856
    ds_read_b64_tr_b16 v[42:43], v12 offset:58880
    s_waitcnt lgkmcnt(10)
    v_mfma_f32_32x32x16_bf16 v[80:95], v[52:55], v[244:247], v[80:95]
    ds_read_b64_tr_b16 v[44:45], v12 offset:61952
    ds_read_b64_tr_b16 v[46:47], v12 offset:62976
    s_nop 1
    v_cvt_pk_bf16_f32 v64, v64, v65
    v_cvt_pk_bf16_f32 v65, v66, v67
    v_cvt_pk_bf16_f32 v66, v68, v69
    v_cvt_pk_bf16_f32 v67, v70, v71
    s_waitcnt lgkmcnt(10)
    v_mfma_f32_32x32x16_bf16 v[80:95], v[56:59], v[248:251], v[80:95]
    ds_read_b64_tr_b16 v[48:49], v12 offset:49920
    ds_read_b64_tr_b16 v[50:51], v12 offset:50944
    v_cvt_pk_bf16_f32 v72, v72, v73
    v_cvt_pk_bf16_f32 v73, v74, v75
    v_cvt_pk_bf16_f32 v74, v76, v77
    v_cvt_pk_bf16_f32 v75, v78, v79
    v_permlane32_swap_b32 v64, v66
    s_waitcnt lgkmcnt(10)
    v_mfma_f32_32x32x16_bf16 v[80:95], v[60:63], v[252:255], v[80:95]
    ds_read_b64_tr_b16 v[52:53], v12 offset:54016
    ds_read_b64_tr_b16 v[54:55], v12 offset:55040
    v_permlane32_swap_b32 v65, v67
    v_permlane32_swap_b32 v72, v74
    v_permlane32_swap_b32 v73, v75
    ds_write_b128 v20, v[64:67] offset:0
    ds_write_b128 v20, v[72:75] offset:1024
    s_waitcnt lgkmcnt(12)
    v_mfma_f32_32x32x16_bf16 v[96:111], v[32:35], v[240:243], v[96:111]
    ds_read_b64_tr_b16 v[56:57], v12 offset:58112
    ds_read_b64_tr_b16 v[58:59], v12 offset:59136
    s_waitcnt lgkmcnt(12)
    v_mfma_f32_32x32x16_bf16 v[96:111], v[36:39], v[244:247], v[96:111]
    ds_read_b64_tr_b16 v[60:61], v12 offset:62208
    ds_read_b64_tr_b16 v[62:63], v12 offset:63232
    v_cvt_pk_bf16_f32 v80, v80, v81
    v_cvt_pk_bf16_f32 v81, v82, v83
    v_cvt_pk_bf16_f32 v82, v84, v85
    v_cvt_pk_bf16_f32 v83, v86, v87
    s_waitcnt lgkmcnt(12)
    v_mfma_f32_32x32x16_bf16 v[96:111], v[40:43], v[248:251], v[96:111]
    v_cvt_pk_bf16_f32 v88, v88, v89
    v_cvt_pk_bf16_f32 v89, v90, v91
    v_cvt_pk_bf16_f32 v90, v92, v93
    v_cvt_pk_bf16_f32 v91, v94, v95
    v_permlane32_swap_b32 v80, v82
    s_waitcnt lgkmcnt(10)
    v_mfma_f32_32x32x16_bf16 v[96:111], v[44:47], v[252:255], v[96:111]
    v_permlane32_swap_b32 v81, v83
    v_permlane32_swap_b32 v88, v90
    v_permlane32_swap_b32 v89, v91
    ds_write_b128 v20, v[80:83] offset:2048
    ds_write_b128 v20, v[88:91] offset:3072
    s_waitcnt lgkmcnt(10)
    v_mfma_f32_32x32x16_bf16 v[112:127], v[48:51], v[240:243], v[112:127]
    s_waitcnt lgkmcnt(8)
    v_mfma_f32_32x32x16_bf16 v[112:127], v[52:55], v[244:247], v[112:127]
    s_nop 2
    v_cvt_pk_bf16_f32 v96, v96, v97
    v_cvt_pk_bf16_f32 v97, v98, v99
    v_cvt_pk_bf16_f32 v98, v100, v101
    v_cvt_pk_bf16_f32 v99, v102, v103
    s_waitcnt lgkmcnt(4)
    v_mfma_f32_32x32x16_bf16 v[112:127], v[56:59], v[248:251], v[112:127]
    v_cvt_pk_bf16_f32 v104, v104, v105
    v_cvt_pk_bf16_f32 v105, v106, v107
    v_cvt_pk_bf16_f32 v106, v108, v109
    v_cvt_pk_bf16_f32 v107, v110, v111
    v_permlane32_swap_b32 v96, v98
    s_waitcnt lgkmcnt(2)
    v_mfma_f32_32x32x16_bf16 v[112:127], v[60:63], v[252:255], v[112:127]
    v_permlane32_swap_b32 v97, v99
    v_permlane32_swap_b32 v104, v106
    v_permlane32_swap_b32 v105, v107
    ds_write_b128 v20, v[96:99] offset:4096
    ds_write_b128 v20, v[104:107] offset:5120
    s_nop 6
    v_cvt_pk_bf16_f32 v112, v112, v113
    v_cvt_pk_bf16_f32 v113, v114, v115
    v_cvt_pk_bf16_f32 v114, v116, v117
    v_cvt_pk_bf16_f32 v115, v118, v119
    v_cvt_pk_bf16_f32 v120, v120, v121
    v_cvt_pk_bf16_f32 v121, v122, v123
    v_cvt_pk_bf16_f32 v122, v124, v125
    v_cvt_pk_bf16_f32 v123, v126, v127
    v_permlane32_swap_b32 v112, v114
    v_permlane32_swap_b32 v113, v115
    v_permlane32_swap_b32 v120, v122
    v_permlane32_swap_b32 v121, v123
    ds_write_b128 v20, v[112:115] offset:6144
    ds_write_b128 v20, v[120:123] offset:7168
    s_waitcnt lgkmcnt(0)
    s_barrier
    s_barrier
    v_mov_b32 v16, -1
    v_mov_b32 v17, -1
    v_mov_b32 v18, -1
    v_mov_b32 v19, -1
    s_add_u32 m0, s69, 0
    s_add_u32 s41, s73, 1048576
    buffer_load_dwordx4 v5, s[12:15], s41 offen offset:0 lds
    s_add_u32 s41, s73, 1080320
    buffer_load_dwordx4 v5, s[12:15], s41 offen offset:1024 lds
    s_add_u32 s41, s73, 1112064
    buffer_load_dwordx4 v5, s[12:15], s41 offen offset:2048 lds
    s_add_u32 s41, s73, 1143808
    buffer_load_dwordx4 v5, s[12:15], s41 offen offset:3072 lds
    s_mov_b64 exec, s[46:47]
    buffer_store_dwordx4 v[16:19], v8, s[20:23], s80 offen offset:0 sc1
    s_mov_b64 exec, -1
    s_waitcnt vmcnt(9)
    s_barrier
    s_add_u32 m0, s69, 98304
    s_add_u32 s41, s73, 1572864
    buffer_load_dwordx4 v5, s[12:15], s41 offen offset:0 lds
    s_add_u32 s41, s73, 1604608
    buffer_load_dwordx4 v5, s[12:15], s41 offen offset:1024 lds
    s_add_u32 s41, s73, 1636352
    buffer_load_dwordx4 v5, s[12:15], s41 offen offset:2048 lds
    s_add_u32 s41, s73, 1668096
    buffer_load_dwordx4 v5, s[12:15], s41 offen offset:3072 lds
    ds_read_b64_tr_b16 v[32:33], v12 offset:0
    ds_read_b64_tr_b16 v[34:35], v12 offset:1024
    ds_read_b64_tr_b16 v[36:37], v12 offset:256
    ds_read_b64_tr_b16 v[38:39], v12 offset:1280
    ds_read_b64_tr_b16 v[40:41], v12 offset:512
    ds_read_b64_tr_b16 v[42:43], v12 offset:1536
    ds_read_b64_tr_b16 v[44:45], v12 offset:768
    ds_read_b64_tr_b16 v[46:47], v12 offset:1792
    ds_read_b64_tr_b16 v[48:49], v12 offset:4096
    ds_read_b64_tr_b16 v[50:51], v12 offset:5120
    ds_read_b64_tr_b16 v[52:53], v12 offset:4352
    ds_read_b64_tr_b16 v[54:55], v12 offset:5376
    s_waitcnt lgkmcnt(10)
    v_mfma_f32_32x32x16_bf16 v[64:79], v[32:35], v[128:131], 0
    ds_read_b64_tr_b16 v[56:57], v12 offset:4608
    ds_read_b64_tr_b16 v[58:59], v12 offset:5632
    s_waitcnt lgkmcnt(10)
    v_mfma_f32_32x32x16_bf16 v[80:95], v[36:39], v[128:131], 0
    ds_read_b64_tr_b16 v[60:61], v12 offset:4864
    ds_read_b64_tr_b16 v[62:63], v12 offset:5888
    s_waitcnt lgkmcnt(10)
    v_mfma_f32_32x32x16_bf16 v[96:111], v[40:43], v[128:131], 0
    ds_read_b64_tr_b16 v[32:33], v12 offset:8192
    ds_read_b64_tr_b16 v[34:35], v12 offset:9216
    s_waitcnt lgkmcnt(10)
    v_mfma_f32_32x32x16_bf16 v[112:127], v[44:47], v[128:131], 0
    s_waitcnt lgkmcnt(8)
    v_mfma_f32_32x32x16_bf16 v[64:79], v[48:51], v[132:135], v[64:79]
    s_waitcnt lgkmcnt(6)
    v_mfma_f32_32x32x16_bf16 v[80:95], v[52:55], v[132:135], v[80:95]
    s_waitcnt lgkmcnt(4)
    v_mfma_f32_32x32x16_bf16 v[96:111], v[56:59], v[132:135], v[96:111]
    s_waitcnt lgkmcnt(2)
    v_mfma_f32_32x32x16_bf16 v[112:127], v[60:63], v[132:135], v[112:127]
    s_waitcnt lgkmcnt(0)
    v_mfma_f32_32x32x16_bf16 v[64:79], v[32:35], v[136:139], v[64:79]
    s_mov_b64 exec, s[46:47]
    buffer_store_dwordx4 v[16:19], v8, s[20:23], s80 offen offset:1024 sc1
    s_mov_b64 exec, -1
    s_waitcnt vmcnt(10)
    s_barrier
    ds_read_b64_tr_b16 v[36:37], v12 offset:8448
    ds_read_b64_tr_b16 v[38:39], v12 offset:9472
    ds_read_b64_tr_b16 v[40:41], v12 offset:8704
    ds_read_b64_tr_b16 v[42:43], v12 offset:9728
    ds_read_b64_tr_b16 v[44:45], v12 offset:8960
    ds_read_b64_tr_b16 v[46:47], v12 offset:9984
    ds_read_b64_tr_b16 v[48:49], v12 offset:12288
    ds_read_b64_tr_b16 v[50:51], v12 offset:13312
    ds_read_b64_tr_b16 v[52:53], v12 offset:12544
    ds_read_b64_tr_b16 v[54:55], v12 offset:13568
    ds_read_b64_tr_b16 v[56:57], v12 offset:12800
    ds_read_b64_tr_b16 v[58:59], v12 offset:13824
    s_waitcnt lgkmcnt(10)
    v_mfma_f32_32x32x16_bf16 v[80:95], v[36:39], v[136:139], v[80:95]
    ds_read_b64_tr_b16 v[60:61], v12 offset:13056
    ds_read_b64_tr_b16 v[62:63], v12 offset:14080
    s_waitcnt lgkmcnt(10)
    v_mfma_f32_32x32x16_bf16 v[96:111], v[40:43], v[136:139], v[96:111]
    ds_read_b64_tr_b16 v[32:33], v12 offset:16384
    ds_read_b64_tr_b16 v[34:35], v12 offset:17408
    s_waitcnt lgkmcnt(10)
    v_mfma_f32_32x32x16_bf16 v[112:127], v[44:47], v[136:139], v[112:127]
    ds_read_b64_tr_b16 v[36:37], v12 offset:16640
    ds_read_b64_tr_b16 v[38:39], v12 offset:17664
    s_waitcnt lgkmcnt(10)
    v_mfma_f32_32x32x16_bf16 v[64:79], v[48:51], v[140:143], v[64:79]
    ds_read_b64_tr_b16 v[40:41], v12 offset:16896
    ds_read_b64_tr_b16 v[42:43], v12 offset:17920
    s_waitcnt lgkmcnt(10)
    v_mfma_f32_32x32x16_bf16 v[80:95], v[52:55], v[140:143], v[80:95]
    s_waitcnt lgkmcnt(8)
    v_mfma_f32_32x32x16_bf16 v[96:111], v[56:59], v[140:143], v[96:111]
    s_waitcnt lgkmcnt(6)
    v_mfma_f32_32x32x16_bf16 v[112:127], v[60:63], v[140:143], v[112:127]
    s_waitcnt lgkmcnt(4)
    v_mfma_f32_32x32x16_bf16 v[64:79], v[32:35], v[144:147], v[64:79]
    s_waitcnt lgkmcnt(2)
    v_mfma_f32_32x32x16_bf16 v[80:95], v[36:39], v[144:147], v[80:95]
    s_waitcnt lgkmcnt(0)
    v_mfma_f32_32x32x16_bf16 v[96:111], v[40:43], v[144:147], v[96:111]
    s_mov_b64 exec, s[46:47]
    buffer_store_dwordx4 v[16:19], v8, s[20:23], s80 offen offset:2048 sc1
    s_mov_b64 exec, -1
    s_barrier
    s_add_u32 m0, s69, 16384
    s_add_u32 s41, s73, 2097152
    buffer_load_dwordx4 v5, s[12:15], s41 offen offset:0 lds
    s_add_u32 s41, s73, 2128896
    buffer_load_dwordx4 v5, s[12:15], s41 offen offset:1024 lds
    s_add_u32 s41, s73, 2160640
    buffer_load_dwordx4 v5, s[12:15], s41 offen offset:2048 lds
    s_add_u32 s41, s73, 2192384
    buffer_load_dwordx4 v5, s[12:15], s41 offen offset:3072 lds
    ds_read_b64_tr_b16 v[44:45], v12 offset:17152
    ds_read_b64_tr_b16 v[46:47], v12 offset:18176
    ds_read_b64_tr_b16 v[48:49], v12 offset:20480
    ds_read_b64_tr_b16 v[50:51], v12 offset:21504
    ds_read_b64_tr_b16 v[52:53], v12 offset:20736
    ds_read_b64_tr_b16 v[54:55], v12 offset:21760
    ds_read_b64_tr_b16 v[56:57], v12 offset:20992
    ds_read_b64_tr_b16 v[58:59], v12 offset:22016
    ds_read_b64_tr_b16 v[60:61], v12 offset:21248
    ds_read_b64_tr_b16 v[62:63], v12 offset:22272
    ds_read_b64_tr_b16 v[32:33], v12 offset:24576
    ds_read_b64_tr_b16 v[34:35], v12 offset:25600
    s_waitcnt lgkmcnt(10)
    v_mfma_f32_32x32x16_bf16 v[112:127], v[44:47], v[144:147], v[112:127]
    ds_read_b64_tr_b16 v[36:37], v12 offset:24832
    ds_read_b64_tr_b16 v[38:39], v12 offset:25856
    s_waitcnt lgkmcnt(10)
    v_mfma_f32_32x32x16_bf16 v[64:79], v[48:51], v[148:151], v[64:79]
    ds_read_b64_tr_b16 v[40:41], v12 offset:25088
    ds_read_b64_tr_b16 v[42:43], v12 offset:26112
    s_waitcnt lgkmcnt(10)
    v_mfma_f32_32x32x16_bf16 v[80:95], v[52:55], v[148:151], v[80:95]
    ds_read_b64_tr_b16 v[44:45], v12 offset:25344
    ds_read_b64_tr_b16 v[46:47], v12 offset:26368
    s_waitcnt lgkmcnt(10)
    v_mfma_f32_32x32x16_bf16 v[96:111], v[56:59], v[148:151], v[96:111]
    s_waitcnt lgkmcnt(8)
    v_mfma_f32_32x32x16_bf16 v[112:127], v[60:63], v[148:151], v[112:127]
    s_waitcnt lgkmcnt(6)
    v_mfma_f32_32x32x16_bf16 v[64:79], v[32:35], v[152:155], v[64:79]
    s_waitcnt lgkmcnt(4)
    v_mfma_f32_32x32x16_bf16 v[80:95], v[36:39], v[152:155], v[80:95]
    s_waitcnt lgkmcnt(2)
    v_mfma_f32_32x32x16_bf16 v[96:111], v[40:43], v[152:155], v[96:111]
    s_waitcnt lgkmcnt(0)
    v_mfma_f32_32x32x16_bf16 v[112:127], v[44:47], v[152:155], v[112:127]
    s_mov_b64 exec, s[46:47]
    buffer_store_dwordx4 v[16:19], v8, s[20:23], s80 offen offset:3072 sc1
    s_mov_b64 exec, -1
    s_waitcnt vmcnt(12)
    s_barrier
    s_add_u32 m0, s69, 32768
    s_add_u32 s41, s73, 2621440
    buffer_load_dwordx4 v5, s[12:15], s41 offen offset:0 lds
    s_add_u32 s41, s73, 2653184
    buffer_load_dwordx4 v5, s[12:15], s41 offen offset:1024 lds
    s_add_u32 s41, s73, 2684928
    buffer_load_dwordx4 v5, s[12:15], s41 offen offset:2048 lds
    s_add_u32 s41, s73, 2716672
    buffer_load_dwordx4 v5, s[12:15], s41 offen offset:3072 lds
    ds_read_b64_tr_b16 v[48:49], v12 offset:28672
    ds_read_b64_tr_b16 v[50:51], v12 offset:29696
    ds_read_b64_tr_b16 v[52:53], v12 offset:28928
    ds_read_b64_tr_b16 v[54:55], v12 offset:29952
    ds_read_b64_tr_b16 v[56:57], v12 offset:29184
    ds_read_b64_tr_b16 v[58:59], v12 offset:30208
    ds_read_b64_tr_b16 v[60:61], v12 offset:29440
    ds_read_b64_tr_b16 v[62:63], v12 offset:30464
    ds_read_b64_tr_b16 v[32:33], v11 offset:0
    ds_read_b64_tr_b16 v[34:35], v11 offset:1024
    ds_read_b64_tr_b16 v[36:37], v11 offset:256
    ds_read_b64_tr_b16 v[38:39], v11 offset:1280
    s_waitcnt lgkmcnt(10)
    v_mfma_f32_32x32x16_bf16 v[64:79], v[48:51], v[156:159], v[64:79]
    ds_read_b64_tr_b16 v[40:41], v11 offset:512
    ds_read_b64_tr_b16 v[42:43], v11 offset:1536
    s_waitcnt lgkmcnt(10)
    v_mfma_f32_32x32x16_bf16 v[80:95], v[52:55], v[156:159], v[80:95]
    ds_read_b64_tr_b16 v[44:45], v11 offset:768
    ds_read_b64_tr_b16 v[46:47], v11 offset:1792
    s_waitcnt lgkmcnt(10)
    v_mfma_f32_32x32x16_bf16 v[96:111], v[56:59], v[156:159], v[96:111]
    ds_read_b64_tr_b16 v[48:49], v11 offset:4096
    ds_read_b64_tr_b16 v[50:51], v11 offset:5120
    s_waitcnt lgkmcnt(10)
    v_mfma_f32_32x32x16_bf16 v[112:127], v[60:63], v[156:159], v[112:127]
    ds_read_b64_tr_b16 v[52:53], v11 offset:4352
    ds_read_b64_tr_b16 v[54:55], v11 offset:5376
    s_waitcnt lgkmcnt(10)
    v_mfma_f32_32x32x16_bf16 v[64:79], v[32:35], v[160:163], v[64:79]
    ds_read_b64_tr_b16 v[56:57], v11 offset:4608
    ds_read_b64_tr_b16 v[58:59], v11 offset:5632
    s_waitcnt lgkmcnt(10)
    v_mfma_f32_32x32x16_bf16 v[80:95], v[36:39], v[160:163], v[80:95]
    ds_read_b64_tr_b16 v[60:61], v11 offset:4864
    ds_read_b64_tr_b16 v[62:63], v11 offset:5888
    s_waitcnt lgkmcnt(10)
    v_mfma_f32_32x32x16_bf16 v[96:111], v[40:43], v[160:163], v[96:111]
    ds_read_b64_tr_b16 v[32:33], v11 offset:8192
    ds_read_b64_tr_b16 v[34:35], v11 offset:9216
    s_waitcnt lgkmcnt(10)
    v_mfma_f32_32x32x16_bf16 v[112:127], v[44:47], v[160:163], v[112:127]
    ds_read_b64_tr_b16 v[36:37], v11 offset:8448
    ds_read_b64_tr_b16 v[38:39], v11 offset:9472
    s_waitcnt lgkmcnt(10)
    v_mfma_f32_32x32x16_bf16 v[64:79], v[48:51], v[164:167], v[64:79]
    ds_read_b64_tr_b16 v[40:41], v11 offset:8704
    ds_read_b64_tr_b16 v[42:43], v11 offset:9728
    s_waitcnt lgkmcnt(10)
    v_mfma_f32_32x32x16_bf16 v[80:95], v[52:55], v[164:167], v[80:95]
    s_waitcnt lgkmcnt(8)
    v_mfma_f32_32x32x16_bf16 v[96:111], v[56:59], v[164:167], v[96:111]
    s_waitcnt lgkmcnt(6)
    v_mfma_f32_32x32x16_bf16 v[112:127], v[60:63], v[164:167], v[112:127]
    s_waitcnt lgkmcnt(4)
    v_mfma_f32_32x32x16_bf16 v[64:79], v[32:35], v[168:171], v[64:79]
    s_waitcnt lgkmcnt(2)
    v_mfma_f32_32x32x16_bf16 v[80:95], v[36:39], v[168:171], v[80:95]
    s_waitcnt lgkmcnt(0)
    v_mfma_f32_32x32x16_bf16 v[96:111], v[40:43], v[168:171], v[96:111]
    s_mov_b64 exec, s[46:47]
    s_add_u32 s74, s80, 4096
    buffer_store_dwordx4 v[16:19], v8, s[20:23], s74 offen offset:0 sc1
    s_mov_b64 exec, -1
    s_waitcnt vmcnt(12)
    s_barrier
    ds_read_b64_tr_b16 v[44:45], v11 offset:8960
    ds_read_b64_tr_b16 v[46:47], v11 offset:9984
    ds_read_b64_tr_b16 v[48:49], v11 offset:12288
    ds_read_b64_tr_b16 v[50:51], v11 offset:13312
    ds_read_b64_tr_b16 v[52:53], v11 offset:12544
    ds_read_b64_tr_b16 v[54:55], v11 offset:13568
    ds_read_b64_tr_b16 v[56:57], v11 offset:12800
    ds_read_b64_tr_b16 v[58:59], v11 offset:13824
    ds_read_b64_tr_b16 v[60:61], v11 offset:13056
    ds_read_b64_tr_b16 v[62:63], v11 offset:14080
    ds_read_b64_tr_b16 v[32:33], v12 offset:32768
    ds_read_b64_tr_b16 v[34:35], v12 offset:33792
    s_waitcnt lgkmcnt(10)
    v_mfma_f32_32x32x16_bf16 v[112:127], v[44:47], v[168:171], v[112:127]
    ds_read_b64_tr_b16 v[36:37], v12 offset:33024
    ds_read_b64_tr_b16 v[38:39], v12 offset:34048
    s_waitcnt lgkmcnt(10)
    v_mfma_f32_32x32x16_bf16 v[64:79], v[48:51], v[172:175], v[64:79]
    ds_read_b64_tr_b16 v[40:41], v12 offset:33280
    ds_read_b64_tr_b16 v[42:43], v12 offset:34304
    s_waitcnt lgkmcnt(10)
    v_mfma_f32_32x32x16_bf16 v[80:95], v[52:55], v[172:175], v[80:95]
    ds_read_b64_tr_b16 v[44:45], v12 offset:33536
    ds_read_b64_tr_b16 v[46:47], v12 offset:34560
    s_waitcnt lgkmcnt(10)
    v_mfma_f32_32x32x16_bf16 v[96:111], v[56:59], v[172:175], v[96:111]
    s_waitcnt lgkmcnt(8)
    v_mfma_f32_32x32x16_bf16 v[112:127], v[60:63], v[172:175], v[112:127]
    s_waitcnt lgkmcnt(6)
    v_mfma_f32_32x32x16_bf16 v[64:79], v[32:35], v[176:179], v[64:79]
    s_waitcnt lgkmcnt(4)
    v_mfma_f32_32x32x16_bf16 v[80:95], v[36:39], v[176:179], v[80:95]
    s_mov_b64 exec, s[46:47]
    s_add_u32 s74, s80, 4096
    buffer_store_dwordx4 v[16:19], v8, s[20:23], s74 offen offset:1024 sc1
    s_mov_b64 exec, -1
    s_waitcnt lgkmcnt(2)
    v_mfma_f32_32x32x16_bf16 v[96:111], v[40:43], v[176:179], v[96:111]
    s_waitcnt lgkmcnt(0)
    v_mfma_f32_32x32x16_bf16 v[112:127], v[44:47], v[176:179], v[112:127]
    s_mov_b64 exec, s[46:47]
    s_add_u32 s74, s80, 4096
    buffer_store_dwordx4 v[16:19], v8, s[20:23], s74 offen offset:2048 sc1
    s_mov_b64 exec, -1
    s_barrier
    s_add_u32 m0, s69, 0
    s_add_u32 s41, s73, 3145728
    buffer_load_dwordx4 v5, s[12:15], s41 offen offset:0 lds
    s_add_u32 s41, s73, 3177472
    buffer_load_dwordx4 v5, s[12:15], s41 offen offset:1024 lds
    s_add_u32 s41, s73, 3209216
    buffer_load_dwordx4 v5, s[12:15], s41 offen offset:2048 lds
    s_add_u32 s41, s73, 3240960
    buffer_load_dwordx4 v5, s[12:15], s41 offen offset:3072 lds
    ds_read_b64_tr_b16 v[48:49], v12 offset:36864
    ds_read_b64_tr_b16 v[50:51], v12 offset:37888
    ds_read_b64_tr_b16 v[52:53], v12 offset:37120
    ds_read_b64_tr_b16 v[54:55], v12 offset:38144
    ds_read_b64_tr_b16 v[56:57], v12 offset:37376
    ds_read_b64_tr_b16 v[58:59], v12 offset:38400
    ds_read_b64_tr_b16 v[60:61], v12 offset:37632
    ds_read_b64_tr_b16 v[62:63], v12 offset:38656
    ds_read_b64_tr_b16 v[32:33], v12 offset:40960
    ds_read_b64_tr_b16 v[34:35], v12 offset:41984
    ds_read_b64_tr_b16 v[36:37], v12 offset:41216
    ds_read_b64_tr_b16 v[38:39], v12 offset:42240
    s_waitcnt lgkmcnt(10)
    v_mfma_f32_32x32x16_bf16 v[64:79], v[48:51], v[180:183], v[64:79]
    ds_read_b64_tr_b16 v[40:41], v12 offset:41472
    ds_read_b64_tr_b16 v[42:43], v12 offset:42496
    s_waitcnt lgkmcnt(10)
    v_mfma_f32_32x32x16_bf16 v[80:95], v[52:55], v[180:183], v[80:95]
    ds_read_b64_tr_b16 v[44:45], v12 offset:41728
    ds_read_b64_tr_b16 v[46:47], v12 offset:42752
    s_waitcnt lgkmcnt(10)
    v_mfma_f32_32x32x16_bf16 v[96:111], v[56:59], v[180:183], v[96:111]
    ds_read_b64_tr_b16 v[48:49], v12 offset:45056
    ds_read_b64_tr_b16 v[50:51], v12 offset:46080
    s_waitcnt lgkmcnt(10)
    v_mfma_f32_32x32x16_bf16 v[112:127], v[60:63], v[180:183], v[112:127]
    ds_read_b64_tr_b16 v[52:53], v12 offset:45312
    ds_read_b64_tr_b16 v[54:55], v12 offset:46336
    s_waitcnt lgkmcnt(10)
    v_mfma_f32_32x32x16_bf16 v[64:79], v[32:35], v[184:187], v[64:79]
    s_waitcnt lgkmcnt(8)
    v_mfma_f32_32x32x16_bf16 v[80:95], v[36:39], v[184:187], v[80:95]
    s_waitcnt lgkmcnt(6)
    v_mfma_f32_32x32x16_bf16 v[96:111], v[40:43], v[184:187], v[96:111]
    s_waitcnt lgkmcnt(4)
    v_mfma_f32_32x32x16_bf16 v[112:127], v[44:47], v[184:187], v[112:127]
    s_waitcnt lgkmcnt(2)
    v_mfma_f32_32x32x16_bf16 v[64:79], v[48:51], v[188:191], v[64:79]
    s_waitcnt lgkmcnt(0)
    v_mfma_f32_32x32x16_bf16 v[80:95], v[52:55], v[188:191], v[80:95]
    s_mov_b64 exec, s[46:47]
    s_add_u32 s74, s80, 4096
    buffer_store_dwordx4 v[16:19], v8, s[20:23], s74 offen offset:3072 sc1
    s_mov_b64 exec, -1
    s_waitcnt vmcnt(13)
    s_barrier
    s_add_u32 m0, s69, 114688
    s_add_u32 s41, s73, 3670016
    buffer_load_dwordx4 v5, s[12:15], s41 offen offset:0 lds
    s_add_u32 s41, s73, 3701760
    buffer_load_dwordx4 v5, s[12:15], s41 offen offset:1024 lds
    s_add_u32 s41, s73, 3733504
    buffer_load_dwordx4 v5, s[12:15], s41 offen offset:2048 lds
    s_add_u32 s41, s73, 3765248
    buffer_load_dwordx4 v5, s[12:15], s41 offen offset:3072 lds
    ds_read_b64_tr_b16 v[56:57], v12 offset:45568
    ds_read_b64_tr_b16 v[58:59], v12 offset:46592
    ds_read_b64_tr_b16 v[60:61], v12 offset:45824
    ds_read_b64_tr_b16 v[62:63], v12 offset:46848
    ds_read_b64_tr_b16 v[32:33], v11 offset:16384
    ds_read_b64_tr_b16 v[34:35], v11 offset:17408
    ds_read_b64_tr_b16 v[36:37], v11 offset:16640
    ds_read_b64_tr_b16 v[38:39], v11 offset:17664
    ds_read_b64_tr_b16 v[40:41], v11 offset:16896
    ds_read_b64_tr_b16 v[42:43], v11 offset:17920
    ds_read_b64_tr_b16 v[44:45], v11 offset:17152
    ds_read_b64_tr_b16 v[46:47], v11 offset:18176
    s_waitcnt lgkmcnt(10)
    v_mfma_f32_32x32x16_bf16 v[96:111], v[56:59], v[188:191], v[96:111]
    ds_read_b64_tr_b16 v[48:49], v11 offset:20480
    ds_read_b64_tr_b16 v[50:51], v11 offset:21504
    s_waitcnt lgkmcnt(10)
    v_mfma_f32_32x32x16_bf16 v[112:127], v[60:63], v[188:191], v[112:127]
    ds_read_b64_tr_b16 v[52:53], v11 offset:20736
    ds_read_b64_tr_b16 v[54:55], v11 offset:21760
    s_waitcnt lgkmcnt(10)
    v_mfma_f32_32x32x16_bf16 v[64:79], v[32:35], v[192:195], v[64:79]
    ds_read_b64_tr_b16 v[56:57], v11 offset:20992
    ds_read_b64_tr_b16 v[58:59], v11 offset:22016
    s_waitcnt lgkmcnt(10)
    v_mfma_f32_32x32x16_bf16 v[80:95], v[36:39], v[192:195], v[80:95]
    s_waitcnt lgkmcnt(8)
    v_mfma_f32_32x32x16_bf16 v[96:111], v[40:43], v[192:195], v[96:111]
    s_waitcnt lgkmcnt(6)
    v_mfma_f32_32x32x16_bf16 v[112:127], v[44:47], v[192:195], v[112:127]
    s_waitcnt lgkmcnt(4)
    v_mfma_f32_32x32x16_bf16 v[64:79], v[48:51], v[196:199], v[64:79]
    s_waitcnt lgkmcnt(2)
    v_mfma_f32_32x32x16_bf16 v[80:95], v[52:55], v[196:199], v[80:95]
    s_waitcnt lgkmcnt(0)
    v_mfma_f32_32x32x16_bf16 v[96:111], v[56:59], v[196:199], v[96:111]
    s_mov_b64 exec, s[46:47]
    buffer_store_dwordx4 v[16:19], v8, s[20:23], s89 offen offset:0 sc1
    s_mov_b64 exec, -1
    s_waitcnt vmcnt(13)
    s_barrier
    ds_read_b64_tr_b16 v[60:61], v11 offset:21248
    ds_read_b64_tr_b16 v[62:63], v11 offset:22272
    ds_read_b64_tr_b16 v[32:33], v11 offset:24576
    ds_read_b64_tr_b16 v[34:35], v11 offset:25600
    ds_read_b64_tr_b16 v[36:37], v11 offset:24832
    ds_read_b64_tr_b16 v[38:39], v11 offset:25856
    ds_read_b64_tr_b16 v[40:41], v11 offset:25088
    ds_read_b64_tr_b16 v[42:43], v11 offset:26112
    ds_read_b64_tr_b16 v[44:45], v11 offset:25344
    ds_read_b64_tr_b16 v[46:47], v11 offset:26368
    ds_read_b64_tr_b16 v[48:49], v11 offset:28672
    ds_read_b64_tr_b16 v[50:51], v11 offset:29696
    s_waitcnt lgkmcnt(10)
    v_mfma_f32_32x32x16_bf16 v[112:127], v[60:63], v[196:199], v[112:127]
    ds_read_b64_tr_b16 v[52:53], v11 offset:28928
    ds_read_b64_tr_b16 v[54:55], v11 offset:29952
    s_waitcnt lgkmcnt(10)
    v_mfma_f32_32x32x16_bf16 v[64:79], v[32:35], v[200:203], v[64:79]
    ds_read_b64_tr_b16 v[56:57], v11 offset:29184
    ds_read_b64_tr_b16 v[58:59], v11 offset:30208
    s_waitcnt lgkmcnt(10)
    v_mfma_f32_32x32x16_bf16 v[80:95], v[36:39], v[200:203], v[80:95]
    ds_read_b64_tr_b16 v[60:61], v11 offset:29440
    ds_read_b64_tr_b16 v[62:63], v11 offset:30464
    s_waitcnt lgkmcnt(10)
    v_mfma_f32_32x32x16_bf16 v[96:111], v[40:43], v[200:203], v[96:111]
    ds_read_b64_tr_b16 v[32:33], v11 offset:32768
    ds_read_b64_tr_b16 v[34:35], v11 offset:33792
    s_waitcnt lgkmcnt(10)
    v_mfma_f32_32x32x16_bf16 v[112:127], v[44:47], v[200:203], v[112:127]
    ds_read_b64_tr_b16 v[36:37], v11 offset:33024
    ds_read_b64_tr_b16 v[38:39], v11 offset:34048
    s_waitcnt lgkmcnt(10)
    v_mfma_f32_32x32x16_bf16 v[64:79], v[48:51], v[204:207], v[64:79]
    ds_read_b64_tr_b16 v[40:41], v11 offset:33280
    ds_read_b64_tr_b16 v[42:43], v11 offset:34304
    s_waitcnt lgkmcnt(10)
    v_mfma_f32_32x32x16_bf16 v[80:95], v[52:55], v[204:207], v[80:95]
    ds_read_b64_tr_b16 v[44:45], v11 offset:33536
    ds_read_b64_tr_b16 v[46:47], v11 offset:34560
    s_waitcnt lgkmcnt(10)
    v_mfma_f32_32x32x16_bf16 v[96:111], v[56:59], v[204:207], v[96:111]
    ds_read_b64_tr_b16 v[48:49], v11 offset:36864
    ds_read_b64_tr_b16 v[50:51], v11 offset:37888
    s_waitcnt lgkmcnt(10)
    v_mfma_f32_32x32x16_bf16 v[112:127], v[60:63], v[204:207], v[112:127]
    s_waitcnt lgkmcnt(8)
    v_mfma_f32_32x32x16_bf16 v[64:79], v[32:35], v[208:211], v[64:79]
    s_waitcnt lgkmcnt(6)
    v_mfma_f32_32x32x16_bf16 v[80:95], v[36:39], v[208:211], v[80:95]
    s_waitcnt lgkmcnt(4)
    v_mfma_f32_32x32x16_bf16 v[96:111], v[40:43], v[208:211], v[96:111]
    s_waitcnt lgkmcnt(2)
    v_mfma_f32_32x32x16_bf16 v[112:127], v[44:47], v[208:211], v[112:127]
    s_waitcnt lgkmcnt(0)
    v_mfma_f32_32x32x16_bf16 v[64:79], v[48:51], v[212:215], v[64:79]
    s_mov_b64 exec, s[46:47]
    buffer_store_dwordx4 v[16:19], v8, s[20:23], s89 offen offset:1024 sc1
    s_mov_b64 exec, -1
    s_barrier
    ds_read_b64_tr_b16 v[52:53], v11 offset:37120
    ds_read_b64_tr_b16 v[54:55], v11 offset:38144
    ds_read_b64_tr_b16 v[56:57], v11 offset:37376
    ds_read_b64_tr_b16 v[58:59], v11 offset:38400
    ds_read_b64_tr_b16 v[60:61], v11 offset:37632
    ds_read_b64_tr_b16 v[62:63], v11 offset:38656
    ds_read_b64_tr_b16 v[32:33], v11 offset:40960
    ds_read_b64_tr_b16 v[34:35], v11 offset:41984
    ds_read_b64_tr_b16 v[36:37], v11 offset:41216
    ds_read_b64_tr_b16 v[38:39], v11 offset:42240
    ds_read_b64_tr_b16 v[40:41], v11 offset:41472
    ds_read_b64_tr_b16 v[42:43], v11 offset:42496
    s_waitcnt lgkmcnt(10)
    v_mfma_f32_32x32x16_bf16 v[80:95], v[52:55], v[212:215], v[80:95]
    ds_read_b64_tr_b16 v[44:45], v11 offset:41728
    ds_read_b64_tr_b16 v[46:47], v11 offset:42752
    s_waitcnt lgkmcnt(10)
    v_mfma_f32_32x32x16_bf16 v[96:111], v[56:59], v[212:215], v[96:111]
    ds_read_b64_tr_b16 v[48:49], v11 offset:45056
    ds_read_b64_tr_b16 v[50:51], v11 offset:46080
    s_waitcnt lgkmcnt(10)
    v_mfma_f32_32x32x16_bf16 v[112:127], v[60:63], v[212:215], v[112:127]
    ds_read_b64_tr_b16 v[52:53], v11 offset:45312
    ds_read_b64_tr_b16 v[54:55], v11 offset:46336
    s_waitcnt lgkmcnt(10)
    v_mfma_f32_32x32x16_bf16 v[64:79], v[32:35], v[216:219], v[64:79]
    ds_read_b64_tr_b16 v[56:57], v11 offset:45568
    ds_read_b64_tr_b16 v[58:59], v11 offset:46592
    s_waitcnt lgkmcnt(10)
    v_mfma_f32_32x32x16_bf16 v[80:95], v[36:39], v[216:219], v[80:95]
    s_waitcnt lgkmcnt(8)
    v_mfma_f32_32x32x16_bf16 v[96:111], v[40:43], v[216:219], v[96:111]
    s_waitcnt lgkmcnt(6)
    v_mfma_f32_32x32x16_bf16 v[112:127], v[44:47], v[216:219], v[112:127]
    s_waitcnt lgkmcnt(4)
    v_mfma_f32_32x32x16_bf16 v[64:79], v[48:51], v[220:223], v[64:79]
    s_waitcnt lgkmcnt(2)
    v_mfma_f32_32x32x16_bf16 v[80:95], v[52:55], v[220:223], v[80:95]
    s_waitcnt lgkmcnt(0)
    v_mfma_f32_32x32x16_bf16 v[96:111], v[56:59], v[220:223], v[96:111]
    s_mov_b64 exec, s[46:47]
    buffer_store_dwordx4 v[16:19], v8, s[20:23], s90 offen offset:0 sc1
    s_mov_b64 exec, -1
    s_waitcnt vmcnt(8)
    s_barrier
    ds_read_b64_tr_b16 v[60:61], v11 offset:45824
    ds_read_b64_tr_b16 v[62:63], v11 offset:46848
    ds_read_b64_tr_b16 v[32:33], v11 offset:0
    ds_read_b64_tr_b16 v[34:35], v11 offset:1024
    ds_read_b64_tr_b16 v[36:37], v11 offset:256
    ds_read_b64_tr_b16 v[38:39], v11 offset:1280
    ds_read_b64_tr_b16 v[40:41], v11 offset:512
    ds_read_b64_tr_b16 v[42:43], v11 offset:1536
    ds_read_b64_tr_b16 v[44:45], v11 offset:768
    ds_read_b64_tr_b16 v[46:47], v11 offset:1792
    ds_read_b64_tr_b16 v[48:49], v11 offset:4096
    ds_read_b64_tr_b16 v[50:51], v11 offset:5120
    s_waitcnt lgkmcnt(10)
    v_mfma_f32_32x32x16_bf16 v[112:127], v[60:63], v[220:223], v[112:127]
    ds_read_b64_tr_b16 v[52:53], v11 offset:4352
    ds_read_b64_tr_b16 v[54:55], v11 offset:5376
    s_waitcnt lgkmcnt(10)
    v_mfma_f32_32x32x16_bf16 v[64:79], v[32:35], v[224:227], v[64:79]
    ds_read_b64_tr_b16 v[56:57], v11 offset:4608
    ds_read_b64_tr_b16 v[58:59], v11 offset:5632
    s_waitcnt lgkmcnt(10)
    v_mfma_f32_32x32x16_bf16 v[80:95], v[36:39], v[224:227], v[80:95]
    ds_read_b64_tr_b16 v[60:61], v11 offset:4864
    ds_read_b64_tr_b16 v[62:63], v11 offset:5888
    s_waitcnt lgkmcnt(10)
    v_mfma_f32_32x32x16_bf16 v[96:111], v[40:43], v[224:227], v[96:111]
    s_waitcnt lgkmcnt(8)
    v_mfma_f32_32x32x16_bf16 v[112:127], v[44:47], v[224:227], v[112:127]
    s_waitcnt lgkmcnt(6)
    v_mfma_f32_32x32x16_bf16 v[64:79], v[48:51], v[228:231], v[64:79]
    s_waitcnt lgkmcnt(4)
    v_mfma_f32_32x32x16_bf16 v[80:95], v[52:55], v[228:231], v[80:95]
    s_waitcnt lgkmcnt(2)
    v_mfma_f32_32x32x16_bf16 v[96:111], v[56:59], v[228:231], v[96:111]
    s_waitcnt lgkmcnt(0)
    v_mfma_f32_32x32x16_bf16 v[112:127], v[60:63], v[228:231], v[112:127]
    s_mov_b64 exec, s[46:47]
    buffer_store_dwordx4 v[16:19], v8, s[20:23], s90 offen offset:1024 sc1
    s_mov_b64 exec, -1
    s_waitcnt vmcnt(4)
    s_barrier
    ds_read_b64_tr_b16 v[32:33], v11 offset:8192
    ds_read_b64_tr_b16 v[34:35], v11 offset:9216
    ds_read_b64_tr_b16 v[36:37], v11 offset:8448
    ds_read_b64_tr_b16 v[38:39], v11 offset:9472
    ds_read_b64_tr_b16 v[40:41], v11 offset:8704
    ds_read_b64_tr_b16 v[42:43], v11 offset:9728
    ds_read_b64_tr_b16 v[44:45], v11 offset:8960
    ds_read_b64_tr_b16 v[46:47], v11 offset:9984
    ds_read_b64_tr_b16 v[48:49], v11 offset:12288
    ds_read_b64_tr_b16 v[50:51], v11 offset:13312
    ds_read_b64_tr_b16 v[52:53], v11 offset:12544
    ds_read_b64_tr_b16 v[54:55], v11 offset:13568
    s_waitcnt lgkmcnt(10)
    v_mfma_f32_32x32x16_bf16 v[64:79], v[32:35], v[232:235], v[64:79]
    ds_read_b64_tr_b16 v[56:57], v11 offset:12800
    ds_read_b64_tr_b16 v[58:59], v11 offset:13824
    s_waitcnt lgkmcnt(10)
    v_mfma_f32_32x32x16_bf16 v[80:95], v[36:39], v[232:235], v[80:95]
    ds_read_b64_tr_b16 v[60:61], v11 offset:13056
    ds_read_b64_tr_b16 v[62:63], v11 offset:14080
    s_waitcnt lgkmcnt(10)
    v_mfma_f32_32x32x16_bf16 v[96:111], v[40:43], v[232:235], v[96:111]
    ds_read_b64_tr_b16 v[32:33], v12 offset:49152
    ds_read_b64_tr_b16 v[34:35], v12 offset:50176
    s_waitcnt lgkmcnt(10)
    v_mfma_f32_32x32x16_bf16 v[112:127], v[44:47], v[232:235], v[112:127]
    ds_read_b64_tr_b16 v[36:37], v12 offset:53248
    ds_read_b64_tr_b16 v[38:39], v12 offset:54272
    s_waitcnt lgkmcnt(10)
    v_mfma_f32_32x32x16_bf16 v[64:79], v[48:51], v[236:239], v[64:79]
    s_waitcnt lgkmcnt(8)
    v_mfma_f32_32x32x16_bf16 v[80:95], v[52:55], v[236:239], v[80:95]
    s_waitcnt lgkmcnt(6)
    v_mfma_f32_32x32x16_bf16 v[96:111], v[56:59], v[236:239], v[96:111]
    s_waitcnt lgkmcnt(4)
    v_mfma_f32_32x32x16_bf16 v[112:127], v[60:63], v[236:239], v[112:127]
    s_mov_b64 exec, s[46:47]
    buffer_store_dwordx4 v[16:19], v8, s[20:23], s91 offen offset:0 sc1
    s_mov_b64 exec, -1
    s_waitcnt lgkmcnt(2)
    v_mfma_f32_32x32x16_bf16 v[64:79], v[32:35], v[240:243], v[64:79]
    s_waitcnt lgkmcnt(0)
    v_mfma_f32_32x32x16_bf16 v[64:79], v[36:39], v[244:247], v[64:79]
    s_mov_b64 exec, s[46:47]
    buffer_store_dwordx4 v[16:19], v8, s[20:23], s91 offen offset:1024 sc1
    s_mov_b64 exec, -1
    s_barrier
    ds_read_b64_tr_b16 v[40:41], v12 offset:57344
    ds_read_b64_tr_b16 v[42:43], v12 offset:58368
    ds_read_b64_tr_b16 v[44:45], v12 offset:61440
    ds_read_b64_tr_b16 v[46:47], v12 offset:62464
    ds_read_b64_tr_b16 v[48:49], v12 offset:49408
    ds_read_b64_tr_b16 v[50:51], v12 offset:50432
    ds_read_b64_tr_b16 v[52:53], v12 offset:53504
    ds_read_b64_tr_b16 v[54:55], v12 offset:54528
    ds_read_b64_tr_b16 v[56:57], v12 offset:57600
    ds_read_b64_tr_b16 v[58:59], v12 offset:58624
    ds_read_b64_tr_b16 v[60:61], v12 offset:61696
    ds_read_b64_tr_b16 v[62:63], v12 offset:62720
    s_waitcnt lgkmcnt(10)
    v_mfma_f32_32x32x16_bf16 v[64:79], v[40:43], v[248:251], v[64:79]
    ds_read_b64_tr_b16 v[32:33], v12 offset:49664
    ds_read_b64_tr_b16 v[34:35], v12 offset:50688
    s_waitcnt lgkmcnt(10)
    v_mfma_f32_32x32x16_bf16 v[64:79], v[44:47], v[252:255], v[64:79]
    ds_read_b64_tr_b16 v[36:37], v12 offset:53760
    ds_read_b64_tr_b16 v[38:39], v12 offset:54784
    s_waitcnt lgkmcnt(10)
    v_mfma_f32_32x32x16_bf16 v[80:95], v[48:51], v[240:243], v[80:95]
    ds_read_b64_tr_b16 v[40:41], v12 offset:57856
    ds_read_b64_tr_b16 v[42:43], v12 offset:58880
    s_waitcnt lgkmcnt(10)
    v_mfma_f32_32x32x16_bf16 v[80:95], v[52:55], v[244:247], v[80:95]
    ds_read_b64_tr_b16 v[44:45], v12 offset:61952
    ds_read_b64_tr_b16 v[46:47], v12 offset:62976
    s_nop 1
    v_cvt_pk_bf16_f32 v64, v64, v65
    v_cvt_pk_bf16_f32 v65, v66, v67
    v_cvt_pk_bf16_f32 v66, v68, v69
    v_cvt_pk_bf16_f32 v67, v70, v71
    s_waitcnt lgkmcnt(10)
    v_mfma_f32_32x32x16_bf16 v[80:95], v[56:59], v[248:251], v[80:95]
    ds_read_b64_tr_b16 v[48:49], v12 offset:49920
    ds_read_b64_tr_b16 v[50:51], v12 offset:50944
    v_cvt_pk_bf16_f32 v72, v72, v73
    v_cvt_pk_bf16_f32 v73, v74, v75
    v_cvt_pk_bf16_f32 v74, v76, v77
    v_cvt_pk_bf16_f32 v75, v78, v79
    s_waitcnt lgkmcnt(10)
    v_mfma_f32_32x32x16_bf16 v[80:95], v[60:63], v[252:255], v[80:95]
    ds_read_b64_tr_b16 v[52:53], v12 offset:54016
    ds_read_b64_tr_b16 v[54:55], v12 offset:55040
    v_permlane32_swap_b32 v64, v66
    v_permlane32_swap_b32 v65, v67
    v_permlane32_swap_b32 v72, v74
    v_permlane32_swap_b32 v73, v75
    s_waitcnt lgkmcnt(10)
    v_mfma_f32_32x32x16_bf16 v[96:111], v[32:35], v[240:243], v[96:111]
    ds_read_b64_tr_b16 v[56:57], v12 offset:58112
    ds_read_b64_tr_b16 v[58:59], v12 offset:59136
    s_waitcnt lgkmcnt(10)
    v_mfma_f32_32x32x16_bf16 v[96:111], v[36:39], v[244:247], v[96:111]
    ds_read_b64_tr_b16 v[60:61], v12 offset:62208
    ds_read_b64_tr_b16 v[62:63], v12 offset:63232
    v_cvt_pk_bf16_f32 v80, v80, v81
    v_cvt_pk_bf16_f32 v81, v82, v83
    v_cvt_pk_bf16_f32 v82, v84, v85
    v_cvt_pk_bf16_f32 v83, v86, v87
    s_waitcnt lgkmcnt(10)
    v_mfma_f32_32x32x16_bf16 v[96:111], v[40:43], v[248:251], v[96:111]
    v_cvt_pk_bf16_f32 v88, v88, v89
    v_cvt_pk_bf16_f32 v89, v90, v91
    v_cvt_pk_bf16_f32 v90, v92, v93
    v_cvt_pk_bf16_f32 v91, v94, v95
    s_waitcnt lgkmcnt(8)
    v_mfma_f32_32x32x16_bf16 v[96:111], v[44:47], v[252:255], v[96:111]
    v_permlane32_swap_b32 v80, v82
    v_permlane32_swap_b32 v81, v83
    v_permlane32_swap_b32 v88, v90
    v_permlane32_swap_b32 v89, v91
    s_waitcnt lgkmcnt(6)
    v_mfma_f32_32x32x16_bf16 v[112:127], v[48:51], v[240:243], v[112:127]
    s_waitcnt lgkmcnt(4)
    v_mfma_f32_32x32x16_bf16 v[112:127], v[52:55], v[244:247], v[112:127]
    s_nop 3
    v_cvt_pk_bf16_f32 v96, v96, v97
    v_cvt_pk_bf16_f32 v97, v98, v99
    v_cvt_pk_bf16_f32 v98, v100, v101
    v_cvt_pk_bf16_f32 v99, v102, v103
    s_waitcnt lgkmcnt(2)
    v_mfma_f32_32x32x16_bf16 v[112:127], v[56:59], v[248:251], v[112:127]
    v_cvt_pk_bf16_f32 v104, v104, v105
    v_cvt_pk_bf16_f32 v105, v106, v107
    v_cvt_pk_bf16_f32 v106, v108, v109
    v_cvt_pk_bf16_f32 v107, v110, v111
    s_waitcnt lgkmcnt(0)
    v_mfma_f32_32x32x16_bf16 v[112:127], v[60:63], v[252:255], v[112:127]
    v_permlane32_swap_b32 v96, v98
    v_permlane32_swap_b32 v97, v99
    v_permlane32_swap_b32 v104, v106
    v_permlane32_swap_b32 v105, v107
    s_nop 7
    v_cvt_pk_bf16_f32 v112, v112, v113
    v_cvt_pk_bf16_f32 v113, v114, v115
    v_cvt_pk_bf16_f32 v114, v116, v117
    v_cvt_pk_bf16_f32 v115, v118, v119
    v_cvt_pk_bf16_f32 v120, v120, v121
    v_cvt_pk_bf16_f32 v121, v122, v123
    v_cvt_pk_bf16_f32 v122, v124, v125
    v_cvt_pk_bf16_f32 v123, v126, v127
    v_permlane32_swap_b32 v112, v114
    v_permlane32_swap_b32 v113, v115
    v_permlane32_swap_b32 v120, v122
    v_permlane32_swap_b32 v121, v123
    s_barrier
    s_add_u32 m0, s69, 114688
    s_add_u32 s41, s85, 0
    buffer_load_dwordx4 v6, s[24:27], s41 offen offset:0 lds
    s_add_u32 s41, s85, 3072
    buffer_load_dwordx4 v6, s[24:27], s41 offen offset:1024 lds
    s_add_u32 s41, s85, 6144
    buffer_load_dwordx4 v6, s[24:27], s41 offen offset:2048 lds
    s_add_u32 s41, s85, 9216
    buffer_load_dwordx4 v6, s[24:27], s41 offen offset:3072 lds
    s_cmp_lt_u32 s68, 2
    s_cselect_b32 s93, 0, 8
    s_and_b32 s74, s68, 1
    s_add_u32 s93, s93, s74
    s_lshl_b32 s93, s93, 13
    v_add_u32 v20, s93, v8
    ds_write_b128 v20, v[64:67] offset:0
    ds_write_b128 v20, v[72:75] offset:1024
    ds_write_b128 v20, v[80:83] offset:2048
    ds_write_b128 v20, v[88:91] offset:3072
    ds_write_b128 v20, v[96:99] offset:4096
    ds_write_b128 v20, v[104:107] offset:5120
    ds_write_b128 v20, v[112:115] offset:6144
    ds_write_b128 v20, v[120:123] offset:7168
    s_waitcnt lgkmcnt(0)
    s_barrier
    s_barrier
    s_cmp_lt_u32 s68, 2
    s_cselect_b32 s93, 12, 2
    s_and_b32 s74, s68, 1
    s_add_u32 s93, s93, s74
    s_lshl_b32 s93, s93, 13
    v_add_u32 v20, s93, v8
    ds_read_b128 v[128:131], v20 offset:0
    ds_read_b128 v[132:135], v20 offset:1024
    ds_read_b128 v[136:139], v20 offset:2048
    ds_read_b128 v[140:143], v20 offset:3072
    ds_read_b128 v[144:147], v20 offset:4096
    ds_read_b128 v[148:151], v20 offset:5120
    ds_read_b128 v[152:155], v20 offset:6144
    ds_read_b128 v[156:159], v20 offset:7168
    s_add_u32 s76, s79, 4096
    s_mov_b64 exec, s[46:47]
    s_waitcnt lgkmcnt(7)
    buffer_store_dwordx4 v[128:131], v8, s[20:23], s79 offen offset:0 sc1
    s_waitcnt lgkmcnt(6)
    buffer_store_dwordx4 v[132:135], v8, s[20:23], s79 offen offset:1024 sc1
    s_waitcnt lgkmcnt(5)
    buffer_store_dwordx4 v[136:139], v8, s[20:23], s79 offen offset:2048 sc1
    s_waitcnt lgkmcnt(4)
    buffer_store_dwordx4 v[140:143], v8, s[20:23], s79 offen offset:3072 sc1
    s_waitcnt lgkmcnt(3)
    buffer_store_dwordx4 v[144:147], v8, s[20:23], s76 offen offset:0 sc1
    s_waitcnt lgkmcnt(2)
    buffer_store_dwordx4 v[148:151], v8, s[20:23], s76 offen offset:1024 sc1
    s_waitcnt lgkmcnt(1)
    buffer_store_dwordx4 v[152:155], v8, s[20:23], s76 offen offset:2048 sc1
    s_waitcnt lgkmcnt(0)
    buffer_store_dwordx4 v[156:159], v8, s[20:23], s76 offen offset:3072 sc1
    s_mov_b64 exec, -1
    s_barrier
    s_waitcnt vmcnt(0)
    s_barrier
    s_cmp_lg_u32 s68, 0
    s_cbranch_scc1 g_noflag
    s_mov_b64 exec, 1
    v_mov_b32 v9, s96
    buffer_atomic_or v9, off, s[32:35], s97 sc1
    s_mov_b64 exec, -1
g_noflag:
    s_nop 7
    s_nop 3
    s_add_u32 m0, s69, 32768
    s_add_u32 s41, s85, 65536
    buffer_load_dwordx4 v6, s[24:27], s41 offen offset:0 lds
    s_add_u32 s41, s85, 68608
    buffer_load_dwordx4 v6, s[24:27], s41 offen offset:1024 lds
    s_add_u32 s41, s85, 71680
    buffer_load_dwordx4 v6, s[24:27], s41 offen offset:2048 lds
    s_add_u32 s41, s85, 74752
    buffer_load_dwordx4 v6, s[24:27], s41 offen offset:3072 lds
    ds_read_b64_tr_b16 v[32:33], v12 offset:49152
    ds_read_b64_tr_b16 v[34:35], v12 offset:50176
    ds_read_b64_tr_b16 v[36:37], v12 offset:49408
    ds_read_b64_tr_b16 v[38:39], v12 offset:50432
    ds_read_b64_tr_b16 v[40:41], v12 offset:49664
    ds_read_b64_tr_b16 v[42:43], v12 offset:50688
    s_waitcnt lgkmcnt(4)
    v_mfma_f32_32x32x16_bf16 v[64:79], v[32:35], v[128:131], 0
    s_waitcnt lgkmcnt(2)
    v_mfma_f32_32x32x16_bf16 v[80:95], v[36:39], v[128:131], 0
    s_waitcnt lgkmcnt(0)
    v_mfma_f32_32x32x16_bf16 v[96:111], v[40:43], v[128:131], 0
    s_barrier
    ds_read_b64_tr_b16 v[44:45], v12 offset:49920
    ds_read_b64_tr_b16 v[46:47], v12 offset:50944
    ds_read_b64_tr_b16 v[48:49], v12 offset:53248
    ds_read_b64_tr_b16 v[50:51], v12 offset:54272
    ds_read_b64_tr_b16 v[52:53], v12 offset:53504
    ds_read_b64_tr_b16 v[54:55], v12 offset:54528
    s_waitcnt lgkmcnt(4)
    v_mfma_f32_32x32x16_bf16 v[112:127], v[44:47], v[128:131], 0
    s_waitcnt lgkmcnt(2)
    v_mfma_f32_32x32x16_bf16 v[64:79], v[48:51], v[132:135], v[64:79]
    s_waitcnt lgkmcnt(0)
    v_mfma_f32_32x32x16_bf16 v[80:95], v[52:55], v[132:135], v[80:95]
    s_barrier
    ds_read_b64_tr_b16 v[56:57], v12 offset:53760
    ds_read_b64_tr_b16 v[58:59], v12 offset:54784
    ds_read_b64_tr_b16 v[60:61], v12 offset:54016
    ds_read_b64_tr_b16 v[62:63], v12 offset:55040
    ds_read_b64_tr_b16 v[32:33], v12 offset:57344
    ds_read_b64_tr_b16 v[34:35], v12 offset:58368
    ds_read_b64_tr_b16 v[36:37], v12 offset:57600
    ds_read_b64_tr_b16 v[38:39], v12 offset:58624
    s_waitcnt lgkmcnt(6)
    v_mfma_f32_32x32x16_bf16 v[96:111], v[56:59], v[132:135], v[96:111]
    s_waitcnt lgkmcnt(4)
    v_mfma_f32_32x32x16_bf16 v[112:127], v[60:63], v[132:135], v[112:127]
    s_waitcnt lgkmcnt(2)
    v_mfma_f32_32x32x16_bf16 v[64:79], v[32:35], v[136:139], v[64:79]
    s_waitcnt lgkmcnt(0)
    v_mfma_f32_32x32x16_bf16 v[80:95], v[36:39], v[136:139], v[80:95]
    s_barrier
    ds_read_b64_tr_b16 v[40:41], v12 offset:57856
    ds_read_b64_tr_b16 v[42:43], v12 offset:58880
    ds_read_b64_tr_b16 v[44:45], v12 offset:58112
    ds_read_b64_tr_b16 v[46:47], v12 offset:59136
    ds_read_b64_tr_b16 v[48:49], v12 offset:61440
    ds_read_b64_tr_b16 v[50:51], v12 offset:62464
    ds_read_b64_tr_b16 v[52:53], v12 offset:61696
    ds_read_b64_tr_b16 v[54:55], v12 offset:62720
    s_waitcnt lgkmcnt(6)
    v_mfma_f32_32x32x16_bf16 v[96:111], v[40:43], v[136:139], v[96:111]
    s_waitcnt lgkmcnt(4)
    v_mfma_f32_32x32x16_bf16 v[112:127], v[44:47], v[136:139], v[112:127]
    s_waitcnt lgkmcnt(2)
    v_mfma_f32_32x32x16_bf16 v[64:79], v[48:51], v[140:143], v[64:79]
    s_waitcnt lgkmcnt(0)
    v_mfma_f32_32x32x16_bf16 v[80:95], v[52:55], v[140:143], v[80:95]
    s_waitcnt vmcnt(0)
    s_barrier
    ds_read_b64_tr_b16 v[56:57], v12 offset:61952
    ds_read_b64_tr_b16 v[58:59], v12 offset:62976
    ds_read_b64_tr_b16 v[60:61], v12 offset:62208
    ds_read_b64_tr_b16 v[62:63], v12 offset:63232
    ds_read_b64_tr_b16 v[32:33], v11 offset:32768
    ds_read_b64_tr_b16 v[34:35], v11 offset:33792
    ds_read_b64_tr_b16 v[36:37], v11 offset:33024
    ds_read_b64_tr_b16 v[38:39], v11 offset:34048
    s_waitcnt lgkmcnt(6)
    v_mfma_f32_32x32x16_bf16 v[96:111], v[56:59], v[140:143], v[96:111]
    s_waitcnt lgkmcnt(4)
    v_mfma_f32_32x32x16_bf16 v[112:127], v[60:63], v[140:143], v[112:127]
    s_waitcnt lgkmcnt(2)
    v_mfma_f32_32x32x16_bf16 v[64:79], v[32:35], v[144:147], v[64:79]
    s_waitcnt lgkmcnt(0)
    v_mfma_f32_32x32x16_bf16 v[80:95], v[36:39], v[144:147], v[80:95]
    s_barrier
    s_add_u32 m0, s69, 49152
    s_add_u32 s41, s86, 0
    buffer_load_dwordx4 v6, s[24:27], s41 offen offset:0 lds
    s_add_u32 s41, s86, 3072
    buffer_load_dwordx4 v6, s[24:27], s41 offen offset:1024 lds
    s_add_u32 s41, s86, 6144
    buffer_load_dwordx4 v6, s[24:27], s41 offen offset:2048 lds
    s_add_u32 s41, s86, 9216
    buffer_load_dwordx4 v6, s[24:27], s41 offen offset:3072 lds
    s_add_u32 m0, s69, 98304
    s_add_u32 s41, s86, 65536
    buffer_load_dwordx4 v6, s[24:27], s41 offen offset:0 lds
    s_add_u32 s41, s86, 68608
    buffer_load_dwordx4 v6, s[24:27], s41 offen offset:1024 lds
    s_add_u32 s41, s86, 71680
    buffer_load_dwordx4 v6, s[24:27], s41 offen offset:2048 lds
    s_add_u32 s41, s86, 74752
    buffer_load_dwordx4 v6, s[24:27], s41 offen offset:3072 lds
    ds_read_b64_tr_b16 v[40:41], v11 offset:33280
    ds_read_b64_tr_b16 v[42:43], v11 offset:34304
    ds_read_b64_tr_b16 v[44:45], v11 offset:33536
    ds_read_b64_tr_b16 v[46:47], v11 offset:34560
    ds_read_b64_tr_b16 v[48:49], v11 offset:36864
    ds_read_b64_tr_b16 v[50:51], v11 offset:37888
    s_waitcnt lgkmcnt(4)
    v_mfma_f32_32x32x16_bf16 v[96:111], v[40:43], v[144:147], v[96:111]
    s_waitcnt lgkmcnt(2)
    v_mfma_f32_32x32x16_bf16 v[112:127], v[44:47], v[144:147], v[112:127]
    s_waitcnt lgkmcnt(0)
    v_mfma_f32_32x32x16_bf16 v[64:79], v[48:51], v[148:151], v[64:79]
    s_barrier
    s_cmp_lg_u32 s68, 0
    s_cbranch_scc1 g_nopoll
    buffer_load_dword v21, off, s[32:35], s97 sc1
g_nopoll:
    s_nop 7
    s_nop 3
    s_add_u32 m0, s69, 65536
    s_add_u32 s41, s87, 0
    buffer_load_dwordx4 v6, s[24:27], s41 offen offset:0 lds
    s_add_u32 s41, s87, 3072
    buffer_load_dwordx4 v6, s[24:27], s41 offen offset:1024 lds
    s_add_u32 s41, s87, 6144
    buffer_load_dwordx4 v6, s[24:27], s41 offen offset:2048 lds
    s_add_u32 s41, s87, 9216
    buffer_load_dwordx4 v6, s[24:27], s41 offen offset:3072 lds
    s_add_u32 m0, s69, 147456
    s_add_u32 s41, s55, 0
    buffer_load_dwordx4 v6, s[24:27], s41 offen offset:0 lds
    s_add_u32 s41, s55, 3072
    buffer_load_dwordx4 v6, s[24:27], s41 offen offset:1024 lds
    s_add_u32 s41, s55, 6144
    buffer_load_dwordx4 v6, s[24:27], s41 offen offset:2048 lds
    s_add_u32 s41, s55, 9216
    buffer_load_dwordx4 v6, s[24:27], s41 offen offset:3072 lds
    ds_read_b64_tr_b16 v[52:53], v11 offset:37120
    ds_read_b64_tr_b16 v[54:55], v11 offset:38144
    ds_read_b64_tr_b16 v[56:57], v11 offset:37376
    ds_read_b64_tr_b16 v[58:59], v11 offset:38400
    ds_read_b64_tr_b16 v[60:61], v11 offset:37632
    ds_read_b64_tr_b16 v[62:63], v11 offset:38656
    s_waitcnt lgkmcnt(4)
    v_mfma_f32_32x32x16_bf16 v[80:95], v[52:55], v[148:151], v[80:95]
    s_waitcnt lgkmcnt(2)
    v_mfma_f32_32x32x16_bf16 v[96:111], v[56:59], v[148:151], v[96:111]
    s_waitcnt lgkmcnt(0)
    v_mfma_f32_32x32x16_bf16 v[112:127], v[60:63], v[148:151], v[112:127]
    s_barrier
    s_add_u32 m0, s69, 81920
    s_add_u32 s41, s87, 65536
    buffer_load_dwordx4 v6, s[24:27], s41 offen offset:0 lds
    s_add_u32 s41, s87, 68608
    buffer_load_dwordx4 v6, s[24:27], s41 offen offset:1024 lds
    s_add_u32 s41, s87, 71680
    buffer_load_dwordx4 v6, s[24:27], s41 offen offset:2048 lds
    s_add_u32 s41, s87, 74752
    buffer_load_dwordx4 v6, s[24:27], s41 offen offset:3072 lds
    ds_read_b64_tr_b16 v[32:33], v11 offset:40960
    ds_read_b64_tr_b16 v[34:35], v11 offset:41984
    ds_read_b64_tr_b16 v[36:37], v11 offset:41216
    ds_read_b64_tr_b16 v[38:39], v11 offset:42240
    ds_read_b64_tr_b16 v[40:41], v11 offset:41472
    ds_read_b64_tr_b16 v[42:43], v11 offset:42496
    ds_read_b64_tr_b16 v[44:45], v11 offset:41728
    ds_read_b64_tr_b16 v[46:47], v11 offset:42752
    ds_read_b64_tr_b16 v[48:49], v11 offset:45056
    ds_read_b64_tr_b16 v[50:51], v11 offset:46080
    s_waitcnt lgkmcnt(8)
    v_mfma_f32_32x32x16_bf16 v[64:79], v[32:35], v[152:155], v[64:79]
    s_waitcnt lgkmcnt(6)
    v_mfma_f32_32x32x16_bf16 v[80:95], v[36:39], v[152:155], v[80:95]
    s_waitcnt lgkmcnt(4)
    v_mfma_f32_32x32x16_bf16 v[96:111], v[40:43], v[152:155], v[96:111]
    s_waitcnt lgkmcnt(2)
    v_mfma_f32_32x32x16_bf16 v[112:127], v[44:47], v[152:155], v[112:127]
    s_waitcnt lgkmcnt(0)
    v_mfma_f32_32x32x16_bf16 v[64:79], v[48:51], v[156:159], v[64:79]
    s_cmp_lg_u32 s68, 0
    s_cbranch_scc1 g_cp_ok
    s_waitcnt vmcnt(12)
g_cp_chk:
    v_readfirstlane_b32 s74, v21
    s_nop 1
    s_and_b32 s74, s74, s94
    s_cmp_eq_u32 s74, s94
    s_cbranch_scc1 g_cp_ok
    s_sub_u32 s99, s99, 1
    s_cbranch_scc1 g_cp_giveup
    s_sleep 4
    buffer_load_dword v21, off, s[32:35], s97 sc1
    s_waitcnt vmcnt(0)
    s_branch g_cp_chk
g_cp_giveup:
    s_mov_b32 s99, 0
g_cp_ok:
    s_nop 7
    s_nop 3
    s_barrier
    s_mov_b64 exec, s[46:47]
    s_add_u32 s74, s82, 0
    buffer_load_dwordx4 v[160:163], v8, s[20:23], s74 offen offset:0
    s_mov_b64 exec, -1
    s_mov_b64 exec, s[46:47]
    s_add_u32 s74, s82, 0
    buffer_load_dwordx4 v[164:167], v8, s[20:23], s74 offen offset:1024
    s_mov_b64 exec, -1
    s_mov_b64 exec, s[46:47]
    s_add_u32 s74, s82, 0
    buffer_load_dwordx4 v[168:171], v8, s[20:23], s74 offen offset:2048
    s_mov_b64 exec, -1
    s_mov_b64 exec, s[46:47]
    s_add_u32 s74, s82, 0
    buffer_load_dwordx4 v[172:175], v8, s[20:23], s74 offen offset:3072
    s_mov_b64 exec, -1
    s_mov_b64 exec, s[46:47]
    s_add_u32 s74, s82, 4096
    buffer_load_dwordx4 v[176:179], v8, s[20:23], s74 offen offset:0
    s_mov_b64 exec, -1
    s_mov_b64 exec, s[46:47]
    s_add_u32 s74, s82, 4096
    buffer_load_dwordx4 v[180:183], v8, s[20:23], s74 offen offset:1024
    s_mov_b64 exec, -1
    s_mov_b64 exec, s[46:47]
    s_add_u32 s74, s82, 4096
    buffer_load_dwordx4 v[184:187], v8, s[20:23], s74 offen offset:2048
    s_mov_b64 exec, -1
    s_mov_b64 exec, s[46:47]
    s_add_u32 s74, s82, 4096
    buffer_load_dwordx4 v[188:191], v8, s[20:23], s74 offen offset:3072
    s_mov_b64 exec, -1
    s_mov_b64 exec, s[46:47]
    s_add_u32 s74, s83, 0
    buffer_load_dwordx4 v[192:195], v8, s[20:23], s74 offen offset:0
    s_mov_b64 exec, -1
    s_mov_b64 exec, s[46:47]
    s_add_u32 s74, s83, 0
    buffer_load_dwordx4 v[196:199], v8, s[20:23], s74 offen offset:1024
    s_mov_b64 exec, -1
    s_mov_b64 exec, s[46:47]
    s_add_u32 s74, s83, 0
    buffer_load_dwordx4 v[200:203], v8, s[20:23], s74 offen offset:2048
    s_mov_b64 exec, -1
    s_mov_b64 exec, s[46:47]
    s_add_u32 s74, s83, 0
    buffer_load_dwordx4 v[204:207], v8, s[20:23], s74 offen offset:3072
    s_mov_b64 exec, -1
    s_mov_b64 exec, s[46:47]
    s_add_u32 s74, s83, 4096
    buffer_load_dwordx4 v[208:211], v8, s[20:23], s74 offen offset:0
    s_mov_b64 exec, -1
    s_mov_b64 exec, s[46:47]
    s_add_u32 s74, s83, 4096
    buffer_load_dwordx4 v[212:215], v8, s[20:23], s74 offen offset:1024
    s_mov_b64 exec, -1
    s_mov_b64 exec, s[46:47]
    s_add_u32 s74, s83, 4096
    buffer_load_dwordx4 v[216:219], v8, s[20:23], s74 offen offset:2048
    s_mov_b64 exec, -1
    s_mov_b64 exec, s[46:47]
    s_add_u32 s74, s83, 4096
    buffer_load_dwordx4 v[220:223], v8, s[20:23], s74 offen offset:3072
    s_mov_b64 exec, -1
    ds_read_b64_tr_b16 v[52:53], v11 offset:45312
    ds_read_b64_tr_b16 v[54:55], v11 offset:46336
    ds_read_b64_tr_b16 v[56:57], v11 offset:45568
    ds_read_b64_tr_b16 v[58:59], v11 offset:46592
    ds_read_b64_tr_b16 v[60:61], v11 offset:45824
    ds_read_b64_tr_b16 v[62:63], v11 offset:46848
    s_waitcnt lgkmcnt(4)
    v_mfma_f32_32x32x16_bf16 v[80:95], v[52:55], v[156:159], v[80:95]
    s_waitcnt lgkmcnt(2)
    v_mfma_f32_32x32x16_bf16 v[96:111], v[56:59], v[156:159], v[96:111]
    s_waitcnt lgkmcnt(0)
    v_mfma_f32_32x32x16_bf16 v[112:127], v[60:63], v[156:159], v[112:127]
    s_waitcnt vmcnt(28)
    s_barrier
    s_mov_b64 exec, s[46:47]
    s_add_u32 s74, s84, 0
    buffer_load_dwordx4 v[224:227], v8, s[20:23], s74 offen offset:0
    s_mov_b64 exec, -1
    s_mov_b64 exec, s[46:47]
    s_add_u32 s74, s84, 0
    buffer_load_dwordx4 v[228:231], v8, s[20:23], s74 offen offset:1024
    s_mov_b64 exec, -1
    s_mov_b64 exec, s[46:47]
    s_add_u32 s74, s84, 0
    buffer_load_dwordx4 v[232:235], v8, s[20:23], s74 offen offset:2048
    s_mov_b64 exec, -1
    s_mov_b64 exec, s[46:47]
    s_add_u32 s74, s84, 0
    buffer_load_dwordx4 v[236:239], v8, s[20:23], s74 offen offset:3072
    s_mov_b64 exec, -1
    s_mov_b64 exec, s[46:47]
    s_add_u32 s74, s84, 4096
    buffer_load_dwordx4 v[240:243], v8, s[20:23], s74 offen offset:0
    s_mov_b64 exec, -1
    s_mov_b64 exec, s[46:47]
    s_add_u32 s74, s84, 4096
    buffer_load_dwordx4 v[244:247], v8, s[20:23], s74 offen offset:1024
    s_mov_b64 exec, -1
    s_mov_b64 exec, s[46:47]
    s_add_u32 s74, s84, 4096
    buffer_load_dwordx4 v[248:251], v8, s[20:23], s74 offen offset:2048
    s_mov_b64 exec, -1
    s_mov_b64 exec, s[46:47]
    s_add_u32 s74, s84, 4096
    buffer_load_dwordx4 v[252:255], v8, s[20:23], s74 offen offset:3072
    s_mov_b64 exec, -1
    s_add_u32 m0, s69, 16384
    s_add_u32 s41, s88, 0
    buffer_load_dwordx4 v6, s[24:27], s41 offen offset:0 lds
    s_add_u32 s41, s88, 3072
    buffer_load_dwordx4 v6, s[24:27], s41 offen offset:1024 lds
    s_add_u32 s41, s88, 6144
    buffer_load_dwordx4 v6, s[24:27], s41 offen offset:2048 lds
    s_add_u32 s41, s88, 9216
    buffer_load_dwordx4 v6, s[24:27], s41 offen offset:3072 lds
    ds_read_b64_tr_b16 v[32:33], v11 offset:49152
    ds_read_b64_tr_b16 v[34:35], v11 offset:50176
    ds_read_b64_tr_b16 v[36:37], v11 offset:49408
    ds_read_b64_tr_b16 v[38:39], v11 offset:50432
    ds_read_b64_tr_b16 v[40:41], v11 offset:49664
    ds_read_b64_tr_b16 v[42:43], v11 offset:50688
    ds_read_b64_tr_b16 v[44:45], v11 offset:49920
    ds_read_b64_tr_b16 v[46:47], v11 offset:50944
    ds_read_b64_tr_b16 v[48:49], v11 offset:53248
    ds_read_b64_tr_b16 v[50:51], v11 offset:54272
    ds_read_b64_tr_b16 v[52:53], v11 offset:53504
    ds_read_b64_tr_b16 v[54:55], v11 offset:54528
    s_waitcnt vmcnt(20)
    s_waitcnt lgkmcnt(10)
    v_mfma_f32_32x32x16_bf16 v[64:79], v[32:35], v[160:163], v[64:79]
    ds_read_b64_tr_b16 v[56:57], v11 offset:53760
    ds_read_b64_tr_b16 v[58:59], v11 offset:54784
    s_waitcnt lgkmcnt(10)
    v_mfma_f32_32x32x16_bf16 v[80:95], v[36:39], v[160:163], v[80:95]
    ds_read_b64_tr_b16 v[60:61], v11 offset:54016
    ds_read_b64_tr_b16 v[62:63], v11 offset:55040
    s_waitcnt lgkmcnt(10)
    v_mfma_f32_32x32x16_bf16 v[96:111], v[40:43], v[160:163], v[96:111]
    ds_read_b64_tr_b16 v[32:33], v11 offset:57344
    ds_read_b64_tr_b16 v[34:35], v11 offset:58368
    s_waitcnt lgkmcnt(10)
    v_mfma_f32_32x32x16_bf16 v[112:127], v[44:47], v[160:163], v[112:127]
    ds_read_b64_tr_b16 v[36:37], v11 offset:57600
    ds_read_b64_tr_b16 v[38:39], v11 offset:58624
    s_waitcnt lgkmcnt(10)
    v_mfma_f32_32x32x16_bf16 v[64:79], v[48:51], v[164:167], v[64:79]
    ds_read_b64_tr_b16 v[40:41], v11 offset:57856
    ds_read_b64_tr_b16 v[42:43], v11 offset:58880
    s_waitcnt lgkmcnt(10)
    v_mfma_f32_32x32x16_bf16 v[80:95], v[52:55], v[164:167], v[80:95]
    ds_read_b64_tr_b16 v[44:45], v11 offset:58112
    ds_read_b64_tr_b16 v[46:47], v11 offset:59136
    s_waitcnt lgkmcnt(10)
    v_mfma_f32_32x32x16_bf16 v[96:111], v[56:59], v[164:167], v[96:111]
    ds_read_b64_tr_b16 v[48:49], v11 offset:61440
    ds_read_b64_tr_b16 v[50:51], v11 offset:62464
    s_waitcnt lgkmcnt(10)
    v_mfma_f32_32x32x16_bf16 v[112:127], v[60:63], v[164:167], v[112:127]
    ds_read_b64_tr_b16 v[52:53], v11 offset:61696
    ds_read_b64_tr_b16 v[54:55], v11 offset:62720
    s_waitcnt lgkmcnt(10)
    v_mfma_f32_32x32x16_bf16 v[64:79], v[32:35], v[168:171], v[64:79]
    ds_read_b64_tr_b16 v[56:57], v11 offset:61952
    ds_read_b64_tr_b16 v[58:59], v11 offset:62976
    s_waitcnt lgkmcnt(10)
    v_mfma_f32_32x32x16_bf16 v[80:95], v[36:39], v[168:171], v[80:95]
    ds_read_b64_tr_b16 v[60:61], v11 offset:62208
    ds_read_b64_tr_b16 v[62:63], v11 offset:63232
    s_waitcnt lgkmcnt(10)
    v_mfma_f32_32x32x16_bf16 v[96:111], v[40:43], v[168:171], v[96:111]
    ds_read_b64_tr_b16 v[32:33], v12 offset:32768
    ds_read_b64_tr_b16 v[34:35], v12 offset:33792
    s_waitcnt lgkmcnt(10)
    v_mfma_f32_32x32x16_bf16 v[112:127], v[44:47], v[168:171], v[112:127]
    s_waitcnt lgkmcnt(8)
    v_mfma_f32_32x32x16_bf16 v[64:79], v[48:51], v[172:175], v[64:79]
    s_waitcnt lgkmcnt(6)
    v_mfma_f32_32x32x16_bf16 v[80:95], v[52:55], v[172:175], v[80:95]
    s_waitcnt lgkmcnt(4)
    v_mfma_f32_32x32x16_bf16 v[96:111], v[56:59], v[172:175], v[96:111]
    s_waitcnt lgkmcnt(2)
    v_mfma_f32_32x32x16_bf16 v[112:127], v[60:63], v[172:175], v[112:127]
    s_waitcnt lgkmcnt(0)
    v_mfma_f32_32x32x16_bf16 v[64:79], v[32:35], v[176:179], v[64:79]
    s_barrier
    s_add_u32 m0, s69, 49152
    s_add_u32 s41, s88, 65536
    buffer_load_dwordx4 v6, s[24:27], s41 offen offset:0 lds
    s_add_u32 s41, s88, 68608
    buffer_load_dwordx4 v6, s[24:27], s41 offen offset:1024 lds
    s_add_u32 s41, s88, 71680
    buffer_load_dwordx4 v6, s[24:27], s41 offen offset:2048 lds
    s_add_u32 s41, s88, 74752
    buffer_load_dwordx4 v6, s[24:27], s41 offen offset:3072 lds
    ds_read_b64_tr_b16 v[36:37], v12 offset:33024
    ds_read_b64_tr_b16 v[38:39], v12 offset:34048
    ds_read_b64_tr_b16 v[40:41], v12 offset:33280
    ds_read_b64_tr_b16 v[42:43], v12 offset:34304
    ds_read_b64_tr_b16 v[44:45], v12 offset:33536
    ds_read_b64_tr_b16 v[46:47], v12 offset:34560
    ds_read_b64_tr_b16 v[48:49], v12 offset:36864
    ds_read_b64_tr_b16 v[50:51], v12 offset:37888
    ds_read_b64_tr_b16 v[52:53], v12 offset:37120
    ds_read_b64_tr_b16 v[54:55], v12 offset:38144
    ds_read_b64_tr_b16 v[56:57], v12 offset:37376
    ds_read_b64_tr_b16 v[58:59], v12 offset:38400
    s_waitcnt lgkmcnt(10)
    v_mfma_f32_32x32x16_bf16 v[80:95], v[36:39], v[176:179], v[80:95]
    ds_read_b64_tr_b16 v[60:61], v12 offset:37632
    ds_read_b64_tr_b16 v[62:63], v12 offset:38656
    s_waitcnt lgkmcnt(10)
    v_mfma_f32_32x32x16_bf16 v[96:111], v[40:43], v[176:179], v[96:111]
    ds_read_b64_tr_b16 v[32:33], v12 offset:40960
    ds_read_b64_tr_b16 v[34:35], v12 offset:41984
    s_waitcnt lgkmcnt(10)
    v_mfma_f32_32x32x16_bf16 v[112:127], v[44:47], v[176:179], v[112:127]
    ds_read_b64_tr_b16 v[36:37], v12 offset:41216
    ds_read_b64_tr_b16 v[38:39], v12 offset:42240
    s_waitcnt lgkmcnt(10)
    v_mfma_f32_32x32x16_bf16 v[64:79], v[48:51], v[180:183], v[64:79]
    ds_read_b64_tr_b16 v[40:41], v12 offset:41472
    ds_read_b64_tr_b16 v[42:43], v12 offset:42496
    s_waitcnt lgkmcnt(10)
    v_mfma_f32_32x32x16_bf16 v[80:95], v[52:55], v[180:183], v[80:95]
    ds_read_b64_tr_b16 v[44:45], v12 offset:41728
    ds_read_b64_tr_b16 v[46:47], v12 offset:42752
    s_waitcnt lgkmcnt(10)
    v_mfma_f32_32x32x16_bf16 v[96:111], v[56:59], v[180:183], v[96:111]
    ds_read_b64_tr_b16 v[48:49], v12 offset:45056
    ds_read_b64_tr_b16 v[50:51], v12 offset:46080
    s_waitcnt lgkmcnt(10)
    v_mfma_f32_32x32x16_bf16 v[112:127], v[60:63], v[180:183], v[112:127]
    ds_read_b64_tr_b16 v[52:53], v12 offset:45312
    ds_read_b64_tr_b16 v[54:55], v12 offset:46336
    s_waitcnt lgkmcnt(10)
    v_mfma_f32_32x32x16_bf16 v[64:79], v[32:35], v[184:187], v[64:79]
    ds_read_b64_tr_b16 v[56:57], v12 offset:45568
    ds_read_b64_tr_b16 v[58:59], v12 offset:46592
    s_waitcnt lgkmcnt(10)
    v_mfma_f32_32x32x16_bf16 v[80:95], v[36:39], v[184:187], v[80:95]
    ds_read_b64_tr_b16 v[60:61], v12 offset:45824
    ds_read_b64_tr_b16 v[62:63], v12 offset:46848
    s_waitcnt lgkmcnt(10)
    v_mfma_f32_32x32x16_bf16 v[96:111], v[40:43], v[184:187], v[96:111]
    ds_read_b64_tr_b16 v[32:33], v12 offset:0
    ds_read_b64_tr_b16 v[34:35], v12 offset:1024
    s_waitcnt lgkmcnt(10)
    v_mfma_f32_32x32x16_bf16 v[112:127], v[44:47], v[184:187], v[112:127]
    ds_read_b64_tr_b16 v[36:37], v12 offset:256
    ds_read_b64_tr_b16 v[38:39], v12 offset:1280
    s_waitcnt lgkmcnt(10)
    v_mfma_f32_32x32x16_bf16 v[64:79], v[48:51], v[188:191], v[64:79]
    ds_read_b64_tr_b16 v[40:41], v12 offset:512
    ds_read_b64_tr_b16 v[42:43], v12 offset:1536
    s_waitcnt lgkmcnt(10)
    v_mfma_f32_32x32x16_bf16 v[80:95], v[52:55], v[188:191], v[80:95]
    s_waitcnt lgkmcnt(8)
    v_mfma_f32_32x32x16_bf16 v[96:111], v[56:59], v[188:191], v[96:111]
    s_waitcnt lgkmcnt(6)
    v_mfma_f32_32x32x16_bf16 v[112:127], v[60:63], v[188:191], v[112:127]
    s_waitcnt vmcnt(16)
    s_waitcnt lgkmcnt(4)
    v_mfma_f32_32x32x16_bf16 v[64:79], v[32:35], v[192:195], v[64:79]
    s_waitcnt lgkmcnt(2)
    v_mfma_f32_32x32x16_bf16 v[80:95], v[36:39], v[192:195], v[80:95]
    s_waitcnt lgkmcnt(0)
    v_mfma_f32_32x32x16_bf16 v[96:111], v[40:43], v[192:195], v[96:111]
    s_barrier
    s_add_u32 m0, s69, 98304
    s_add_u32 s41, s55, 65536
    buffer_load_dwordx4 v6, s[24:27], s41 offen offset:0 lds
    s_add_u32 s41, s55, 68608
    buffer_load_dwordx4 v6, s[24:27], s41 offen offset:1024 lds
    s_add_u32 s41, s55, 71680
    buffer_load_dwordx4 v6, s[24:27], s41 offen offset:2048 lds
    s_add_u32 s41, s55, 74752
    buffer_load_dwordx4 v6, s[24:27], s41 offen offset:3072 lds
    s_add_u32 m0, s69, 131072
    s_add_u32 s41, s54, 0
    buffer_load_dwordx4 v6, s[24:27], s41 offen offset:0 lds
    s_add_u32 s41, s54, 3072
    buffer_load_dwordx4 v6, s[24:27], s41 offen offset:1024 lds
    s_add_u32 s41, s54, 6144
    buffer_load_dwordx4 v6, s[24:27], s41 offen offset:2048 lds
    s_add_u32 s41, s54, 9216
    buffer_load_dwordx4 v6, s[24:27], s41 offen offset:3072 lds
    ds_read_b64_tr_b16 v[44:45], v12 offset:768
    ds_read_b64_tr_b16 v[46:47], v12 offset:1792
    ds_read_b64_tr_b16 v[48:49], v12 offset:4096
    ds_read_b64_tr_b16 v[50:51], v12 offset:5120
    ds_read_b64_tr_b16 v[52:53], v12 offset:4352
    ds_read_b64_tr_b16 v[54:55], v12 offset:5376
    ds_read_b64_tr_b16 v[56:57], v12 offset:4608
    ds_read_b64_tr_b16 v[58:59], v12 offset:5632
    ds_read_b64_tr_b16 v[60:61], v12 offset:4864
    ds_read_b64_tr_b16 v[62:63], v12 offset:5888
    ds_read_b64_tr_b16 v[32:33], v12 offset:8192
    ds_read_b64_tr_b16 v[34:35], v12 offset:9216
    s_waitcnt lgkmcnt(10)
    v_mfma_f32_32x32x16_bf16 v[112:127], v[44:47], v[192:195], v[112:127]
    ds_read_b64_tr_b16 v[36:37], v12 offset:8448
    ds_read_b64_tr_b16 v[38:39], v12 offset:9472
    s_waitcnt lgkmcnt(10)
    v_mfma_f32_32x32x16_bf16 v[64:79], v[48:51], v[196:199], v[64:79]
    ds_read_b64_tr_b16 v[40:41], v12 offset:8704
    ds_read_b64_tr_b16 v[42:43], v12 offset:9728
    s_waitcnt lgkmcnt(10)
    v_mfma_f32_32x32x16_bf16 v[80:95], v[52:55], v[196:199], v[80:95]
    ds_read_b64_tr_b16 v[44:45], v12 offset:8960
    ds_read_b64_tr_b16 v[46:47], v12 offset:9984
    s_waitcnt lgkmcnt(10)
    v_mfma_f32_32x32x16_bf16 v[96:111], v[56:59], v[196:199], v[96:111]
    ds_read_b64_tr_b16 v[48:49], v12 offset:12288
    ds_read_b64_tr_b16 v[50:51], v12 offset:13312
    s_waitcnt lgkmcnt(10)
    v_mfma_f32_32x32x16_bf16 v[112:127], v[60:63], v[196:199], v[112:127]
    ds_read_b64_tr_b16 v[52:53], v12 offset:12544
    ds_read_b64_tr_b16 v[54:55], v12 offset:13568
    s_waitcnt lgkmcnt(10)
    v_mfma_f32_32x32x16_bf16 v[64:79], v[32:35], v[200:203], v[64:79]
    ds_read_b64_tr_b16 v[56:57], v12 offset:12800
    ds_read_b64_tr_b16 v[58:59], v12 offset:13824
    s_waitcnt lgkmcnt(10)
    v_mfma_f32_32x32x16_bf16 v[80:95], v[36:39], v[200:203], v[80:95]
    ds_read_b64_tr_b16 v[60:61], v12 offset:13056
    ds_read_b64_tr_b16 v[62:63], v12 offset:14080
    s_waitcnt lgkmcnt(10)
    v_mfma_f32_32x32x16_bf16 v[96:111], v[40:43], v[200:203], v[96:111]
    ds_read_b64_tr_b16 v[32:33], v12 offset:16384
    ds_read_b64_tr_b16 v[34:35], v12 offset:17408
    s_waitcnt lgkmcnt(10)
    v_mfma_f32_32x32x16_bf16 v[112:127], v[44:47], v[200:203], v[112:127]
    ds_read_b64_tr_b16 v[36:37], v12 offset:16640
    ds_read_b64_tr_b16 v[38:39], v12 offset:17664
    s_waitcnt lgkmcnt(10)
    v_mfma_f32_32x32x16_bf16 v[64:79], v[48:51], v[204:207], v[64:79]
    ds_read_b64_tr_b16 v[40:41], v12 offset:16896
    ds_read_b64_tr_b16 v[42:43], v12 offset:17920
    s_waitcnt lgkmcnt(10)
    v_mfma_f32_32x32x16_bf16 v[80:95], v[52:55], v[204:207], v[80:95]
    ds_read_b64_tr_b16 v[44:45], v12 offset:17152
    ds_read_b64_tr_b16 v[46:47], v12 offset:18176
    s_waitcnt lgkmcnt(10)
    v_mfma_f32_32x32x16_bf16 v[96:111], v[56:59], v[204:207], v[96:111]
    ds_read_b64_tr_b16 v[48:49], v12 offset:20480
    ds_read_b64_tr_b16 v[50:51], v12 offset:21504
    s_waitcnt lgkmcnt(10)
    v_mfma_f32_32x32x16_bf16 v[112:127], v[60:63], v[204:207], v[112:127]
    ds_read_b64_tr_b16 v[52:53], v12 offset:20736
    ds_read_b64_tr_b16 v[54:55], v12 offset:21760
    s_waitcnt lgkmcnt(10)
    v_mfma_f32_32x32x16_bf16 v[64:79], v[32:35], v[208:211], v[64:79]
    ds_read_b64_tr_b16 v[56:57], v12 offset:20992
    ds_read_b64_tr_b16 v[58:59], v12 offset:22016
    s_waitcnt lgkmcnt(10)
    v_mfma_f32_32x32x16_bf16 v[80:95], v[36:39], v[208:211], v[80:95]
    ds_read_b64_tr_b16 v[60:61], v12 offset:21248
    ds_read_b64_tr_b16 v[62:63], v12 offset:22272
    s_waitcnt lgkmcnt(10)
    v_mfma_f32_32x32x16_bf16 v[96:111], v[40:43], v[208:211], v[96:111]
    ds_read_b64_tr_b16 v[32:33], v12 offset:24576
    ds_read_b64_tr_b16 v[34:35], v12 offset:25600
    s_waitcnt lgkmcnt(10)
    v_mfma_f32_32x32x16_bf16 v[112:127], v[44:47], v[208:211], v[112:127]
    ds_read_b64_tr_b16 v[36:37], v12 offset:24832
    ds_read_b64_tr_b16 v[38:39], v12 offset:25856
    s_waitcnt lgkmcnt(10)
    v_mfma_f32_32x32x16_bf16 v[64:79], v[48:51], v[212:215], v[64:79]
    ds_read_b64_tr_b16 v[40:41], v12 offset:25088
    ds_read_b64_tr_b16 v[42:43], v12 offset:26112
    s_waitcnt lgkmcnt(10)
    v_mfma_f32_32x32x16_bf16 v[80:95], v[52:55], v[212:215], v[80:95]
    ds_read_b64_tr_b16 v[44:45], v12 offset:25344
    ds_read_b64_tr_b16 v[46:47], v12 offset:26368
    s_waitcnt lgkmcnt(10)
    v_mfma_f32_32x32x16_bf16 v[96:111], v[56:59], v[212:215], v[96:111]
    ds_read_b64_tr_b16 v[48:49], v12 offset:28672
    ds_read_b64_tr_b16 v[50:51], v12 offset:29696
    s_waitcnt lgkmcnt(10)
    v_mfma_f32_32x32x16_bf16 v[112:127], v[60:63], v[212:215], v[112:127]
    s_waitcnt lgkmcnt(8)
    v_mfma_f32_32x32x16_bf16 v[64:79], v[32:35], v[216:219], v[64:79]
    s_waitcnt lgkmcnt(6)
    v_mfma_f32_32x32x16_bf16 v[80:95], v[36:39], v[216:219], v[80:95]
    s_waitcnt lgkmcnt(4)
    v_mfma_f32_32x32x16_bf16 v[96:111], v[40:43], v[216:219], v[96:111]
    s_waitcnt lgkmcnt(2)
    v_mfma_f32_32x32x16_bf16 v[112:127], v[44:47], v[216:219], v[112:127]
    s_waitcnt lgkmcnt(0)
    v_mfma_f32_32x32x16_bf16 v[64:79], v[48:51], v[220:223], v[64:79]
    s_waitcnt vmcnt(12)
    s_barrier
    s_add_u32 m0, s69, 65536
    s_add_u32 s41, s54, 65536
    buffer_load_dwordx4 v6, s[24:27], s41 offen offset:0 lds
    s_add_u32 s41, s54, 68608
    buffer_load_dwordx4 v6, s[24:27], s41 offen offset:1024 lds
    s_add_u32 s41, s54, 71680
    buffer_load_dwordx4 v6, s[24:27], s41 offen offset:2048 lds
    s_add_u32 s41, s54, 74752
    buffer_load_dwordx4 v6, s[24:27], s41 offen offset:3072 lds
    ds_read_b64_tr_b16 v[52:53], v12 offset:28928
    ds_read_b64_tr_b16 v[54:55], v12 offset:29952
    ds_read_b64_tr_b16 v[56:57], v12 offset:29184
    ds_read_b64_tr_b16 v[58:59], v12 offset:30208
    ds_read_b64_tr_b16 v[60:61], v12 offset:29440
    ds_read_b64_tr_b16 v[62:63], v12 offset:30464
    ds_read_b64_tr_b16 v[32:33], v11 offset:16384
    ds_read_b64_tr_b16 v[34:35], v11 offset:17408
    ds_read_b64_tr_b16 v[36:37], v11 offset:16640
    ds_read_b64_tr_b16 v[38:39], v11 offset:17664
    ds_read_b64_tr_b16 v[40:41], v11 offset:16896
    ds_read_b64_tr_b16 v[42:43], v11 offset:17920
    s_waitcnt lgkmcnt(10)
    v_mfma_f32_32x32x16_bf16 v[80:95], v[52:55], v[220:223], v[80:95]
    ds_read_b64_tr_b16 v[44:45], v11 offset:17152
    ds_read_b64_tr_b16 v[46:47], v11 offset:18176
    s_waitcnt lgkmcnt(10)
    v_mfma_f32_32x32x16_bf16 v[96:111], v[56:59], v[220:223], v[96:111]
    ds_read_b64_tr_b16 v[48:49], v11 offset:20480
    ds_read_b64_tr_b16 v[50:51], v11 offset:21504
    s_waitcnt lgkmcnt(10)
    v_mfma_f32_32x32x16_bf16 v[112:127], v[60:63], v[220:223], v[112:127]
    ds_read_b64_tr_b16 v[52:53], v11 offset:20736
    ds_read_b64_tr_b16 v[54:55], v11 offset:21760
    s_waitcnt lgkmcnt(10)
    v_mfma_f32_32x32x16_bf16 v[64:79], v[32:35], v[224:227], v[64:79]
    ds_read_b64_tr_b16 v[56:57], v11 offset:20992
    ds_read_b64_tr_b16 v[58:59], v11 offset:22016
    s_waitcnt lgkmcnt(10)
    v_mfma_f32_32x32x16_bf16 v[80:95], v[36:39], v[224:227], v[80:95]
    ds_read_b64_tr_b16 v[60:61], v11 offset:21248
    ds_read_b64_tr_b16 v[62:63], v11 offset:22272
    s_waitcnt lgkmcnt(10)
    v_mfma_f32_32x32x16_bf16 v[96:111], v[40:43], v[224:227], v[96:111]
    ds_read_b64_tr_b16 v[32:33], v11 offset:24576
    ds_read_b64_tr_b16 v[34:35], v11 offset:25600
    s_waitcnt lgkmcnt(10)
    v_mfma_f32_32x32x16_bf16 v[112:127], v[44:47], v[224:227], v[112:127]
    ds_read_b64_tr_b16 v[36:37], v11 offset:24832
    ds_read_b64_tr_b16 v[38:39], v11 offset:25856
    s_waitcnt lgkmcnt(10)
    v_mfma_f32_32x32x16_bf16 v[64:79], v[48:51], v[228:231], v[64:79]
    ds_read_b64_tr_b16 v[40:41], v11 offset:25088
    ds_read_b64_tr_b16 v[42:43], v11 offset:26112
    s_waitcnt lgkmcnt(10)
    v_mfma_f32_32x32x16_bf16 v[80:95], v[52:55], v[228:231], v[80:95]
    ds_read_b64_tr_b16 v[44:45], v11 offset:25344
    ds_read_b64_tr_b16 v[46:47], v11 offset:26368
    s_waitcnt lgkmcnt(10)
    v_mfma_f32_32x32x16_bf16 v[96:111], v[56:59], v[228:231], v[96:111]
    ds_read_b64_tr_b16 v[48:49], v11 offset:28672
    ds_read_b64_tr_b16 v[50:51], v11 offset:29696
    s_waitcnt lgkmcnt(10)
    v_mfma_f32_32x32x16_bf16 v[112:127], v[60:63], v[228:231], v[112:127]
    ds_read_b64_tr_b16 v[52:53], v11 offset:28928
    ds_read_b64_tr_b16 v[54:55], v11 offset:29952
    s_waitcnt lgkmcnt(10)
    v_mfma_f32_32x32x16_bf16 v[64:79], v[32:35], v[232:235], v[64:79]
    ds_read_b64_tr_b16 v[56:57], v11 offset:29184
    ds_read_b64_tr_b16 v[58:59], v11 offset:30208
    s_waitcnt lgkmcnt(10)
    v_mfma_f32_32x32x16_bf16 v[80:95], v[36:39], v[232:235], v[80:95]
    s_waitcnt lgkmcnt(8)
    v_mfma_f32_32x32x16_bf16 v[96:111], v[40:43], v[232:235], v[96:111]
    s_waitcnt lgkmcnt(6)
    v_mfma_f32_32x32x16_bf16 v[112:127], v[44:47], v[232:235], v[112:127]
    s_waitcnt lgkmcnt(4)
    v_mfma_f32_32x32x16_bf16 v[64:79], v[48:51], v[236:239], v[64:79]
    s_waitcnt lgkmcnt(2)
    v_mfma_f32_32x32x16_bf16 v[80:95], v[52:55], v[236:239], v[80:95]
    s_waitcnt lgkmcnt(0)
    v_mfma_f32_32x32x16_bf16 v[96:111], v[56:59], v[236:239], v[96:111]
    s_cmp_lg_u32 s68, 0
    s_cbranch_scc1 g_cq_ok
g_cq_chk:
    v_readfirstlane_b32 s74, v21
    s_nop 1
    s_and_b32 s74, s74, s95
    s_cmp_eq_u32 s74, s95
    s_cbranch_scc1 g_cq_ok
    s_sub_u32 s99, s99, 1
    s_cbranch_scc1 g_cq_giveup
    s_sleep 4
    buffer_load_dword v21, off, s[32:35], s97 sc1
    s_waitcnt vmcnt(0)
    s_branch g_cq_chk
g_cq_giveup:
    s_mov_b32 s99, 0
g_cq_ok:
    s_nop 7
    s_nop 3
    s_waitcnt vmcnt(12)
    s_barrier
    s_add_u32 m0, s69, 81920
    s_add_u32 s41, s57, 0
    buffer_load_dwordx4 v6, s[24:27], s41 offen offset:0 lds
    s_add_u32 s41, s57, 3072
    buffer_load_dwordx4 v6, s[24:27], s41 offen offset:1024 lds
    s_add_u32 s41, s57, 6144
    buffer_load_dwordx4 v6, s[24:27], s41 offen offset:2048 lds
    s_add_u32 s41, s57, 9216
    buffer_load_dwordx4 v6, s[24:27], s41 offen offset:3072 lds
    ds_read_b64_tr_b16 v[60:61], v11 offset:29440
    ds_read_b64_tr_b16 v[62:63], v11 offset:30464
    ds_read_b64_tr_b16 v[32:33], v11 offset:49152
    ds_read_b64_tr_b16 v[34:35], v11 offset:50176
    ds_read_b64_tr_b16 v[36:37], v11 offset:49408
    ds_read_b64_tr_b16 v[38:39], v11 offset:50432
    ds_read_b64_tr_b16 v[40:41], v11 offset:49664
    ds_read_b64_tr_b16 v[42:43], v11 offset:50688
    ds_read_b64_tr_b16 v[44:45], v11 offset:49920
    ds_read_b64_tr_b16 v[46:47], v11 offset:50944
    ds_read_b64_tr_b16 v[48:49], v11 offset:53248
    ds_read_b64_tr_b16 v[50:51], v11 offset:54272
    s_waitcnt lgkmcnt(10)
    v_mfma_f32_32x32x16_bf16 v[112:127], v[60:63], v[236:239], v[112:127]
    ds_read_b64_tr_b16 v[52:53], v11 offset:53504
    ds_read_b64_tr_b16 v[54:55], v11 offset:54528
    s_waitcnt lgkmcnt(10)
    v_mfma_f32_32x32x16_bf16 v[64:79], v[32:35], v[240:243], v[64:79]
    ds_read_b64_tr_b16 v[56:57], v11 offset:53760
    ds_read_b64_tr_b16 v[58:59], v11 offset:54784
    s_waitcnt lgkmcnt(10)
    v_mfma_f32_32x32x16_bf16 v[80:95], v[36:39], v[240:243], v[80:95]
    ds_read_b64_tr_b16 v[60:61], v11 offset:54016
    ds_read_b64_tr_b16 v[62:63], v11 offset:55040
    s_waitcnt lgkmcnt(10)
    v_mfma_f32_32x32x16_bf16 v[96:111], v[40:43], v[240:243], v[96:111]
    ds_read_b64_tr_b16 v[32:33], v11 offset:57344
    ds_read_b64_tr_b16 v[34:35], v11 offset:58368
    s_waitcnt lgkmcnt(10)
    v_mfma_f32_32x32x16_bf16 v[112:127], v[44:47], v[240:243], v[112:127]
    ds_read_b64_tr_b16 v[36:37], v11 offset:57600
    ds_read_b64_tr_b16 v[38:39], v11 offset:58624
    s_waitcnt lgkmcnt(10)
    v_mfma_f32_32x32x16_bf16 v[64:79], v[48:51], v[244:247], v[64:79]
    ds_read_b64_tr_b16 v[40:41], v11 offset:57856
    ds_read_b64_tr_b16 v[42:43], v11 offset:58880
    s_waitcnt lgkmcnt(10)
    v_mfma_f32_32x32x16_bf16 v[80:95], v[52:55], v[244:247], v[80:95]
    ds_read_b64_tr_b16 v[44:45], v11 offset:58112
    ds_read_b64_tr_b16 v[46:47], v11 offset:59136
    s_waitcnt lgkmcnt(10)
    v_mfma_f32_32x32x16_bf16 v[96:111], v[56:59], v[244:247], v[96:111]
    ds_read_b64_tr_b16 v[48:49], v11 offset:61440
    ds_read_b64_tr_b16 v[50:51], v11 offset:62464
    s_waitcnt lgkmcnt(10)
    v_mfma_f32_32x32x16_bf16 v[112:127], v[60:63], v[244:247], v[112:127]
    ds_read_b64_tr_b16 v[52:53], v11 offset:61696
    ds_read_b64_tr_b16 v[54:55], v11 offset:62720
    s_waitcnt lgkmcnt(10)
    v_mfma_f32_32x32x16_bf16 v[64:79], v[32:35], v[248:251], v[64:79]
    ds_read_b64_tr_b16 v[56:57], v11 offset:61952
    ds_read_b64_tr_b16 v[58:59], v11 offset:62976
    s_waitcnt lgkmcnt(10)
    v_mfma_f32_32x32x16_bf16 v[80:95], v[36:39], v[248:251], v[80:95]
    ds_read_b64_tr_b16 v[60:61], v11 offset:62208
    ds_read_b64_tr_b16 v[62:63], v11 offset:63232
    s_waitcnt lgkmcnt(10)
    v_mfma_f32_32x32x16_bf16 v[96:111], v[40:43], v[248:251], v[96:111]
    s_waitcnt lgkmcnt(8)
    v_mfma_f32_32x32x16_bf16 v[112:127], v[44:47], v[248:251], v[112:127]
    s_waitcnt lgkmcnt(6)
    v_mfma_f32_32x32x16_bf16 v[64:79], v[48:51], v[252:255], v[64:79]
    s_waitcnt lgkmcnt(4)
    v_mfma_f32_32x32x16_bf16 v[80:95], v[52:55], v[252:255], v[80:95]
    s_waitcnt lgkmcnt(2)
    v_mfma_f32_32x32x16_bf16 v[96:111], v[56:59], v[252:255], v[96:111]
    s_waitcnt lgkmcnt(0)
    v_mfma_f32_32x32x16_bf16 v[112:127], v[60:63], v[252:255], v[112:127]
    s_waitcnt vmcnt(12)
    s_barrier
    s_cmp_lt_u32 s68, 2
    s_cselect_b32 s93, 0, 4
    s_and_b32 s74, s68, 1
    s_add_u32 s93, s93, s74
    s_lshl_b32 s93, s93, 13
    v_add_u32 v20, s93, v8
    ds_read_b128 v[128:131], v20 offset:0
    ds_read_b128 v[132:135], v20 offset:1024
    ds_read_b128 v[136:139], v20 offset:2048
    ds_read_b128 v[140:143], v20 offset:3072
    ds_read_b128 v[144:147], v20 offset:4096
    ds_read_b128 v[148:151], v20 offset:5120
    ds_read_b128 v[152:155], v20 offset:6144
    ds_read_b128 v[156:159], v20 offset:7168
    s_add_u32 m0, s69, 16384
    s_add_u32 s41, s57, 65536
    buffer_load_dwordx4 v6, s[24:27], s41 offen offset:0 lds
    s_add_u32 s41, s57, 68608
    buffer_load_dwordx4 v6, s[24:27], s41 offen offset:1024 lds
    s_add_u32 s41, s57, 71680
    buffer_load_dwordx4 v6, s[24:27], s41 offen offset:2048 lds
    s_add_u32 s41, s57, 74752
    buffer_load_dwordx4 v6, s[24:27], s41 offen offset:3072 lds
    s_add_u32 m0, s69, 49152
    s_add_u32 s41, s56, 0
    buffer_load_dwordx4 v6, s[24:27], s41 offen offset:0 lds
    s_add_u32 s41, s56, 3072
    buffer_load_dwordx4 v6, s[24:27], s41 offen offset:1024 lds
    s_add_u32 s41, s56, 6144
    buffer_load_dwordx4 v6, s[24:27], s41 offen offset:2048 lds
    s_add_u32 s41, s56, 9216
    buffer_load_dwordx4 v6, s[24:27], s41 offen offset:3072 lds
    s_add_u32 m0, s69, 114688
    s_add_u32 s41, s56, 65536
    buffer_load_dwordx4 v6, s[24:27], s41 offen offset:0 lds
    s_add_u32 s41, s56, 68608
    buffer_load_dwordx4 v6, s[24:27], s41 offen offset:1024 lds
    s_add_u32 s41, s56, 71680
    buffer_load_dwordx4 v6, s[24:27], s41 offen offset:2048 lds
    s_add_u32 s41, s56, 74752
    buffer_load_dwordx4 v6, s[24:27], s41 offen offset:3072 lds
    ds_read_b64_tr_b16 v[32:33], v13 offset:16384
    ds_read_b64_tr_b16 v[34:35], v13 offset:17408
    ds_read_b64_tr_b16 v[36:37], v13 offset:16640
    ds_read_b64_tr_b16 v[38:39], v13 offset:17664
    ds_read_b64_tr_b16 v[40:41], v13 offset:16896
    ds_read_b64_tr_b16 v[42:43], v13 offset:17920
    ds_read_b64_tr_b16 v[44:45], v13 offset:17152
    ds_read_b64_tr_b16 v[46:47], v13 offset:18176
    ds_read_b64_tr_b16 v[48:49], v13 offset:20480
    ds_read_b64_tr_b16 v[50:51], v13 offset:21504
    ds_read_b64_tr_b16 v[52:53], v13 offset:20736
    ds_read_b64_tr_b16 v[54:55], v13 offset:21760
    s_waitcnt lgkmcnt(15)
    s_waitcnt lgkmcnt(10)
    v_mfma_f32_32x32x16_bf16 v[64:79], v[32:35], v[128:131], v[64:79]
    ds_read_b64_tr_b16 v[56:57], v13 offset:20992
    ds_read_b64_tr_b16 v[58:59], v13 offset:22016
    s_waitcnt lgkmcnt(10)
    v_mfma_f32_32x32x16_bf16 v[80:95], v[36:39], v[128:131], v[80:95]
    ds_read_b64_tr_b16 v[60:61], v13 offset:21248
    ds_read_b64_tr_b16 v[62:63], v13 offset:22272
    s_waitcnt lgkmcnt(10)
    v_mfma_f32_32x32x16_bf16 v[96:111], v[40:43], v[128:131], v[96:111]
    ds_read_b64_tr_b16 v[32:33], v13 offset:24576
    ds_read_b64_tr_b16 v[34:35], v13 offset:25600
    s_waitcnt lgkmcnt(10)
    v_mfma_f32_32x32x16_bf16 v[112:127], v[44:47], v[128:131], v[112:127]
    ds_read_b64_tr_b16 v[36:37], v13 offset:24832
    ds_read_b64_tr_b16 v[38:39], v13 offset:25856
    s_waitcnt lgkmcnt(10)
    v_mfma_f32_32x32x16_bf16 v[64:79], v[48:51], v[132:135], v[64:79]
    ds_read_b64_tr_b16 v[40:41], v13 offset:25088
    ds_read_b64_tr_b16 v[42:43], v13 offset:26112
    s_waitcnt lgkmcnt(10)
    v_mfma_f32_32x32x16_bf16 v[80:95], v[52:55], v[132:135], v[80:95]
    ds_read_b64_tr_b16 v[44:45], v13 offset:25344
    ds_read_b64_tr_b16 v[46:47], v13 offset:26368
    s_waitcnt lgkmcnt(10)
    v_mfma_f32_32x32x16_bf16 v[96:111], v[56:59], v[132:135], v[96:111]
    ds_read_b64_tr_b16 v[48:49], v13 offset:28672
    ds_read_b64_tr_b16 v[50:51], v13 offset:29696
    s_waitcnt lgkmcnt(10)
    v_mfma_f32_32x32x16_bf16 v[112:127], v[60:63], v[132:135], v[112:127]
    ds_read_b64_tr_b16 v[52:53], v13 offset:28928
    ds_read_b64_tr_b16 v[54:55], v13 offset:29952
    s_waitcnt lgkmcnt(10)
    v_mfma_f32_32x32x16_bf16 v[64:79], v[32:35], v[136:139], v[64:79]
    ds_read_b64_tr_b16 v[56:57], v13 offset:29184
    ds_read_b64_tr_b16 v[58:59], v13 offset:30208
    s_waitcnt lgkmcnt(10)
    v_mfma_f32_32x32x16_bf16 v[80:95], v[36:39], v[136:139], v[80:95]
    ds_read_b64_tr_b16 v[60:61], v13 offset:29440
    ds_read_b64_tr_b16 v[62:63], v13 offset:30464
    s_waitcnt lgkmcnt(10)
    v_mfma_f32_32x32x16_bf16 v[96:111], v[40:43], v[136:139], v[96:111]
    ds_read_b64_tr_b16 v[32:33], v12 offset:32768
    ds_read_b64_tr_b16 v[34:35], v12 offset:33792
    s_waitcnt lgkmcnt(10)
    v_mfma_f32_32x32x16_bf16 v[112:127], v[44:47], v[136:139], v[112:127]
    ds_read_b64_tr_b16 v[36:37], v12 offset:33024
    ds_read_b64_tr_b16 v[38:39], v12 offset:34048
    s_waitcnt lgkmcnt(10)
    v_mfma_f32_32x32x16_bf16 v[64:79], v[48:51], v[140:143], v[64:79]
    ds_read_b64_tr_b16 v[40:41], v12 offset:33280
    ds_read_b64_tr_b16 v[42:43], v12 offset:34304
    s_waitcnt lgkmcnt(10)
    v_mfma_f32_32x32x16_bf16 v[80:95], v[52:55], v[140:143], v[80:95]
    ds_read_b64_tr_b16 v[44:45], v12 offset:33536
    ds_read_b64_tr_b16 v[46:47], v12 offset:34560
    s_waitcnt lgkmcnt(10)
    v_mfma_f32_32x32x16_bf16 v[96:111], v[56:59], v[140:143], v[96:111]
    ds_read_b64_tr_b16 v[48:49], v12 offset:36864
    ds_read_b64_tr_b16 v[50:51], v12 offset:37888
    s_waitcnt lgkmcnt(10)
    v_mfma_f32_32x32x16_bf16 v[112:127], v[60:63], v[140:143], v[112:127]
    ds_read_b64_tr_b16 v[52:53], v12 offset:37120
    ds_read_b64_tr_b16 v[54:55], v12 offset:38144
    s_waitcnt lgkmcnt(10)
    v_mfma_f32_32x32x16_bf16 v[64:79], v[32:35], v[144:147], v[64:79]
    ds_read_b64_tr_b16 v[56:57], v12 offset:37376
    ds_read_b64_tr_b16 v[58:59], v12 offset:38400
    s_mov_b64 exec, s[46:47]
    s_add_u32 s74, s81, 528384
    buffer_load_dwordx4 v[188:191], v8, s[20:23], s74 offen offset:3072 sc1
    s_mov_b64 exec, -1
    s_mov_b64 exec, s[46:47]
    s_add_u32 s74, s84, 528384
    buffer_load_dwordx4 v[220:223], v8, s[20:23], s74 offen offset:3072 sc1
    s_mov_b64 exec, -1
    s_mov_b64 exec, s[46:47]
    s_add_u32 s74, s83, 528384
    buffer_load_dwordx4 v[252:255], v8, s[20:23], s74 offen offset:3072 sc1
    s_mov_b64 exec, -1
    s_waitcnt lgkmcnt(10)
    v_mfma_f32_32x32x16_bf16 v[80:95], v[36:39], v[144:147], v[80:95]
    ds_read_b64_tr_b16 v[60:61], v12 offset:37632
    ds_read_b64_tr_b16 v[62:63], v12 offset:38656
    s_waitcnt lgkmcnt(10)
    v_mfma_f32_32x32x16_bf16 v[96:111], v[40:43], v[144:147], v[96:111]
    ds_read_b64_tr_b16 v[32:33], v12 offset:40960
    ds_read_b64_tr_b16 v[34:35], v12 offset:41984
    s_waitcnt lgkmcnt(10)
    v_mfma_f32_32x32x16_bf16 v[112:127], v[44:47], v[144:147], v[112:127]
    ds_read_b64_tr_b16 v[36:37], v12 offset:41216
    ds_read_b64_tr_b16 v[38:39], v12 offset:42240
    s_waitcnt lgkmcnt(10)
    v_mfma_f32_32x32x16_bf16 v[64:79], v[48:51], v[148:151], v[64:79]
    ds_read_b64_tr_b16 v[40:41], v12 offset:41472
    ds_read_b64_tr_b16 v[42:43], v12 offset:42496
    s_waitcnt lgkmcnt(10)
    v_mfma_f32_32x32x16_bf16 v[80:95], v[52:55], v[148:151], v[80:95]
    ds_read_b64_tr_b16 v[44:45], v12 offset:41728
    ds_read_b64_tr_b16 v[46:47], v12 offset:42752
    s_waitcnt lgkmcnt(10)
    v_mfma_f32_32x32x16_bf16 v[96:111], v[56:59], v[148:151], v[96:111]
    ds_read_b64_tr_b16 v[48:49], v12 offset:45056
    ds_read_b64_tr_b16 v[50:51], v12 offset:46080
    s_waitcnt lgkmcnt(10)
    v_mfma_f32_32x32x16_bf16 v[112:127], v[60:63], v[148:151], v[112:127]
    ds_read_b64_tr_b16 v[52:53], v12 offset:45312
    ds_read_b64_tr_b16 v[54:55], v12 offset:46336
    s_waitcnt lgkmcnt(10)
    v_mfma_f32_32x32x16_bf16 v[64:79], v[32:35], v[152:155], v[64:79]
    ds_read_b64_tr_b16 v[56:57], v12 offset:45568
    ds_read_b64_tr_b16 v[58:59], v12 offset:46592
    s_waitcnt lgkmcnt(10)
    v_mfma_f32_32x32x16_bf16 v[80:95], v[36:39], v[152:155], v[80:95]
    ds_read_b64_tr_b16 v[60:61], v12 offset:45824
    ds_read_b64_tr_b16 v[62:63], v12 offset:46848
    s_waitcnt lgkmcnt(10)
    v_mfma_f32_32x32x16_bf16 v[96:111], v[40:43], v[152:155], v[96:111]
    s_waitcnt lgkmcnt(8)
    v_mfma_f32_32x32x16_bf16 v[112:127], v[44:47], v[152:155], v[112:127]
    s_waitcnt lgkmcnt(6)
    v_mfma_f32_32x32x16_bf16 v[64:79], v[48:51], v[156:159], v[64:79]
    s_waitcnt lgkmcnt(4)
    v_mfma_f32_32x32x16_bf16 v[80:95], v[52:55], v[156:159], v[80:95]
    s_waitcnt lgkmcnt(2)
    v_mfma_f32_32x32x16_bf16 v[96:111], v[56:59], v[156:159], v[96:111]
    s_waitcnt lgkmcnt(0)
    v_mfma_f32_32x32x16_bf16 v[112:127], v[60:63], v[156:159], v[112:127]
    s_waitcnt vmcnt(3)
    s_barrier
    s_waitcnt vmcnt(0)
    v_max_u32 v9, v188, v189
    v_max3_u32 v9, v190, v191, v9
    v_max3_u32 v9, v220, v221, v9
    v_max3_u32 v9, v222, v223, v9
    v_max3_u32 v9, v252, v253, v9
    v_max3_u32 v9, v254, v255, v9
    v_cmp_eq_u32 vcc, -1, v9
    s_and_b64 vcc, vcc, s[48:49]
    s_nop 0
    s_cbranch_vccnz g_poll_retry
g_poll_ok:
    s_mov_b64 exec, s[46:47]
    s_add_u32 s74, s81, 524288
    buffer_load_dwordx4 v[160:163], v8, s[20:23], s74 offen offset:0
    s_mov_b64 exec, -1
    s_mov_b64 exec, s[46:47]
    s_add_u32 s74, s81, 524288
    buffer_load_dwordx4 v[164:167], v8, s[20:23], s74 offen offset:1024
    s_mov_b64 exec, -1
    s_mov_b64 exec, s[46:47]
    s_add_u32 s74, s81, 524288
    buffer_load_dwordx4 v[168:171], v8, s[20:23], s74 offen offset:2048
    s_mov_b64 exec, -1
    s_mov_b64 exec, s[46:47]
    s_add_u32 s74, s81, 524288
    buffer_load_dwordx4 v[172:175], v8, s[20:23], s74 offen offset:3072
    s_mov_b64 exec, -1
    s_mov_b64 exec, s[46:47]
    s_add_u32 s74, s81, 528384
    buffer_load_dwordx4 v[176:179], v8, s[20:23], s74 offen offset:0
    s_mov_b64 exec, -1
    s_mov_b64 exec, s[46:47]
    s_add_u32 s74, s81, 528384
    buffer_load_dwordx4 v[180:183], v8, s[20:23], s74 offen offset:1024
    s_mov_b64 exec, -1
    s_mov_b64 exec, s[46:47]
    s_add_u32 s74, s81, 528384
    buffer_load_dwordx4 v[184:187], v8, s[20:23], s74 offen offset:2048
    s_mov_b64 exec, -1
    s_mov_b64 exec, s[46:47]
    s_add_u32 s74, s84, 524288
    buffer_load_dwordx4 v[192:195], v8, s[20:23], s74 offen offset:0
    s_mov_b64 exec, -1
    s_mov_b64 exec, s[46:47]
    s_add_u32 s74, s84, 524288
    buffer_load_dwordx4 v[196:199], v8, s[20:23], s74 offen offset:1024
    s_mov_b64 exec, -1
    s_mov_b64 exec, s[46:47]
    s_add_u32 s74, s84, 524288
    buffer_load_dwordx4 v[200:203], v8, s[20:23], s74 offen offset:2048
    s_mov_b64 exec, -1
    s_mov_b64 exec, s[46:47]
    s_add_u32 s74, s84, 524288
    buffer_load_dwordx4 v[204:207], v8, s[20:23], s74 offen offset:3072
    s_mov_b64 exec, -1
    s_mov_b64 exec, s[46:47]
    s_add_u32 s74, s84, 528384
    buffer_load_dwordx4 v[208:211], v8, s[20:23], s74 offen offset:0
    s_mov_b64 exec, -1
    s_mov_b64 exec, s[46:47]
    s_add_u32 s74, s84, 528384
    buffer_load_dwordx4 v[212:215], v8, s[20:23], s74 offen offset:1024
    s_mov_b64 exec, -1
    s_mov_b64 exec, s[46:47]
    s_add_u32 s74, s84, 528384
    buffer_load_dwordx4 v[216:219], v8, s[20:23], s74 offen offset:2048
    s_mov_b64 exec, -1
    s_mov_b64 exec, s[46:47]
    s_add_u32 s74, s83, 524288
    buffer_load_dwordx4 v[224:227], v8, s[20:23], s74 offen offset:0
    s_mov_b64 exec, -1
    s_mov_b64 exec, s[46:47]
    s_add_u32 s74, s83, 524288
    buffer_load_dwordx4 v[228:231], v8, s[20:23], s74 offen offset:1024
    s_mov_b64 exec, -1
    s_mov_b64 exec, s[46:47]
    s_add_u32 s74, s83, 524288
    buffer_load_dwordx4 v[232:235], v8, s[20:23], s74 offen offset:2048
    s_mov_b64 exec, -1
    s_mov_b64 exec, s[46:47]
    s_add_u32 s74, s83, 524288
    buffer_load_dwordx4 v[236:239], v8, s[20:23], s74 offen offset:3072
    s_mov_b64 exec, -1
    s_mov_b64 exec, s[46:47]
    s_add_u32 s74, s83, 528384
    buffer_load_dwordx4 v[240:243], v8, s[20:23], s74 offen offset:0
    s_mov_b64 exec, -1
    s_mov_b64 exec, s[46:47]
    s_add_u32 s74, s83, 528384
    buffer_load_dwordx4 v[244:247], v8, s[20:23], s74 offen offset:1024
    s_mov_b64 exec, -1
    s_mov_b64 exec, s[46:47]
    s_add_u32 s74, s83, 528384
    buffer_load_dwordx4 v[248:251], v8, s[20:23], s74 offen offset:2048
    s_mov_b64 exec, -1
    ds_read_b64_tr_b16 v[32:33], v13 offset:256
    ds_read_b64_tr_b16 v[34:35], v13 offset:1280
    ds_read_b64_tr_b16 v[36:37], v13 offset:4352
    ds_read_b64_tr_b16 v[38:39], v13 offset:5376
    ds_read_b64_tr_b16 v[40:41], v13 offset:8448
    ds_read_b64_tr_b16 v[42:43], v13 offset:9472
    ds_read_b64_tr_b16 v[44:45], v13 offset:12544
    ds_read_b64_tr_b16 v[46:47], v13 offset:13568
    ds_read_b64_tr_b16 v[48:49], v12 offset:256
    ds_read_b64_tr_b16 v[50:51], v12 offset:1280
    ds_read_b64_tr_b16 v[52:53], v12 offset:4352
    ds_read_b64_tr_b16 v[54:55], v12 offset:5376
    s_waitcnt vmcnt(14)
    v_max_u32 v9, v160, v161
    v_max3_u32 v9, v162, v163, v9
    v_max3_u32 v9, v164, v165, v9
    v_max3_u32 v9, v166, v167, v9
    v_max3_u32 v9, v168, v169, v9
    v_max3_u32 v9, v170, v171, v9
    v_max3_u32 v9, v172, v173, v9
    v_max3_u32 v9, v174, v175, v9
    v_max3_u32 v9, v176, v177, v9
    v_max3_u32 v9, v178, v179, v9
    v_max3_u32 v9, v180, v181, v9
    v_max3_u32 v9, v182, v183, v9
    v_max3_u32 v9, v184, v185, v9
    v_max3_u32 v9, v186, v187, v9
    v_max3_u32 v9, v188, v189, v9
    v_max3_u32 v9, v190, v191, v9
    v_cmp_eq_u32 vcc, -1, v9
    s_and_b64 vcc, vcc, s[48:49]
    s_nop 0
    s_cbranch_vccnz g_o1_retry
g_o1_ok:
    s_waitcnt lgkmcnt(10)
    v_mfma_f32_32x32x16_bf16 v[80:95], v[32:35], v[160:163], v[80:95]
    ds_read_b64_tr_b16 v[56:57], v12 offset:8448
    ds_read_b64_tr_b16 v[58:59], v12 offset:9472
    s_waitcnt lgkmcnt(10)
    v_mfma_f32_32x32x16_bf16 v[80:95], v[36:39], v[164:167], v[80:95]
    ds_read_b64_tr_b16 v[60:61], v12 offset:12544
    ds_read_b64_tr_b16 v[62:63], v12 offset:13568
    s_waitcnt lgkmcnt(10)
    v_mfma_f32_32x32x16_bf16 v[80:95], v[40:43], v[168:171], v[80:95]
    ds_read_b64_tr_b16 v[32:33], v12 offset:16640
    ds_read_b64_tr_b16 v[34:35], v12 offset:17664
    s_waitcnt vmcnt(7)
    v_max_u32 v9, v192, v193
    v_max3_u32 v9, v194, v195, v9
    s_waitcnt lgkmcnt(10)
    v_mfma_f32_32x32x16_bf16 v[80:95], v[44:47], v[172:175], v[80:95]
    ds_read_b64_tr_b16 v[36:37], v12 offset:20736
    ds_read_b64_tr_b16 v[38:39], v12 offset:21760
    v_max3_u32 v9, v196, v197, v9
    v_max3_u32 v9, v198, v199, v9
    v_max3_u32 v9, v200, v201, v9
    s_waitcnt lgkmcnt(10)
    v_mfma_f32_32x32x16_bf16 v[80:95], v[48:51], v[176:179], v[80:95]
    ds_read_b64_tr_b16 v[40:41], v12 offset:24832
    ds_read_b64_tr_b16 v[42:43], v12 offset:25856
    v_max3_u32 v9, v202, v203, v9
    v_max3_u32 v9, v204, v205, v9
    v_max3_u32 v9, v206, v207, v9
    v_max3_u32 v9, v208, v209, v9
    s_waitcnt lgkmcnt(10)
    v_mfma_f32_32x32x16_bf16 v[80:95], v[52:55], v[180:183], v[80:95]
    ds_read_b64_tr_b16 v[44:45], v12 offset:28928
    ds_read_b64_tr_b16 v[46:47], v12 offset:29952
    v_max3_u32 v9, v210, v211, v9
    v_max3_u32 v9, v212, v213, v9
    v_max3_u32 v9, v214, v215, v9
    s_waitcnt lgkmcnt(10)
    v_mfma_f32_32x32x16_bf16 v[80:95], v[56:59], v[184:187], v[80:95]
    ds_read_b64_tr_b16 v[48:49], v11 offset:16640
    ds_read_b64_tr_b16 v[50:51], v11 offset:17664
    v_max3_u32 v9, v216, v217, v9
    v_max3_u32 v9, v218, v219, v9
    v_max3_u32 v9, v220, v221, v9
    s_waitcnt lgkmcnt(10)
    v_mfma_f32_32x32x16_bf16 v[80:95], v[60:63], v[188:191], v[80:95]
    ds_read_b64_tr_b16 v[52:53], v11 offset:20736
    ds_read_b64_tr_b16 v[54:55], v11 offset:21760
    v_max3_u32 v9, v222, v223, v9
    v_cmp_eq_u32 vcc, -1, v9
    s_and_b64 vcc, vcc, s[48:49]
    s_nop 0
    s_cbranch_vccnz g_o2_retry
g_o2_ok:
    s_waitcnt lgkmcnt(10)
    v_mfma_f32_32x32x16_bf16 v[80:95], v[32:35], v[192:195], v[80:95]
    ds_read_b64_tr_b16 v[56:57], v11 offset:24832
    ds_read_b64_tr_b16 v[58:59], v11 offset:25856
    s_waitcnt lgkmcnt(10)
    v_mfma_f32_32x32x16_bf16 v[80:95], v[36:39], v[196:199], v[80:95]
    ds_read_b64_tr_b16 v[60:61], v11 offset:28928
    ds_read_b64_tr_b16 v[62:63], v11 offset:29952
    s_waitcnt lgkmcnt(10)
    v_mfma_f32_32x32x16_bf16 v[80:95], v[40:43], v[200:203], v[80:95]
    ds_read_b64_tr_b16 v[32:33], v11 offset:49408
    ds_read_b64_tr_b16 v[34:35], v11 offset:50432
    s_waitcnt vmcnt(0)
    v_max_u32 v9, v224, v225
    v_max3_u32 v9, v226, v227, v9
    s_waitcnt lgkmcnt(10)
    v_mfma_f32_32x32x16_bf16 v[80:95], v[44:47], v[204:207], v[80:95]
    ds_read_b64_tr_b16 v[36:37], v11 offset:53504
    ds_read_b64_tr_b16 v[38:39], v11 offset:54528
    v_max3_u32 v9, v228, v229, v9
    v_max3_u32 v9, v230, v231, v9
    v_max3_u32 v9, v232, v233, v9
    s_waitcnt lgkmcnt(10)
    v_mfma_f32_32x32x16_bf16 v[80:95], v[48:51], v[208:211], v[80:95]
    ds_read_b64_tr_b16 v[40:41], v11 offset:57600
    ds_read_b64_tr_b16 v[42:43], v11 offset:58624
    v_max3_u32 v9, v234, v235, v9
    v_max3_u32 v9, v236, v237, v9
    v_max3_u32 v9, v238, v239, v9
    v_max3_u32 v9, v240, v241, v9
    s_waitcnt lgkmcnt(10)
    v_mfma_f32_32x32x16_bf16 v[80:95], v[52:55], v[212:215], v[80:95]
    ds_read_b64_tr_b16 v[44:45], v11 offset:61696
    ds_read_b64_tr_b16 v[46:47], v11 offset:62720
    v_max3_u32 v9, v242, v243, v9
    v_max3_u32 v9, v244, v245, v9
    v_max3_u32 v9, v246, v247, v9
    s_waitcnt lgkmcnt(10)
    v_mfma_f32_32x32x16_bf16 v[80:95], v[56:59], v[216:219], v[80:95]
    ds_read_b64_tr_b16 v[48:49], v12 offset:49408
    ds_read_b64_tr_b16 v[50:51], v12 offset:50432
    v_max3_u32 v9, v248, v249, v9
    v_max3_u32 v9, v250, v251, v9
    v_max3_u32 v9, v252, v253, v9
    s_waitcnt lgkmcnt(10)
    v_mfma_f32_32x32x16_bf16 v[80:95], v[60:63], v[220:223], v[80:95]
    ds_read_b64_tr_b16 v[52:53], v12 offset:53504
    ds_read_b64_tr_b16 v[54:55], v12 offset:54528
    v_max3_u32 v9, v254, v255, v9
    v_cmp_eq_u32 vcc, -1, v9
    s_and_b64 vcc, vcc, s[48:49]
    s_nop 0
    s_cbranch_vccnz g_o3_retry
g_o3_ok:
    s_waitcnt lgkmcnt(10)
    v_mfma_f32_32x32x16_bf16 v[80:95], v[32:35], v[224:227], v[80:95]
    ds_read_b64_tr_b16 v[56:57], v12 offset:57600
    ds_read_b64_tr_b16 v[58:59], v12 offset:58624
    s_waitcnt lgkmcnt(10)
    v_mfma_f32_32x32x16_bf16 v[80:95], v[36:39], v[228:231], v[80:95]
    ds_read_b64_tr_b16 v[60:61], v12 offset:61696
    ds_read_b64_tr_b16 v[62:63], v12 offset:62720
    s_waitcnt lgkmcnt(10)
    v_mfma_f32_32x32x16_bf16 v[80:95], v[40:43], v[232:235], v[80:95]
    ds_read_b64_tr_b16 v[32:33], v13 offset:512
    ds_read_b64_tr_b16 v[34:35], v13 offset:1536
    s_waitcnt lgkmcnt(10)
    v_mfma_f32_32x32x16_bf16 v[80:95], v[44:47], v[236:239], v[80:95]
    ds_read_b64_tr_b16 v[36:37], v13 offset:4608
    ds_read_b64_tr_b16 v[38:39], v13 offset:5632
    s_waitcnt lgkmcnt(10)
    v_mfma_f32_32x32x16_bf16 v[80:95], v[48:51], v[240:243], v[80:95]
    ds_read_b64_tr_b16 v[40:41], v13 offset:8704
    ds_read_b64_tr_b16 v[42:43], v13 offset:9728
    s_waitcnt lgkmcnt(10)
    v_mfma_f32_32x32x16_bf16 v[80:95], v[52:55], v[244:247], v[80:95]
    ds_read_b64_tr_b16 v[44:45], v13 offset:12800
    ds_read_b64_tr_b16 v[46:47], v13 offset:13824
    s_waitcnt lgkmcnt(10)
    v_mfma_f32_32x32x16_bf16 v[80:95], v[56:59], v[248:251], v[80:95]
    ds_read_b64_tr_b16 v[48:49], v12 offset:512
    ds_read_b64_tr_b16 v[50:51], v12 offset:1536
    s_waitcnt lgkmcnt(10)
    v_mfma_f32_32x32x16_bf16 v[80:95], v[60:63], v[252:255], v[80:95]
    ds_read_b64_tr_b16 v[52:53], v12 offset:4608
    ds_read_b64_tr_b16 v[54:55], v12 offset:5632
    s_waitcnt lgkmcnt(10)
    v_mfma_f32_32x32x16_bf16 v[96:111], v[32:35], v[160:163], v[96:111]
    ds_read_b64_tr_b16 v[56:57], v12 offset:8704
    ds_read_b64_tr_b16 v[58:59], v12 offset:9728
    s_waitcnt lgkmcnt(10)
    v_mfma_f32_32x32x16_bf16 v[96:111], v[36:39], v[164:167], v[96:111]
    ds_read_b64_tr_b16 v[60:61], v12 offset:12800
    ds_read_b64_tr_b16 v[62:63], v12 offset:13824
    s_nop 1
    v_cvt_pk_bf16_f32 v80, v80, v81
    v_cvt_pk_bf16_f32 v81, v82, v83
    v_cvt_pk_bf16_f32 v82, v84, v85
    v_cvt_pk_bf16_f32 v83, v86, v87
    v_cvt_pk_bf16_f32 v88, v88, v89
    v_cvt_pk_bf16_f32 v89, v90, v91
    v_cvt_pk_bf16_f32 v90, v92, v93
    s_waitcnt lgkmcnt(10)
    v_mfma_f32_32x32x16_bf16 v[96:111], v[40:43], v[168:171], v[96:111]
    ds_read_b64_tr_b16 v[32:33], v12 offset:16896
    ds_read_b64_tr_b16 v[34:35], v12 offset:17920
    v_cvt_pk_bf16_f32 v91, v94, v95
    v_permlane32_swap_b32 v80, v82
    v_permlane32_swap_b32 v81, v83
    v_permlane32_swap_b32 v88, v90
    v_permlane32_swap_b32 v89, v91
    s_mov_b64 exec, s[46:47]
    buffer_store_dwordx4 v[80:83], v8, s[20:23], s89 offen offset:0 sc1
    s_mov_b64 exec, -1
    s_mov_b64 exec, s[46:47]
    buffer_store_dwordx4 v[88:91], v8, s[20:23], s89 offen offset:1024 sc1
    s_mov_b64 exec, -1
    s_waitcnt lgkmcnt(10)
    v_mfma_f32_32x32x16_bf16 v[96:111], v[44:47], v[172:175], v[96:111]
    ds_read_b64_tr_b16 v[36:37], v12 offset:20992
    ds_read_b64_tr_b16 v[38:39], v12 offset:22016
    s_waitcnt lgkmcnt(10)
    v_mfma_f32_32x32x16_bf16 v[96:111], v[48:51], v[176:179], v[96:111]
    ds_read_b64_tr_b16 v[40:41], v12 offset:25088
    ds_read_b64_tr_b16 v[42:43], v12 offset:26112
    v_mbcnt_lo_u32_b32 v10, -1, 0
    v_mbcnt_hi_u32_b32 v10, -1, v10
    s_waitcnt lgkmcnt(10)
    v_mfma_f32_32x32x16_bf16 v[96:111], v[52:55], v[180:183], v[96:111]
    ds_read_b64_tr_b16 v[44:45], v12 offset:29184
    ds_read_b64_tr_b16 v[46:47], v12 offset:30208
    v_lshrrev_b32 v20, 5, v10
    v_and_b32 v10, 31, v10
    s_waitcnt lgkmcnt(10)
    v_mfma_f32_32x32x16_bf16 v[96:111], v[56:59], v[184:187], v[96:111]
    ds_read_b64_tr_b16 v[48:49], v11 offset:16896
    ds_read_b64_tr_b16 v[50:51], v11 offset:17920
    v_lshlrev_b32 v20, 3, v20
    v_sub_u32 v10, v10, v20
    s_waitcnt lgkmcnt(10)
    v_mfma_f32_32x32x16_bf16 v[96:111], v[60:63], v[188:191], v[96:111]
    ds_read_b64_tr_b16 v[52:53], v11 offset:20992
    ds_read_b64_tr_b16 v[54:55], v11 offset:22016
    v_mov_b32 v20, 0x3f80
    v_mov_b32 v21, 0x3f800000
    s_waitcnt lgkmcnt(10)
    v_mfma_f32_32x32x16_bf16 v[96:111], v[32:35], v[192:195], v[96:111]
    ds_read_b64_tr_b16 v[56:57], v11 offset:25088
    ds_read_b64_tr_b16 v[58:59], v11 offset:26112
    v_cmp_eq_u32 vcc, 0, v10
    v_cndmask_b32 v128, 0, v20, vcc
    v_cmp_eq_u32 vcc, 1, v10
    s_waitcnt lgkmcnt(10)
    v_mfma_f32_32x32x16_bf16 v[96:111], v[36:39], v[196:199], v[96:111]
    ds_read_b64_tr_b16 v[60:61], v11 offset:29184
    ds_read_b64_tr_b16 v[62:63], v11 offset:30208
    v_cndmask_b32 v128, v128, v21, vcc
    v_cmp_eq_u32 vcc, 2, v10
    s_waitcnt lgkmcnt(10)
    v_mfma_f32_32x32x16_bf16 v[96:111], v[40:43], v[200:203], v[96:111]
    ds_read_b64_tr_b16 v[32:33], v11 offset:49664
    ds_read_b64_tr_b16 v[34:35], v11 offset:50688
    v_cndmask_b32 v129, 0, v20, vcc
    v_cmp_eq_u32 vcc, 3, v10
    s_waitcnt lgkmcnt(10)
    v_mfma_f32_32x32x16_bf16 v[96:111], v[44:47], v[204:207], v[96:111]
    ds_read_b64_tr_b16 v[36:37], v11 offset:53760
    ds_read_b64_tr_b16 v[38:39], v11 offset:54784
    v_cndmask_b32 v129, v129, v21, vcc
    v_cmp_eq_u32 vcc, 4, v10
    s_waitcnt lgkmcnt(10)
    v_mfma_f32_32x32x16_bf16 v[96:111], v[48:51], v[208:211], v[96:111]
    ds_read_b64_tr_b16 v[40:41], v11 offset:57856
    ds_read_b64_tr_b16 v[42:43], v11 offset:58880
    v_cndmask_b32 v130, 0, v20, vcc
    v_cmp_eq_u32 vcc, 5, v10
    v_cndmask_b32 v130, v130, v21, vcc
    s_waitcnt lgkmcnt(10)
    v_mfma_f32_32x32x16_bf16 v[96:111], v[52:55], v[212:215], v[96:111]
    ds_read_b64_tr_b16 v[44:45], v11 offset:61952
    ds_read_b64_tr_b16 v[46:47], v11 offset:62976
    v_cmp_eq_u32 vcc, 6, v10
    v_cndmask_b32 v131, 0, v20, vcc
    s_waitcnt lgkmcnt(10)
    v_mfma_f32_32x32x16_bf16 v[96:111], v[56:59], v[216:219], v[96:111]
    ds_read_b64_tr_b16 v[48:49], v12 offset:49664
    ds_read_b64_tr_b16 v[50:51], v12 offset:50688
    v_cmp_eq_u32 vcc, 7, v10
    v_cndmask_b32 v131, v131, v21, vcc
    s_waitcnt lgkmcnt(10)
    v_mfma_f32_32x32x16_bf16 v[96:111], v[60:63], v[220:223], v[96:111]
    ds_read_b64_tr_b16 v[52:53], v12 offset:53760
    ds_read_b64_tr_b16 v[54:55], v12 offset:54784
    v_cmp_eq_u32 vcc, 16, v10
    v_cndmask_b32 v132, 0, v20, vcc
    s_waitcnt lgkmcnt(10)
    v_mfma_f32_32x32x16_bf16 v[96:111], v[32:35], v[224:227], v[96:111]
    ds_read_b64_tr_b16 v[56:57], v12 offset:57856
    ds_read_b64_tr_b16 v[58:59], v12 offset:58880
    v_cmp_eq_u32 vcc, 17, v10
    v_cndmask_b32 v132, v132, v21, vcc
    s_waitcnt lgkmcnt(10)
    v_mfma_f32_32x32x16_bf16 v[96:111], v[36:39], v[228:231], v[96:111]
    ds_read_b64_tr_b16 v[60:61], v12 offset:61952
    ds_read_b64_tr_b16 v[62:63], v12 offset:62976
    v_cmp_eq_u32 vcc, 18, v10
    v_cndmask_b32 v133, 0, v20, vcc
    v_cmp_eq_u32 vcc, 19, v10
    s_waitcnt lgkmcnt(10)
    v_mfma_f32_32x32x16_bf16 v[96:111], v[40:43], v[232:235], v[96:111]
    ds_read_b64_tr_b16 v[32:33], v13 offset:768
    ds_read_b64_tr_b16 v[34:35], v13 offset:1792
    v_cndmask_b32 v133, v133, v21, vcc
    v_cmp_eq_u32 vcc, 20, v10
    s_waitcnt lgkmcnt(10)
    v_mfma_f32_32x32x16_bf16 v[96:111], v[44:47], v[236:239], v[96:111]
    ds_read_b64_tr_b16 v[36:37], v13 offset:4864
    ds_read_b64_tr_b16 v[38:39], v13 offset:5888
    v_cndmask_b32 v134, 0, v20, vcc
    v_cmp_eq_u32 vcc, 21, v10
    s_waitcnt lgkmcnt(10)
    v_mfma_f32_32x32x16_bf16 v[96:111], v[48:51], v[240:243], v[96:111]
    ds_read_b64_tr_b16 v[40:41], v13 offset:8960
    ds_read_b64_tr_b16 v[42:43], v13 offset:9984
    v_cndmask_b32 v134, v134, v21, vcc
    v_cmp_eq_u32 vcc, 22, v10
    s_waitcnt lgkmcnt(10)
    v_mfma_f32_32x32x16_bf16 v[96:111], v[52:55], v[244:247], v[96:111]
    ds_read_b64_tr_b16 v[44:45], v13 offset:13056
    ds_read_b64_tr_b16 v[46:47], v13 offset:14080
    v_cndmask_b32 v135, 0, v20, vcc
    v_cmp_eq_u32 vcc, 23, v10
    v_cndmask_b32 v135, v135, v21, vcc
    s_waitcnt lgkmcnt(10)
    v_mfma_f32_32x32x16_bf16 v[96:111], v[56:59], v[248:251], v[96:111]
    ds_read_b64_tr_b16 v[48:49], v12 offset:768
    ds_read_b64_tr_b16 v[50:51], v12 offset:1792
    s_waitcnt lgkmcnt(10)
    v_mfma_f32_32x32x16_bf16 v[96:111], v[60:63], v[252:255], v[96:111]
    ds_read_b64_tr_b16 v[52:53], v12 offset:4864
    ds_read_b64_tr_b16 v[54:55], v12 offset:5888
    s_waitcnt lgkmcnt(10)
    v_mfma_f32_32x32x16_bf16 v[112:127], v[32:35], v[160:163], v[112:127]
    ds_read_b64_tr_b16 v[56:57], v12 offset:8960
    ds_read_b64_tr_b16 v[58:59], v12 offset:9984
    s_waitcnt lgkmcnt(10)
    v_mfma_f32_32x32x16_bf16 v[112:127], v[36:39], v[164:167], v[112:127]
    ds_read_b64_tr_b16 v[60:61], v12 offset:13056
    ds_read_b64_tr_b16 v[62:63], v12 offset:14080
    s_nop 1
    v_cvt_pk_bf16_f32 v96, v96, v97
    v_cvt_pk_bf16_f32 v97, v98, v99
    v_cvt_pk_bf16_f32 v98, v100, v101
    v_cvt_pk_bf16_f32 v99, v102, v103
    v_cvt_pk_bf16_f32 v104, v104, v105
    v_cvt_pk_bf16_f32 v105, v106, v107
    v_cvt_pk_bf16_f32 v106, v108, v109
    s_waitcnt lgkmcnt(10)
    v_mfma_f32_32x32x16_bf16 v[112:127], v[40:43], v[168:171], v[112:127]
    ds_read_b64_tr_b16 v[32:33], v12 offset:17152
    ds_read_b64_tr_b16 v[34:35], v12 offset:18176
    v_cvt_pk_bf16_f32 v107, v110, v111
    v_permlane32_swap_b32 v96, v98
    v_permlane32_swap_b32 v97, v99
    v_permlane32_swap_b32 v104, v106
    v_permlane32_swap_b32 v105, v107
    s_mov_b64 exec, s[46:47]
    buffer_store_dwordx4 v[96:99], v8, s[20:23], s90 offen offset:0 sc1
    s_mov_b64 exec, -1
    s_mov_b64 exec, s[46:47]
    buffer_store_dwordx4 v[104:107], v8, s[20:23], s90 offen offset:1024 sc1
    s_mov_b64 exec, -1
    s_waitcnt lgkmcnt(10)
    v_mfma_f32_32x32x16_bf16 v[112:127], v[44:47], v[172:175], v[112:127]
    ds_read_b64_tr_b16 v[36:37], v12 offset:21248
    ds_read_b64_tr_b16 v[38:39], v12 offset:22272
    s_waitcnt lgkmcnt(10)
    v_mfma_f32_32x32x16_bf16 v[112:127], v[48:51], v[176:179], v[112:127]
    ds_read_b64_tr_b16 v[40:41], v12 offset:25344
    ds_read_b64_tr_b16 v[42:43], v12 offset:26368
    s_waitcnt lgkmcnt(10)
    v_mfma_f32_32x32x16_bf16 v[112:127], v[52:55], v[180:183], v[112:127]
    ds_read_b64_tr_b16 v[44:45], v12 offset:29440
    ds_read_b64_tr_b16 v[46:47], v12 offset:30464
    s_waitcnt lgkmcnt(10)
    v_mfma_f32_32x32x16_bf16 v[112:127], v[56:59], v[184:187], v[112:127]
    ds_read_b64_tr_b16 v[48:49], v11 offset:17152
    ds_read_b64_tr_b16 v[50:51], v11 offset:18176
    s_waitcnt lgkmcnt(10)
    v_mfma_f32_32x32x16_bf16 v[112:127], v[60:63], v[188:191], v[112:127]
    ds_read_b64_tr_b16 v[52:53], v11 offset:21248
    ds_read_b64_tr_b16 v[54:55], v11 offset:22272
    s_waitcnt lgkmcnt(10)
    v_mfma_f32_32x32x16_bf16 v[112:127], v[32:35], v[192:195], v[112:127]
    ds_read_b64_tr_b16 v[56:57], v11 offset:25344
    ds_read_b64_tr_b16 v[58:59], v11 offset:26368
    s_waitcnt lgkmcnt(10)
    v_mfma_f32_32x32x16_bf16 v[112:127], v[36:39], v[196:199], v[112:127]
    ds_read_b64_tr_b16 v[60:61], v11 offset:29440
    ds_read_b64_tr_b16 v[62:63], v11 offset:30464
    s_waitcnt lgkmcnt(10)
    v_mfma_f32_32x32x16_bf16 v[112:127], v[40:43], v[200:203], v[112:127]
    ds_read_b64_tr_b16 v[32:33], v11 offset:49920
    ds_read_b64_tr_b16 v[34:35], v11 offset:50944
    s_waitcnt lgkmcnt(10)
    v_mfma_f32_32x32x16_bf16 v[112:127], v[44:47], v[204:207], v[112:127]
    ds_read_b64_tr_b16 v[36:37], v11 offset:54016
    ds_read_b64_tr_b16 v[38:39], v11 offset:55040
    s_waitcnt lgkmcnt(10)
    v_mfma_f32_32x32x16_bf16 v[112:127], v[48:51], v[208:211], v[112:127]
    ds_read_b64_tr_b16 v[40:41], v11 offset:58112
    ds_read_b64_tr_b16 v[42:43], v11 offset:59136
    s_waitcnt lgkmcnt(10)
    v_mfma_f32_32x32x16_bf16 v[112:127], v[52:55], v[212:215], v[112:127]
    ds_read_b64_tr_b16 v[44:45], v11 offset:62208
    ds_read_b64_tr_b16 v[46:47], v11 offset:63232
    s_waitcnt lgkmcnt(10)
    v_mfma_f32_32x32x16_bf16 v[112:127], v[56:59], v[216:219], v[112:127]
    ds_read_b64_tr_b16 v[48:49], v12 offset:49920
    ds_read_b64_tr_b16 v[50:51], v12 offset:50944
    s_waitcnt lgkmcnt(10)
    v_mfma_f32_32x32x16_bf16 v[112:127], v[60:63], v[220:223], v[112:127]
    ds_read_b64_tr_b16 v[52:53], v12 offset:54016
    ds_read_b64_tr_b16 v[54:55], v12 offset:55040
    s_waitcnt lgkmcnt(10)
    v_mfma_f32_32x32x16_bf16 v[112:127], v[32:35], v[224:227], v[112:127]
    ds_read_b64_tr_b16 v[56:57], v12 offset:58112
    ds_read_b64_tr_b16 v[58:59], v12 offset:59136
    s_waitcnt lgkmcnt(10)
    v_mfma_f32_32x32x16_bf16 v[112:127], v[36:39], v[228:231], v[112:127]
    ds_read_b64_tr_b16 v[60:61], v12 offset:62208
    ds_read_b64_tr_b16 v[62:63], v12 offset:63232
    s_waitcnt lgkmcnt(10)
    v_mfma_f32_32x32x16_bf16 v[112:127], v[40:43], v[232:235], v[112:127]
    ds_read_b64_tr_b16 v[32:33], v13 offset:0
    ds_read_b64_tr_b16 v[34:35], v13 offset:1024
    s_waitcnt lgkmcnt(10)
    v_mfma_f32_32x32x16_bf16 v[112:127], v[44:47], v[236:239], v[112:127]
    ds_read_b64_tr_b16 v[36:37], v13 offset:4096
    ds_read_b64_tr_b16 v[38:39], v13 offset:5120
    s_waitcnt lgkmcnt(10)
    v_mfma_f32_32x32x16_bf16 v[112:127], v[48:51], v[240:243], v[112:127]
    ds_read_b64_tr_b16 v[40:41], v13 offset:8192
    ds_read_b64_tr_b16 v[42:43], v13 offset:9216
    s_waitcnt lgkmcnt(10)
    v_mfma_f32_32x32x16_bf16 v[112:127], v[52:55], v[244:247], v[112:127]
    ds_read_b64_tr_b16 v[44:45], v13 offset:12288
    ds_read_b64_tr_b16 v[46:47], v13 offset:13312
    s_waitcnt lgkmcnt(10)
    v_mfma_f32_32x32x16_bf16 v[112:127], v[56:59], v[248:251], v[112:127]
    ds_read_b64_tr_b16 v[48:49], v12 offset:0
    ds_read_b64_tr_b16 v[50:51], v12 offset:1024
    s_waitcnt lgkmcnt(10)
    v_mfma_f32_32x32x16_bf16 v[112:127], v[60:63], v[252:255], v[112:127]
    ds_read_b64_tr_b16 v[52:53], v12 offset:4096
    ds_read_b64_tr_b16 v[54:55], v12 offset:5120
    s_waitcnt lgkmcnt(10)
    v_mfma_f32_32x32x16_bf16 v[64:79], v[32:35], v[160:163], v[64:79]
    ds_read_b64_tr_b16 v[56:57], v12 offset:8192
    ds_read_b64_tr_b16 v[58:59], v12 offset:9216
    s_waitcnt lgkmcnt(10)
    v_mfma_f32_32x32x16_bf16 v[64:79], v[36:39], v[164:167], v[64:79]
    ds_read_b64_tr_b16 v[60:61], v12 offset:12288
    ds_read_b64_tr_b16 v[62:63], v12 offset:13312
    s_nop 1
    v_cvt_pk_bf16_f32 v112, v112, v113
    v_cvt_pk_bf16_f32 v113, v114, v115
    v_cvt_pk_bf16_f32 v114, v116, v117
    v_cvt_pk_bf16_f32 v115, v118, v119
    v_cvt_pk_bf16_f32 v120, v120, v121
    v_cvt_pk_bf16_f32 v121, v122, v123
    v_cvt_pk_bf16_f32 v122, v124, v125
    s_waitcnt lgkmcnt(10)
    v_mfma_f32_32x32x16_bf16 v[64:79], v[40:43], v[168:171], v[64:79]
    ds_read_b64_tr_b16 v[32:33], v12 offset:16384
    ds_read_b64_tr_b16 v[34:35], v12 offset:17408
    v_cvt_pk_bf16_f32 v123, v126, v127
    v_permlane32_swap_b32 v112, v114
    v_permlane32_swap_b32 v113, v115
    v_permlane32_swap_b32 v120, v122
    v_permlane32_swap_b32 v121, v123
    s_mov_b64 exec, s[46:47]
    buffer_store_dwordx4 v[112:115], v8, s[20:23], s91 offen offset:0 sc1
    s_mov_b64 exec, -1
    s_mov_b64 exec, s[46:47]
    buffer_store_dwordx4 v[120:123], v8, s[20:23], s91 offen offset:1024 sc1
    s_mov_b64 exec, -1
    s_waitcnt lgkmcnt(10)
    v_mfma_f32_32x32x16_bf16 v[64:79], v[44:47], v[172:175], v[64:79]
    ds_read_b64_tr_b16 v[36:37], v12 offset:20480
    ds_read_b64_tr_b16 v[38:39], v12 offset:21504
    s_waitcnt lgkmcnt(10)
    v_mfma_f32_32x32x16_bf16 v[64:79], v[48:51], v[176:179], v[64:79]
    ds_read_b64_tr_b16 v[40:41], v12 offset:24576
    ds_read_b64_tr_b16 v[42:43], v12 offset:25600
    s_waitcnt lgkmcnt(10)
    v_mfma_f32_32x32x16_bf16 v[64:79], v[52:55], v[180:183], v[64:79]
    ds_read_b64_tr_b16 v[44:45], v12 offset:28672
    ds_read_b64_tr_b16 v[46:47], v12 offset:29696
    s_waitcnt lgkmcnt(10)
    v_mfma_f32_32x32x16_bf16 v[64:79], v[56:59], v[184:187], v[64:79]
    ds_read_b64_tr_b16 v[48:49], v11 offset:16384
    ds_read_b64_tr_b16 v[50:51], v11 offset:17408
    s_waitcnt lgkmcnt(10)
    v_mfma_f32_32x32x16_bf16 v[64:79], v[60:63], v[188:191], v[64:79]
    ds_read_b64_tr_b16 v[52:53], v11 offset:20480
    ds_read_b64_tr_b16 v[54:55], v11 offset:21504
    s_waitcnt lgkmcnt(10)
    v_mfma_f32_32x32x16_bf16 v[64:79], v[32:35], v[192:195], v[64:79]
    ds_read_b64_tr_b16 v[56:57], v11 offset:24576
    ds_read_b64_tr_b16 v[58:59], v11 offset:25600
    s_waitcnt lgkmcnt(10)
    v_mfma_f32_32x32x16_bf16 v[64:79], v[36:39], v[196:199], v[64:79]
    ds_read_b64_tr_b16 v[60:61], v11 offset:28672
    ds_read_b64_tr_b16 v[62:63], v11 offset:29696
    s_waitcnt lgkmcnt(10)
    v_mfma_f32_32x32x16_bf16 v[64:79], v[40:43], v[200:203], v[64:79]
    ds_read_b64_tr_b16 v[32:33], v11 offset:49152
    ds_read_b64_tr_b16 v[34:35], v11 offset:50176
    s_waitcnt lgkmcnt(10)
    v_mfma_f32_32x32x16_bf16 v[64:79], v[44:47], v[204:207], v[64:79]
    ds_read_b64_tr_b16 v[36:37], v11 offset:53248
    ds_read_b64_tr_b16 v[38:39], v11 offset:54272
    s_waitcnt lgkmcnt(10)
    v_mfma_f32_32x32x16_bf16 v[64:79], v[48:51], v[208:211], v[64:79]
    ds_read_b64_tr_b16 v[40:41], v11 offset:57344
    ds_read_b64_tr_b16 v[42:43], v11 offset:58368
    s_waitcnt lgkmcnt(10)
    v_mfma_f32_32x32x16_bf16 v[64:79], v[52:55], v[212:215], v[64:79]
    ds_read_b64_tr_b16 v[44:45], v11 offset:61440
    ds_read_b64_tr_b16 v[46:47], v11 offset:62464
    s_waitcnt lgkmcnt(10)
    v_mfma_f32_32x32x16_bf16 v[64:79], v[56:59], v[216:219], v[64:79]
    ds_read_b64_tr_b16 v[48:49], v12 offset:49152
    ds_read_b64_tr_b16 v[50:51], v12 offset:50176
    s_waitcnt lgkmcnt(10)
    v_mfma_f32_32x32x16_bf16 v[64:79], v[60:63], v[220:223], v[64:79]
    ds_read_b64_tr_b16 v[52:53], v12 offset:53248
    ds_read_b64_tr_b16 v[54:55], v12 offset:54272
    s_waitcnt lgkmcnt(10)
    v_mfma_f32_32x32x16_bf16 v[64:79], v[32:35], v[224:227], v[64:79]
    ds_read_b64_tr_b16 v[56:57], v12 offset:57344
    ds_read_b64_tr_b16 v[58:59], v12 offset:58368
    s_waitcnt lgkmcnt(10)
    v_mfma_f32_32x32x16_bf16 v[64:79], v[36:39], v[228:231], v[64:79]
    ds_read_b64_tr_b16 v[60:61], v12 offset:61440
    ds_read_b64_tr_b16 v[62:63], v12 offset:62464
    s_waitcnt lgkmcnt(10)
    v_mfma_f32_32x32x16_bf16 v[64:79], v[40:43], v[232:235], v[64:79]
    s_waitcnt lgkmcnt(8)
    v_mfma_f32_32x32x16_bf16 v[64:79], v[44:47], v[236:239], v[64:79]
    s_waitcnt lgkmcnt(6)
    v_mfma_f32_32x32x16_bf16 v[64:79], v[48:51], v[240:243], v[64:79]
    s_mov_b64 exec, s[46:47]
    s_add_u32 s74, s92, 49152
    buffer_load_dwordx4 v[152:155], v8, s[20:23], s74 offen offset:0 sc1
    s_mov_b64 exec, -1
    s_mov_b64 exec, s[46:47]
    s_add_u32 s74, s92, 49152
    buffer_load_dwordx4 v[156:159], v8, s[20:23], s74 offen offset:1024 sc1
    s_mov_b64 exec, -1
    s_mov_b64 exec, s[46:47]
    s_add_u32 s74, s92, 32768
    buffer_load_dwordx4 v[144:147], v8, s[20:23], s74 offen offset:0 sc1
    s_mov_b64 exec, -1
    s_mov_b64 exec, s[46:47]
    s_add_u32 s74, s92, 32768
    buffer_load_dwordx4 v[148:151], v8, s[20:23], s74 offen offset:1024 sc1
    s_mov_b64 exec, -1
    s_mov_b64 exec, s[46:47]
    s_add_u32 s74, s92, 16384
    buffer_load_dwordx4 v[136:139], v8, s[20:23], s74 offen offset:0 sc1
    s_mov_b64 exec, -1
    s_mov_b64 exec, s[46:47]
    s_add_u32 s74, s92, 16384
    buffer_load_dwordx4 v[140:143], v8, s[20:23], s74 offen offset:1024 sc1
    s_mov_b64 exec, -1
    s_waitcnt lgkmcnt(4)
    v_mfma_f32_32x32x16_bf16 v[64:79], v[52:55], v[244:247], v[64:79]
    s_waitcnt lgkmcnt(2)
    v_mfma_f32_32x32x16_bf16 v[64:79], v[56:59], v[248:251], v[64:79]
    s_waitcnt lgkmcnt(0)
    v_mfma_f32_32x32x16_bf16 v[64:79], v[60:63], v[252:255], v[64:79]
    s_waitcnt vmcnt(4)
    v_max_u32 v9, v152, v153
    v_max3_u32 v9, v154, v155, v9
    v_max3_u32 v9, v156, v157, v9
    v_max3_u32 v9, v158, v159, v9
    v_cmp_eq_u32 vcc, -1, v9
    s_and_b64 vcc, vcc, s[48:49]
    s_nop 0
    s_cbranch_vccnz g_r3_retry
g_r3_ok:
    v_mfma_f32_32x32x16_bf16 v[64:79], v[128:131], v[152:155], v[64:79]
    v_mfma_f32_32x32x16_bf16 v[64:79], v[132:135], v[156:159], v[64:79]
    s_waitcnt vmcnt(2)
    v_max_u32 v9, v144, v145
    v_max3_u32 v9, v146, v147, v9
    v_max3_u32 v9, v148, v149, v9
    v_max3_u32 v9, v150, v151, v9
    v_cmp_eq_u32 vcc, -1, v9
    s_and_b64 vcc, vcc, s[48:49]
    s_nop 0
    s_cbranch_vccnz g_r2_retry
g_r2_ok:
    v_mfma_f32_32x32x16_bf16 v[64:79], v[128:131], v[144:147], v[64:79]
    v_mfma_f32_32x32x16_bf16 v[64:79], v[132:135], v[148:151], v[64:79]
    s_waitcnt vmcnt(0)
    v_max_u32 v9, v136, v137
    v_max3_u32 v9, v138, v139, v9
    v_max3_u32 v9, v140, v141, v9
    v_max3_u32 v9, v142, v143, v9
    v_cmp_eq_u32 vcc, -1, v9
    s_and_b64 vcc, vcc, s[48:49]
    s_nop 0
    s_cbranch_vccnz g_r1_retry
g_r1_ok:
    v_mfma_f32_32x32x16_bf16 v[64:79], v[128:131], v[136:139], v[64:79]
    v_mfma_f32_32x32x16_bf16 v[64:79], v[132:135], v[140:143], v[64:79]
    s_nop 7
    s_nop 3
    v_cvt_pk_bf16_f32 v32, v64, v65
    v_cvt_pk_bf16_f32 v33, v66, v67
    v_cvt_pk_bf16_f32 v34, v68, v69
    v_cvt_pk_bf16_f32 v35, v70, v71
    v_cvt_pk_bf16_f32 v36, v72, v73
    v_cvt_pk_bf16_f32 v37, v74, v75
    v_cvt_pk_bf16_f32 v38, v76, v77
    v_cvt_pk_bf16_f32 v39, v78, v79
    v_permlane32_swap_b32 v32, v34
    v_permlane32_swap_b32 v33, v35
    v_permlane32_swap_b32 v36, v38
    v_permlane32_swap_b32 v37, v39
    v_cmp_gt_u32 vcc, 229376, v14
    s_nop 1
    s_and_b64 exec, exec, vcc
    buffer_store_dwordx4 v[32:35], v14, s[28:31], s98 offen offset:0
    buffer_store_dwordx4 v[36:39], v14, s[28:31], s98 offen offset:32
    s_mov_b64 exec, -1
k_end:
    s_endpgm
g_o1_retry:
    s_nop 7
    s_nop 3
    s_sub_u32 s99, s99, 1
    s_cbranch_scc1 g_o1_giveup
    s_mov_b64 exec, s[46:47]
    s_add_u32 s74, s81, 524288
    buffer_load_dwordx4 v[160:163], v8, s[20:23], s74 offen offset:0 sc1
    s_mov_b64 exec, -1
    s_mov_b64 exec, s[46:47]
    s_add_u32 s74, s81, 524288
    buffer_load_dwordx4 v[164:167], v8, s[20:23], s74 offen offset:1024 sc1
    s_mov_b64 exec, -1
    s_mov_b64 exec, s[46:47]
    s_add_u32 s74, s81, 524288
    buffer_load_dwordx4 v[168:171], v8, s[20:23], s74 offen offset:2048 sc1
    s_mov_b64 exec, -1
    s_mov_b64 exec, s[46:47]
    s_add_u32 s74, s81, 524288
    buffer_load_dwordx4 v[172:175], v8, s[20:23], s74 offen offset:3072 sc1
    s_mov_b64 exec, -1
    s_mov_b64 exec, s[46:47]
    s_add_u32 s74, s81, 528384
    buffer_load_dwordx4 v[176:179], v8, s[20:23], s74 offen offset:0 sc1
    s_mov_b64 exec, -1
    s_mov_b64 exec, s[46:47]
    s_add_u32 s74, s81, 528384
    buffer_load_dwordx4 v[180:183], v8, s[20:23], s74 offen offset:1024 sc1
    s_mov_b64 exec, -1
    s_mov_b64 exec, s[46:47]
    s_add_u32 s74, s81, 528384
    buffer_load_dwordx4 v[184:187], v8, s[20:23], s74 offen offset:2048 sc1
    s_mov_b64 exec, -1
    s_mov_b64 exec, s[46:47]
    s_add_u32 s74, s81, 528384
    buffer_load_dwordx4 v[188:191], v8, s[20:23], s74 offen offset:3072 sc1
    s_mov_b64 exec, -1
    s_waitcnt vmcnt(8)
    v_max_u32 v9, v192, v193
    v_max3_u32 v9, v194, v195, v9
    v_max3_u32 v9, v196, v197, v9
    v_max3_u32 v9, v198, v199, v9
    v_max3_u32 v9, v200, v201, v9
    v_max3_u32 v9, v202, v203, v9
    v_max3_u32 v9, v204, v205, v9
    v_max3_u32 v9, v206, v207, v9
    v_max3_u32 v9, v208, v209, v9
    v_max3_u32 v9, v210, v211, v9
    v_max3_u32 v9, v212, v213, v9
    v_max3_u32 v9, v214, v215, v9
    v_max3_u32 v9, v216, v217, v9
    v_max3_u32 v9, v218, v219, v9
    v_max3_u32 v9, v220, v221, v9
    v_max3_u32 v9, v222, v223, v9
    v_cmp_eq_u32 vcc, -1, v9
    s_and_b64 vcc, vcc, s[48:49]
    s_nop 0
    s_cbranch_vccz g_o1_sk0
    s_mov_b64 exec, s[46:47]
    s_add_u32 s74, s84, 524288
    buffer_load_dwordx4 v[192:195], v8, s[20:23], s74 offen offset:0 sc1
    s_mov_b64 exec, -1
    s_mov_b64 exec, s[46:47]
    s_add_u32 s74, s84, 524288
    buffer_load_dwordx4 v[196:199], v8, s[20:23], s74 offen offset:1024 sc1
    s_mov_b64 exec, -1
    s_mov_b64 exec, s[46:47]
    s_add_u32 s74, s84, 524288
    buffer_load_dwordx4 v[200:203], v8, s[20:23], s74 offen offset:2048 sc1
    s_mov_b64 exec, -1
    s_mov_b64 exec, s[46:47]
    s_add_u32 s74, s84, 524288
    buffer_load_dwordx4 v[204:207], v8, s[20:23], s74 offen offset:3072 sc1
    s_mov_b64 exec, -1
    s_mov_b64 exec, s[46:47]
    s_add_u32 s74, s84, 528384
    buffer_load_dwordx4 v[208:211], v8, s[20:23], s74 offen offset:0 sc1
    s_mov_b64 exec, -1
    s_mov_b64 exec, s[46:47]
    s_add_u32 s74, s84, 528384
    buffer_load_dwordx4 v[212:215], v8, s[20:23], s74 offen offset:1024 sc1
    s_mov_b64 exec, -1
    s_mov_b64 exec, s[46:47]
    s_add_u32 s74, s84, 528384
    buffer_load_dwordx4 v[216:219], v8, s[20:23], s74 offen offset:2048 sc1
    s_mov_b64 exec, -1
    s_mov_b64 exec, s[46:47]
    s_add_u32 s74, s84, 528384
    buffer_load_dwordx4 v[220:223], v8, s[20:23], s74 offen offset:3072 sc1
    s_mov_b64 exec, -1
g_o1_sk0:
    s_nop 7
    s_nop 3
    v_max_u32 v9, v224, v225
    v_max3_u32 v9, v226, v227, v9
    v_max3_u32 v9, v228, v229, v9
    v_max3_u32 v9, v230, v231, v9
    v_max3_u32 v9, v232, v233, v9
    v_max3_u32 v9, v234, v235, v9
    v_max3_u32 v9, v236, v237, v9
    v_max3_u32 v9, v238, v239, v9
    v_max3_u32 v9, v240, v241, v9
    v_max3_u32 v9, v242, v243, v9
    v_max3_u32 v9, v244, v245, v9
    v_max3_u32 v9, v246, v247, v9
    v_max3_u32 v9, v248, v249, v9
    v_max3_u32 v9, v250, v251, v9
    v_max3_u32 v9, v252, v253, v9
    v_max3_u32 v9, v254, v255, v9
    v_cmp_eq_u32 vcc, -1, v9
    s_and_b64 vcc, vcc, s[48:49]
    s_nop 0
    s_cbranch_vccz g_o1_sk1
    s_mov_b64 exec, s[46:47]
    s_add_u32 s74, s83, 524288
    buffer_load_dwordx4 v[224:227], v8, s[20:23], s74 offen offset:0 sc1
    s_mov_b64 exec, -1
    s_mov_b64 exec, s[46:47]
    s_add_u32 s74, s83, 524288
    buffer_load_dwordx4 v[228:231], v8, s[20:23], s74 offen offset:1024 sc1
    s_mov_b64 exec, -1
    s_mov_b64 exec, s[46:47]
    s_add_u32 s74, s83, 524288
    buffer_load_dwordx4 v[232:235], v8, s[20:23], s74 offen offset:2048 sc1
    s_mov_b64 exec, -1
    s_mov_b64 exec, s[46:47]
    s_add_u32 s74, s83, 524288
    buffer_load_dwordx4 v[236:239], v8, s[20:23], s74 offen offset:3072 sc1
    s_mov_b64 exec, -1
    s_mov_b64 exec, s[46:47]
    s_add_u32 s74, s83, 528384
    buffer_load_dwordx4 v[240:243], v8, s[20:23], s74 offen offset:0 sc1
    s_mov_b64 exec, -1
    s_mov_b64 exec, s[46:47]
    s_add_u32 s74, s83, 528384
    buffer_load_dwordx4 v[244:247], v8, s[20:23], s74 offen offset:1024 sc1
    s_mov_b64 exec, -1
    s_mov_b64 exec, s[46:47]
    s_add_u32 s74, s83, 528384
    buffer_load_dwordx4 v[248:251], v8, s[20:23], s74 offen offset:2048 sc1
    s_mov_b64 exec, -1
    s_mov_b64 exec, s[46:47]
    s_add_u32 s74, s83, 528384
    buffer_load_dwordx4 v[252:255], v8, s[20:23], s74 offen offset:3072 sc1
    s_mov_b64 exec, -1
g_o1_sk1:
    s_nop 7
    s_nop 3
    s_waitcnt vmcnt(0)
    v_max_u32 v9, v160, v161
    v_max3_u32 v9, v162, v163, v9
    v_max3_u32 v9, v164, v165, v9
    v_max3_u32 v9, v166, v167, v9
    v_max3_u32 v9, v168, v169, v9
    v_max3_u32 v9, v170, v171, v9
    v_max3_u32 v9, v172, v173, v9
    v_max3_u32 v9, v174, v175, v9
    v_max3_u32 v9, v176, v177, v9
    v_max3_u32 v9, v178, v179, v9
    v_max3_u32 v9, v180, v181, v9
    v_max3_u32 v9, v182, v183, v9
    v_max3_u32 v9, v184, v185, v9
    v_max3_u32 v9, v186, v187, v9
    v_max3_u32 v9, v188, v189, v9
    v_max3_u32 v9, v190, v191, v9
    v_cmp_eq_u32 vcc, -1, v9
    s_and_b64 vcc, vcc, s[48:49]
    s_nop 0
    s_cbranch_vccnz g_o1_retry
    s_nop 7
    s_nop 3
    s_branch g_o1_ok
g_o1_giveup:
    s_mov_b32 s99, 0
    s_branch g_o1_ok
g_o2_retry:
    s_nop 7
    s_nop 3
    s_sub_u32 s99, s99, 1
    s_cbranch_scc1 g_o2_giveup
    s_mov_b64 exec, s[46:47]
    s_add_u32 s74, s84, 524288
    buffer_load_dwordx4 v[192:195], v8, s[20:23], s74 offen offset:0 sc1
    s_mov_b64 exec, -1
    s_mov_b64 exec, s[46:47]
    s_add_u32 s74, s84, 524288
    buffer_load_dwordx4 v[196:199], v8, s[20:23], s74 offen offset:1024 sc1
    s_mov_b64 exec, -1
    s_mov_b64 exec, s[46:47]
    s_add_u32 s74, s84, 524288
    buffer_load_dwordx4 v[200:203], v8, s[20:23], s74 offen offset:2048 sc1
    s_mov_b64 exec, -1
    s_mov_b64 exec, s[46:47]
    s_add_u32 s74, s84, 524288
    buffer_load_dwordx4 v[204:207], v8, s[20:23], s74 offen offset:3072 sc1
    s_mov_b64 exec, -1
    s_mov_b64 exec, s[46:47]
    s_add_u32 s74, s84, 528384
    buffer_load_dwordx4 v[208:211], v8, s[20:23], s74 offen offset:0 sc1
    s_mov_b64 exec, -1
    s_mov_b64 exec, s[46:47]
    s_add_u32 s74, s84, 528384
    buffer_load_dwordx4 v[212:215], v8, s[20:23], s74 offen offset:1024 sc1
    s_mov_b64 exec, -1
    s_mov_b64 exec, s[46:47]
    s_add_u32 s74, s84, 528384
    buffer_load_dwordx4 v[216:219], v8, s[20:23], s74 offen offset:2048 sc1
    s_mov_b64 exec, -1
    s_mov_b64 exec, s[46:47]
    s_add_u32 s74, s84, 528384
    buffer_load_dwordx4 v[220:223], v8, s[20:23], s74 offen offset:3072 sc1
    s_mov_b64 exec, -1
    s_waitcnt vmcnt(8)
    v_max_u32 v9, v224, v225
    v_max3_u32 v9, v226, v227, v9
    v_max3_u32 v9, v228, v229, v9
    v_max3_u32 v9, v230, v231, v9
    v_max3_u32 v9, v232, v233, v9
    v_max3_u32 v9, v234, v235, v9
    v_max3_u32 v9, v236, v237, v9
    v_max3_u32 v9, v238, v239, v9
    v_max3_u32 v9, v240, v241, v9
    v_max3_u32 v9, v242, v243, v9
    v_max3_u32 v9, v244, v245, v9
    v_max3_u32 v9, v246, v247, v9
    v_max3_u32 v9, v248, v249, v9
    v_max3_u32 v9, v250, v251, v9
    v_max3_u32 v9, v252, v253, v9
    v_max3_u32 v9, v254, v255, v9
    v_cmp_eq_u32 vcc, -1, v9
    s_and_b64 vcc, vcc, s[48:49]
    s_nop 0
    s_cbranch_vccz g_o2_sk0
    s_mov_b64 exec, s[46:47]
    s_add_u32 s74, s83, 524288
    buffer_load_dwordx4 v[224:227], v8, s[20:23], s74 offen offset:0 sc1
    s_mov_b64 exec, -1
    s_mov_b64 exec, s[46:47]
    s_add_u32 s74, s83, 524288
    buffer_load_dwordx4 v[228:231], v8, s[20:23], s74 offen offset:1024 sc1
    s_mov_b64 exec, -1
    s_mov_b64 exec, s[46:47]
    s_add_u32 s74, s83, 524288
    buffer_load_dwordx4 v[232:235], v8, s[20:23], s74 offen offset:2048 sc1
    s_mov_b64 exec, -1
    s_mov_b64 exec, s[46:47]
    s_add_u32 s74, s83, 524288
    buffer_load_dwordx4 v[236:239], v8, s[20:23], s74 offen offset:3072 sc1
    s_mov_b64 exec, -1
    s_mov_b64 exec, s[46:47]
    s_add_u32 s74, s83, 528384
    buffer_load_dwordx4 v[240:243], v8, s[20:23], s74 offen offset:0 sc1
    s_mov_b64 exec, -1
    s_mov_b64 exec, s[46:47]
    s_add_u32 s74, s83, 528384
    buffer_load_dwordx4 v[244:247], v8, s[20:23], s74 offen offset:1024 sc1
    s_mov_b64 exec, -1
    s_mov_b64 exec, s[46:47]
    s_add_u32 s74, s83, 528384
    buffer_load_dwordx4 v[248:251], v8, s[20:23], s74 offen offset:2048 sc1
    s_mov_b64 exec, -1
    s_mov_b64 exec, s[46:47]
    s_add_u32 s74, s83, 528384
    buffer_load_dwordx4 v[252:255], v8, s[20:23], s74 offen offset:3072 sc1
    s_mov_b64 exec, -1
g_o2_sk0:
    s_nop 7
    s_nop 3
    s_waitcnt vmcnt(0)
    v_max_u32 v9, v192, v193
    v_max3_u32 v9, v194, v195, v9
    v_max3_u32 v9, v196, v197, v9
    v_max3_u32 v9, v198, v199, v9
    v_max3_u32 v9, v200, v201, v9
    v_max3_u32 v9, v202, v203, v9
    v_max3_u32 v9, v204, v205, v9
    v_max3_u32 v9, v206, v207, v9
    v_max3_u32 v9, v208, v209, v9
    v_max3_u32 v9, v210, v211, v9
    v_max3_u32 v9, v212, v213, v9
    v_max3_u32 v9, v214, v215, v9
    v_max3_u32 v9, v216, v217, v9
    v_max3_u32 v9, v218, v219, v9
    v_max3_u32 v9, v220, v221, v9
    v_max3_u32 v9, v222, v223, v9
    v_cmp_eq_u32 vcc, -1, v9
    s_and_b64 vcc, vcc, s[48:49]
    s_nop 0
    s_cbranch_vccnz g_o2_retry
    s_nop 7
    s_nop 3
    s_branch g_o2_ok
g_o2_giveup:
    s_mov_b32 s99, 0
    s_branch g_o2_ok
g_o3_retry:
    s_nop 7
    s_nop 3
    s_sub_u32 s99, s99, 1
    s_cbranch_scc1 g_o3_giveup
    s_mov_b64 exec, s[46:47]
    s_add_u32 s74, s83, 524288
    buffer_load_dwordx4 v[224:227], v8, s[20:23], s74 offen offset:0 sc1
    s_mov_b64 exec, -1
    s_mov_b64 exec, s[46:47]
    s_add_u32 s74, s83, 524288
    buffer_load_dwordx4 v[228:231], v8, s[20:23], s74 offen offset:1024 sc1
    s_mov_b64 exec, -1
    s_mov_b64 exec, s[46:47]
    s_add_u32 s74, s83, 524288
    buffer_load_dwordx4 v[232:235], v8, s[20:23], s74 offen offset:2048 sc1
    s_mov_b64 exec, -1
    s_mov_b64 exec, s[46:47]
    s_add_u32 s74, s83, 524288
    buffer_load_dwordx4 v[236:239], v8, s[20:23], s74 offen offset:3072 sc1
    s_mov_b64 exec, -1
    s_mov_b64 exec, s[46:47]
    s_add_u32 s74, s83, 528384
    buffer_load_dwordx4 v[240:243], v8, s[20:23], s74 offen offset:0 sc1
    s_mov_b64 exec, -1
    s_mov_b64 exec, s[46:47]
    s_add_u32 s74, s83, 528384
    buffer_load_dwordx4 v[244:247], v8, s[20:23], s74 offen offset:1024 sc1
    s_mov_b64 exec, -1
    s_mov_b64 exec, s[46:47]
    s_add_u32 s74, s83, 528384
    buffer_load_dwordx4 v[248:251], v8, s[20:23], s74 offen offset:2048 sc1
    s_mov_b64 exec, -1
    s_mov_b64 exec, s[46:47]
    s_add_u32 s74, s83, 528384
    buffer_load_dwordx4 v[252:255], v8, s[20:23], s74 offen offset:3072 sc1
    s_mov_b64 exec, -1
    s_waitcnt vmcnt(0)
    v_max_u32 v9, v224, v225
    v_max3_u32 v9, v226, v227, v9
    v_max3_u32 v9, v228, v229, v9
    v_max3_u32 v9, v230, v231, v9
    v_max3_u32 v9, v232, v233, v9
    v_max3_u32 v9, v234, v235, v9
    v_max3_u32 v9, v236, v237, v9
    v_max3_u32 v9, v238, v239, v9
    v_max3_u32 v9, v240, v241, v9
    v_max3_u32 v9, v242, v243, v9
    v_max3_u32 v9, v244, v245, v9
    v_max3_u32 v9, v246, v247, v9
    v_max3_u32 v9, v248, v249, v9
    v_max3_u32 v9, v250, v251, v9
    v_max3_u32 v9, v252, v253, v9
    v_max3_u32 v9, v254, v255, v9
    v_cmp_eq_u32 vcc, -1, v9
    s_and_b64 vcc, vcc, s[48:49]
    s_nop 0
    s_cbranch_vccnz g_o3_retry
    s_nop 7
    s_nop 3
    s_branch g_o3_ok
g_o3_giveup:
    s_mov_b32 s99, 0
    s_branch g_o3_ok
g_poll_retry:
    s_nop 7
    s_nop 3
    s_sub_u32 s99, s99, 1
    s_cbranch_scc1 g_poll_giveup
    s_mov_b64 exec, s[46:47]
    s_add_u32 s74, s81, 528384
    buffer_load_dwordx4 v[188:191], v8, s[20:23], s74 offen offset:3072 sc1
    s_mov_b64 exec, -1
    s_mov_b64 exec, s[46:47]
    s_add_u32 s74, s84, 528384
    buffer_load_dwordx4 v[220:223], v8, s[20:23], s74 offen offset:3072 sc1
    s_mov_b64 exec, -1
    s_mov_b64 exec, s[46:47]
    s_add_u32 s74, s83, 528384
    buffer_load_dwordx4 v[252:255], v8, s[20:23], s74 offen offset:3072 sc1
    s_mov_b64 exec, -1
    s_waitcnt vmcnt(0)
    v_max_u32 v9, v188, v189
    v_max3_u32 v9, v190, v191, v9
    v_max3_u32 v9, v220, v221, v9
    v_max3_u32 v9, v222, v223, v9
    v_max3_u32 v9, v252, v253, v9
    v_max3_u32 v9, v254, v255, v9
    v_cmp_eq_u32 vcc, -1, v9
    s_and_b64 vcc, vcc, s[48:49]
    s_nop 0
    s_cbranch_vccnz g_poll_retry
    s_nop 7
    s_nop 3
    s_branch g_poll_ok
g_poll_giveup:
    s_mov_b32 s99, 0
    s_branch g_poll_ok
g_r3_retry:
    s_nop 7
    s_nop 3
    s_sub_u32 s99, s99, 1
    s_cbranch_scc1 g_r3_giveup
    s_mov_b64 exec, s[46:47]
    s_add_u32 s74, s92, 49152
    buffer_load_dwordx4 v[152:155], v8, s[20:23], s74 offen offset:0 sc1
    s_mov_b64 exec, -1
    s_mov_b64 exec, s[46:47]
    s_add_u32 s74, s92, 49152
    buffer_load_dwordx4 v[156:159], v8, s[20:23], s74 offen offset:1024 sc1
    s_mov_b64 exec, -1
    s_waitcnt vmcnt(2)
    v_max_u32 v9, v144, v145
    v_max3_u32 v9, v146, v147, v9
    v_max3_u32 v9, v148, v149, v9
    v_max3_u32 v9, v150, v151, v9
    v_cmp_eq_u32 vcc, -1, v9
    s_and_b64 vcc, vcc, s[48:49]
    s_nop 0
    s_cbranch_vccz g_r3_sk0
    s_mov_b64 exec, s[46:47]
    s_add_u32 s74, s92, 32768
    buffer_load_dwordx4 v[144:147], v8, s[20:23], s74 offen offset:0 sc1
    s_mov_b64 exec, -1
    s_mov_b64 exec, s[46:47]
    s_add_u32 s74, s92, 32768
    buffer_load_dwordx4 v[148:151], v8, s[20:23], s74 offen offset:1024 sc1
    s_mov_b64 exec, -1
g_r3_sk0:
    s_nop 7
    s_nop 3
    v_max_u32 v9, v136, v137
    v_max3_u32 v9, v138, v139, v9
    v_max3_u32 v9, v140, v141, v9
    v_max3_u32 v9, v142, v143, v9
    v_cmp_eq_u32 vcc, -1, v9
    s_and_b64 vcc, vcc, s[48:49]
    s_nop 0
    s_cbranch_vccz g_r3_sk1
    s_mov_b64 exec, s[46:47]
    s_add_u32 s74, s92, 16384
    buffer_load_dwordx4 v[136:139], v8, s[20:23], s74 offen offset:0 sc1
    s_mov_b64 exec, -1
    s_mov_b64 exec, s[46:47]
    s_add_u32 s74, s92, 16384
    buffer_load_dwordx4 v[140:143], v8, s[20:23], s74 offen offset:1024 sc1
    s_mov_b64 exec, -1
g_r3_sk1:
    s_nop 7
    s_nop 3
    s_waitcnt vmcnt(0)
    v_max_u32 v9, v152, v153
    v_max3_u32 v9, v154, v155, v9
    v_max3_u32 v9, v156, v157, v9
    v_max3_u32 v9, v158, v159, v9
    v_cmp_eq_u32 vcc, -1, v9
    s_and_b64 vcc, vcc, s[48:49]
    s_nop 0
    s_cbranch_vccnz g_r3_retry
    s_nop 7
    s_nop 3
    s_branch g_r3_ok
g_r3_giveup:
    s_mov_b32 s99, 0
    s_branch g_r3_ok
g_r2_retry:
    s_nop 7
    s_nop 3
    s_sub_u32 s99, s99, 1
    s_cbranch_scc1 g_r2_giveup
    s_mov_b64 exec, s[46:47]
    s_add_u32 s74, s92, 32768
    buffer_load_dwordx4 v[144:147], v8, s[20:23], s74 offen offset:0 sc1
    s_mov_b64 exec, -1
    s_mov_b64 exec, s[46:47]
    s_add_u32 s74, s92, 32768
    buffer_load_dwordx4 v[148:151], v8, s[20:23], s74 offen offset:1024 sc1
    s_mov_b64 exec, -1
    s_waitcnt vmcnt(2)
    v_max_u32 v9, v136, v137
    v_max3_u32 v9, v138, v139, v9
    v_max3_u32 v9, v140, v141, v9
    v_max3_u32 v9, v142, v143, v9
    v_cmp_eq_u32 vcc, -1, v9
    s_and_b64 vcc, vcc, s[48:49]
    s_nop 0
    s_cbranch_vccz g_r2_sk0
    s_mov_b64 exec, s[46:47]
    s_add_u32 s74, s92, 16384
    buffer_load_dwordx4 v[136:139], v8, s[20:23], s74 offen offset:0 sc1
    s_mov_b64 exec, -1
    s_mov_b64 exec, s[46:47]
    s_add_u32 s74, s92, 16384
    buffer_load_dwordx4 v[140:143], v8, s[20:23], s74 offen offset:1024 sc1
    s_mov_b64 exec, -1
g_r2_sk0:
    s_nop 7
    s_nop 3
    s_waitcnt vmcnt(0)
    v_max_u32 v9, v144, v145
    v_max3_u32 v9, v146, v147, v9
    v_max3_u32 v9, v148, v149, v9
    v_max3_u32 v9, v150, v151, v9
    v_cmp_eq_u32 vcc, -1, v9
    s_and_b64 vcc, vcc, s[48:49]
    s_nop 0
    s_cbranch_vccnz g_r2_retry
    s_nop 7
    s_nop 3
    s_branch g_r2_ok
g_r2_giveup:
    s_mov_b32 s99, 0
    s_branch g_r2_ok
g_r1_retry:
    s_nop 7
    s_nop 3
    s_sub_u32 s99, s99, 1
    s_cbranch_scc1 g_r1_giveup
    s_mov_b64 exec, s[46:47]
    s_add_u32 s74, s92, 16384
    buffer_load_dwordx4 v[136:139], v8, s[20:23], s74 offen offset:0 sc1
    s_mov_b64 exec, -1
    s_mov_b64 exec, s[46:47]
    s_add_u32 s74, s92, 16384
    buffer_load_dwordx4 v[140:143], v8, s[20:23], s74 offen offset:1024 sc1
    s_mov_b64 exec, -1
    s_waitcnt vmcnt(0)
    v_max_u32 v9, v136, v137
    v_max3_u32 v9, v138, v139, v9
    v_max3_u32 v9, v140, v141, v9
    v_max3_u32 v9, v142, v143, v9
    v_cmp_eq_u32 vcc, -1, v9
    s_and_b64 vcc, vcc, s[48:49]
    s_nop 0
    s_cbranch_vccnz g_r1_retry
    s_nop 7
    s_nop 3
    s_branch g_r1_ok
g_r1_giveup:
    s_mov_b32 s99, 0
    s_branch g_r1_ok
    s_nop 7
    s_nop 3
a_main:
    s_setprio 3
    s_lshl_b32 s74, s78, 5
    s_add_u32 s75, s74, s65
    s_lshl_b32 s75, s75, 2
    s_add_u32 s75, s75, s68
    s_lshl_b32 s79, s75, 13
    s_xor_b32 s80, s79, 557056
    s_xor_b32 s75, s66, 2
    s_lshl_b32 s75, s75, 8
    s_lshl_b32 s76, s65, 17
    s_add_u32 s85, s75, s76
    s_lshl_b32 s75, s77, 21
    s_add_u32 s85, s85, s75
    s_xor_b32 s54, s85, 2097152
    s_xor_b32 s55, s85, 2228224
    s_xor_b32 s56, s85, 2359296
    s_xor_b32 s57, s85, 2490368
    s_mov_b32 s81, s79
    s_xor_b32 s86, s85, 131072
    s_xor_b32 s82, s79, 32768
    s_xor_b32 s87, s85, 262144
    s_xor_b32 s83, s79, 65536
    s_xor_b32 s88, s85, 393216
    s_xor_b32 s84, s79, 98304
    s_lshl_b32 s74, s78, 2
    s_add_u32 s74, s74, s66
    s_lshl_b32 s74, s74, 2
    s_add_u32 s75, s74, s67
    s_lshl_b32 s75, s75, 16
    s_add_u32 s75, s75, s69
    s_add_u32 s92, s75, 16777216
    s_add_u32 s75, s67, 1
    s_and_b32 s75, s75, 3
    s_add_u32 s75, s75, s74
    s_lshl_b32 s75, s75, 16
    s_add_u32 s75, s75, s69
    s_add_u32 s89, s75, 16826368
    s_add_u32 s75, s67, 2
    s_and_b32 s75, s75, 3
    s_add_u32 s75, s75, s74
    s_lshl_b32 s75, s75, 16
    s_add_u32 s75, s75, s69
    s_add_u32 s90, s75, 16809984
    s_add_u32 s75, s67, 3
    s_and_b32 s75, s75, 3
    s_add_u32 s75, s75, s74
    s_lshl_b32 s75, s75, 16
    s_add_u32 s75, s75, s69
    s_add_u32 s91, s75, 16793600
    s_lshl_b32 s96, 1, s65
    s_lshl_b32 s74, s67, 2
    s_lshl_b32 s94, 15, s74
    s_lshl_b32 s95, 0x1111, s66
    s_lshl_b32 s97, s78, 4
    s_mul_i32 s98, s63, 229376
    s_lshl_b32 s74, s64, 10
    s_add_u32 s98, s98, s74
    s_xor_b32 s74, s66, 2
    s_lshl_b32 s74, s74, 8
    s_add_u32 s98, s98, s74
    s_lshl_b32 s74, s67, 6
    s_add_u32 s98, s98, s74
    s_mov_b32 s99, 100000
    s_cmp_eq_u32 s68, 3
    s_cselect_b32 s46, 0xffff, -1
    s_mov_b32 s47, s46
    s_and_b32 s48, s46, -1
    s_mov_b32 s49, s48
    s_mov_b32 s44, 0x3e0293ee
    s_mov_b32 s45, 0x3e0293ee
    v_lshlrev_b32 v23, 4, v0
    v_lshlrev_b32 v224, 6, v0
    v_add_u32 v224, s69, v224
    v_lshrrev_b32 v22, 5, v0
    v_lshlrev_b32 v15, 10, v22
    v_bfe_u32 v22, v0, 2, 2
    v_lshl_add_u32 v15, v22, 6, v15
    v_bfe_u32 v22, v0, 4, 1
    v_lshl_add_u32 v15, v22, 5, v15
    v_and_b32 v22, 3, v0
    v_lshl_add_u32 v15, v22, 3, v15
    v_bfe_u32 v22, v0, 2, 3
    v_lshlrev_b32 v18, 10, v22
    v_and_b32 v19, 3, v0
    v_lshl_add_u32 v18, v19, 6, v18
    v_and_b32 v22, 3, v22
    v_lshrrev_b32 v19, 5, v0
    v_xor_b32 v22, v22, v19
    v_lshl_add_u32 v9, v22, 4, v18
    v_xor_b32 v10, 32, v9
    v_add_u32 v16, 65536, v15
    v_add_u32 v11, 65536, v9
    v_add_u32 v12, 65536, v10
    v_add_u32 v17, 131072, v15
    v_add_u32 v13, 131072, v9
    v_add_u32 v14, 131072, v10
    v_lshrrev_b32 v22, 2, v0
    v_xor_b32 v22, v22, v0
    v_bfe_u32 v22, v22, 2, 1
    v_add_u32 v22, -1, v22
    v_and_b32 v28, 0x3f803f80, v22
    v_and_b32 v29, 0x3f803f80, v22
    v_and_b32 v30, 0x3f803f80, v22
    v_and_b32 v31, 0x3f803f80, v22
    s_barrier
    s_add_u32 m0, s69, 114688
    s_add_u32 s41, s53, 384
    buffer_load_dwordx4 v97, s[16:19], s41 offen offset:0 lds
    buffer_load_dwordx4 v98, s[16:19], s41 offen offset:1024 lds
    buffer_load_dwordx4 v99, s[16:19], s41 offen offset:2048 lds
    buffer_load_dwordx4 v100, s[16:19], s41 offen offset:3072 lds
    s_add_u32 m0, s69, 131072
    s_add_u32 s41, s72, 1572864
    buffer_load_dwordx4 v96, s[12:15], s41 offen offset:0 lds
    s_add_u32 s41, s72, 1604608
    buffer_load_dwordx4 v96, s[12:15], s41 offen offset:1024 lds
    s_add_u32 s41, s72, 1636352
    buffer_load_dwordx4 v96, s[12:15], s41 offen offset:2048 lds
    s_add_u32 s41, s72, 1668096
    buffer_load_dwordx4 v96, s[12:15], s41 offen offset:3072 lds
    s_waitcnt vmcnt(12)
    s_barrier
    s_add_u32 m0, s69, 0
    s_add_u32 s41, s53, 512
    buffer_load_dwordx4 v97, s[16:19], s41 offen offset:0 lds
    buffer_load_dwordx4 v98, s[16:19], s41 offen offset:1024 lds
    buffer_load_dwordx4 v99, s[16:19], s41 offen offset:2048 lds
    buffer_load_dwordx4 v100, s[16:19], s41 offen offset:3072 lds
    s_add_u32 m0, s69, 16384
    s_add_u32 s41, s72, 2097152
    buffer_load_dwordx4 v96, s[12:15], s41 offen offset:0 lds
    s_add_u32 s41, s72, 2128896
    buffer_load_dwordx4 v96, s[12:15], s41 offen offset:1024 lds
    s_add_u32 s41, s72, 2160640
    buffer_load_dwordx4 v96, s[12:15], s41 offen offset:2048 lds
    s_add_u32 s41, s72, 2192384
    buffer_load_dwordx4 v96, s[12:15], s41 offen offset:3072 lds
    s_waitcnt vmcnt(8)
    s_barrier
    s_add_u32 m0, s69, 32768
    s_add_u32 s41, s53, 640
    buffer_load_dwordx4 v97, s[16:19], s41 offen offset:0 lds
    buffer_load_dwordx4 v98, s[16:19], s41 offen offset:1024 lds
    buffer_load_dwordx4 v99, s[16:19], s41 offen offset:2048 lds
    buffer_load_dwordx4 v100, s[16:19], s41 offen offset:3072 lds
    s_add_u32 m0, s69, 49152
    s_add_u32 s41, s72, 2621440
    buffer_load_dwordx4 v96, s[12:15], s41 offen offset:0 lds
    s_add_u32 s41, s72, 2653184
    buffer_load_dwordx4 v96, s[12:15], s41 offen offset:1024 lds
    s_add_u32 s41, s72, 2684928
    buffer_load_dwordx4 v96, s[12:15], s41 offen offset:2048 lds
    s_add_u32 s41, s72, 2716672
    buffer_load_dwordx4 v96, s[12:15], s41 offen offset:3072 lds
    s_waitcnt vmcnt(8)
    s_barrier
    s_add_u32 m0, s69, 65536
    s_add_u32 s41, s53, 768
    buffer_load_dwordx4 v97, s[16:19], s41 offen offset:0 lds
    buffer_load_dwordx4 v98, s[16:19], s41 offen offset:1024 lds
    buffer_load_dwordx4 v99, s[16:19], s41 offen offset:2048 lds
    buffer_load_dwordx4 v100, s[16:19], s41 offen offset:3072 lds
    s_add_u32 m0, s69, 81920
    s_add_u32 s41, s72, 3145728
    buffer_load_dwordx4 v96, s[12:15], s41 offen offset:0 lds
    s_add_u32 s41, s72, 3177472
    buffer_load_dwordx4 v96, s[12:15], s41 offen offset:1024 lds
    s_add_u32 s41, s72, 3209216
    buffer_load_dwordx4 v96, s[12:15], s41 offen offset:2048 lds
    s_add_u32 s41, s72, 3240960
    buffer_load_dwordx4 v96, s[12:15], s41 offen offset:3072 lds
    s_cmp_ge_u32 s68, 2
    s_cbranch_scc0 a_t1
    v_lshrrev_b32 v22, 3, v0
    v_and_b32 v3, 7, v0
    v_lshlrev_b32 v3, 7, v3
    v_lshl_add_u32 v22, v22, 13, v3
    buffer_load_dword v4, v22, s[12:15], s43 offen offset:0
a_t1:
    s_nop 1
    s_waitcnt vmcnt(8)
    s_barrier
    s_add_u32 m0, s69, 0
    s_add_u32 s41, s53, 896
    buffer_load_dwordx4 v97, s[16:19], s41 offen offset:0 lds
    buffer_load_dwordx4 v98, s[16:19], s41 offen offset:1024 lds
    buffer_load_dwordx4 v99, s[16:19], s41 offen offset:2048 lds
    buffer_load_dwordx4 v100, s[16:19], s41 offen offset:3072 lds
    s_add_u32 m0, s69, 114688
    s_add_u32 s41, s72, 3670016
    buffer_load_dwordx4 v96, s[12:15], s41 offen offset:0 lds
    s_add_u32 s41, s72, 3701760
    buffer_load_dwordx4 v96, s[12:15], s41 offen offset:1024 lds
    s_add_u32 s41, s72, 3733504
    buffer_load_dwordx4 v96, s[12:15], s41 offen offset:2048 lds
    s_add_u32 s41, s72, 3765248
    buffer_load_dwordx4 v96, s[12:15], s41 offen offset:3072 lds
    s_add_u32 m0, s69, 131072
    s_xor_b32 s41, s70, 1024
    buffer_load_dwordx4 v5, s[4:7], s41 offen offset:0 nt lds
    s_add_u32 s41, s41, 7168
    buffer_load_dwordx4 v6, s[4:7], s41 offen offset:1024 nt lds
    s_add_u32 s41, s41, 7168
    buffer_load_dwordx4 v7, s[4:7], s41 offen offset:2048 nt lds
    s_add_u32 s41, s41, 7168
    buffer_load_dwordx4 v8, s[4:7], s41 offen offset:3072 nt lds
    s_add_u32 m0, s69, 147456
    s_xor_b32 s41, s70, 0
    buffer_load_dwordx4 v5, s[8:11], s41 offen offset:0 nt lds
    s_add_u32 s41, s41, 7168
    buffer_load_dwordx4 v5, s[8:11], s41 offen offset:1024 nt lds
    s_add_u32 s41, s41, 7168
    buffer_load_dwordx4 v5, s[8:11], s41 offen offset:2048 nt lds
    s_add_u32 s41, s41, 7168
    buffer_load_dwordx4 v5, s[8:11], s41 offen offset:3072 nt lds
    s_waitcnt vmcnt(16)
    s_barrier
    s_add_u32 m0, s69, 16384
    s_xor_b32 s41, s70, 1024
    buffer_load_dwordx4 v5, s[8:11], s41 offen offset:0 nt lds
    s_add_u32 s41, s41, 7168
    buffer_load_dwordx4 v5, s[8:11], s41 offen offset:1024 nt lds
    s_add_u32 s41, s41, 7168
    buffer_load_dwordx4 v5, s[8:11], s41 offen offset:2048 nt lds
    s_add_u32 s41, s41, 7168
    buffer_load_dwordx4 v5, s[8:11], s41 offen offset:3072 nt lds
    s_add_u32 m0, s69, 32768
    s_xor_b32 s41, s70, 2048
    buffer_load_dwordx4 v5, s[4:7], s41 offen offset:0 nt lds
    s_add_u32 s41, s41, 7168
    buffer_load_dwordx4 v6, s[4:7], s41 offen offset:1024 nt lds
    s_add_u32 s41, s41, 7168
    buffer_load_dwordx4 v7, s[4:7], s41 offen offset:2048 nt lds
    s_add_u32 s41, s41, 7168
    buffer_load_dwordx4 v8, s[4:7], s41 offen offset:3072 nt lds
    s_waitcnt vmcnt(16)
    s_barrier
    s_barrier
    s_barrier
    s_cmp_lt_u32 s68, 2
    s_cselect_b32 s93, 6, 0
    s_and_b32 s74, s68, 1
    s_add_u32 s93, s93, s74
    s_lshl_b32 s93, s93, 13
    v_add_u32 v22, s93, v23
    ds_read_b128 v[64:67], v22 offset:0
    ds_read_b128 v[68:71], v22 offset:1024
    ds_read_b128 v[72:75], v22 offset:2048
    ds_read_b128 v[76:79], v22 offset:3072
    ds_read_b128 v[80:83], v22 offset:4096
    ds_read_b128 v[84:87], v22 offset:5120
    ds_read_b128 v[88:91], v22 offset:6144
    ds_read_b128 v[92:95], v22 offset:7168
    s_cmp_lt_u32 s68, 2
    s_cbranch_scc0 a_t2
    v_lshlrev_b32 v22, 7, v0
    buffer_load_dword v4, v22, s[24:27], s40 offen offset:0
a_t2:
    s_nop 1
    ds_read_b128 v[32:35], v11 offset:32768
    ds_read_b128 v[36:39], v12 offset:32768
    ds_read_b128 v[40:43], v11 offset:33024
    ds_read_b128 v[44:47], v12 offset:33024
    ds_read_b128 v[48:51], v11 offset:33280
    ds_read_b128 v[52:55], v12 offset:33280
    s_waitcnt lgkmcnt(13)
    s_waitcnt lgkmcnt(5)
    v_mfma_f32_32x32x16_bf16 v[160:175], v[32:35], v[64:67], 0
    ds_read_b128 v[56:59], v11 offset:33536
    s_waitcnt lgkmcnt(5)
    v_mfma_f32_32x32x16_bf16 v[160:175], v[36:39], v[68:71], v[160:175]
    ds_read_b128 v[60:63], v12 offset:33536
    s_waitcnt lgkmcnt(5)
    v_mfma_f32_32x32x16_bf16 v[160:175], v[40:43], v[72:75], v[160:175]
    ds_read_b128 v[32:35], v11 offset:40960
    s_waitcnt lgkmcnt(5)
    v_mfma_f32_32x32x16_bf16 v[160:175], v[44:47], v[76:79], v[160:175]
    ds_read_b128 v[36:39], v12 offset:40960
    s_waitcnt lgkmcnt(5)
    v_mfma_f32_32x32x16_bf16 v[160:175], v[48:51], v[80:83], v[160:175]
    ds_read_b128 v[40:43], v11 offset:41216
    s_waitcnt lgkmcnt(5)
    v_mfma_f32_32x32x16_bf16 v[160:175], v[52:55], v[84:87], v[160:175]
    ds_read_b128 v[44:47], v12 offset:41216
    s_waitcnt lgkmcnt(5)
    v_mfma_f32_32x32x16_bf16 v[160:175], v[56:59], v[88:91], v[160:175]
    ds_read_b128 v[48:51], v11 offset:41472
    s_waitcnt lgkmcnt(5)
    v_mfma_f32_32x32x16_bf16 v[160:175], v[60:63], v[92:95], v[160:175]
    ds_read_b128 v[52:55], v12 offset:41472
    s_waitcnt lgkmcnt(5)
    v_mfma_f32_32x32x16_bf16 v[176:191], v[32:35], v[64:67], 0
    ds_read_b128 v[56:59], v11 offset:41728
    s_waitcnt lgkmcnt(5)
    v_mfma_f32_32x32x16_bf16 v[176:191], v[36:39], v[68:71], v[176:191]
    ds_read_b128 v[60:63], v12 offset:41728
    s_waitcnt lgkmcnt(5)
    v_mfma_f32_32x32x16_bf16 v[176:191], v[40:43], v[72:75], v[176:191]
    s_nop 2
    v_max_f32 v19, v160, v161
    s_waitcnt lgkmcnt(4)
    v_mfma_f32_32x32x16_bf16 v[176:191], v[44:47], v[76:79], v[176:191]
    v_max3_f32 v19, v162, v163, v19
    s_waitcnt lgkmcnt(3)
    v_mfma_f32_32x32x16_bf16 v[176:191], v[48:51], v[80:83], v[176:191]
    v_max3_f32 v19, v164, v165, v19
    v_max3_f32 v19, v166, v167, v19
    s_waitcnt lgkmcnt(2)
    v_mfma_f32_32x32x16_bf16 v[176:191], v[52:55], v[84:87], v[176:191]
    v_max3_f32 v19, v168, v169, v19
    s_waitcnt lgkmcnt(1)
    v_mfma_f32_32x32x16_bf16 v[176:191], v[56:59], v[88:91], v[176:191]
    v_max3_f32 v19, v170, v171, v19
    s_waitcnt lgkmcnt(0)
    v_mfma_f32_32x32x16_bf16 v[176:191], v[60:63], v[92:95], v[176:191]
    v_max3_f32 v19, v172, v173, v19
    v_max3_f32 v19, v174, v175, v19
    s_waitcnt vmcnt(12)
    s_barrier
    ds_read_b128 v[32:35], v13 offset:0
    ds_read_b128 v[36:39], v14 offset:0
    ds_read_b128 v[40:43], v13 offset:256
    ds_read_b128 v[44:47], v14 offset:256
    ds_read_b128 v[48:51], v13 offset:512
    ds_read_b128 v[52:55], v14 offset:512
    s_waitcnt lgkmcnt(5)
    v_mfma_f32_32x32x16_bf16 v[192:207], v[32:35], v[64:67], 0
    ds_read_b128 v[56:59], v13 offset:768
    s_add_u32 m0, s69, 49152
    s_xor_b32 s41, s70, 3072
    buffer_load_dwordx4 v5, s[4:7], s41 offen offset:0 nt lds
    s_waitcnt lgkmcnt(5)
    v_mfma_f32_32x32x16_bf16 v[192:207], v[36:39], v[68:71], v[192:207]
    ds_read_b128 v[60:63], v14 offset:768
    v_max3_f32 v19, v176, v177, v19
    s_waitcnt lgkmcnt(5)
    v_mfma_f32_32x32x16_bf16 v[192:207], v[40:43], v[72:75], v[192:207]
    ds_read_b128 v[32:35], v13 offset:8192
    s_add_u32 s41, s41, 7168
    buffer_load_dwordx4 v6, s[4:7], s41 offen offset:1024 nt lds
    v_max3_f32 v19, v178, v179, v19
    s_waitcnt lgkmcnt(5)
    v_mfma_f32_32x32x16_bf16 v[192:207], v[44:47], v[76:79], v[192:207]
    ds_read_b128 v[36:39], v14 offset:8192
    v_max3_f32 v19, v180, v181, v19
    s_waitcnt lgkmcnt(5)
    v_mfma_f32_32x32x16_bf16 v[192:207], v[48:51], v[80:83], v[192:207]
    ds_read_b128 v[40:43], v13 offset:8448
    s_add_u32 s41, s41, 7168
    buffer_load_dwordx4 v7, s[4:7], s41 offen offset:2048 nt lds
    v_max3_f32 v19, v182, v183, v19
    s_waitcnt lgkmcnt(5)
    v_mfma_f32_32x32x16_bf16 v[192:207], v[52:55], v[84:87], v[192:207]
    ds_read_b128 v[44:47], v14 offset:8448
    s_waitcnt lgkmcnt(5)
    v_mfma_f32_32x32x16_bf16 v[192:207], v[56:59], v[88:91], v[192:207]
    ds_read_b128 v[48:51], v13 offset:8704
    s_add_u32 s41, s41, 7168
    buffer_load_dwordx4 v8, s[4:7], s41 offen offset:3072 nt lds
    v_max3_f32 v19, v184, v185, v19
    s_waitcnt lgkmcnt(5)
    v_mfma_f32_32x32x16_bf16 v[192:207], v[60:63], v[92:95], v[192:207]
    ds_read_b128 v[52:55], v14 offset:8704
    v_max3_f32 v19, v186, v187, v19
    s_waitcnt lgkmcnt(5)
    v_mfma_f32_32x32x16_bf16 v[208:223], v[32:35], v[64:67], 0
    ds_read_b128 v[56:59], v13 offset:8960
    v_max3_f32 v19, v188, v189, v19
    s_waitcnt lgkmcnt(5)
    v_mfma_f32_32x32x16_bf16 v[208:223], v[36:39], v[68:71], v[208:223]
    ds_read_b128 v[60:63], v14 offset:8960
    v_max3_f32 v19, v190, v191, v19
    s_waitcnt lgkmcnt(5)
    v_mfma_f32_32x32x16_bf16 v[208:223], v[40:43], v[72:75], v[208:223]
    v_max3_f32 v19, v192, v193, v19
    s_waitcnt lgkmcnt(4)
    v_mfma_f32_32x32x16_bf16 v[208:223], v[44:47], v[76:79], v[208:223]
    v_max3_f32 v19, v194, v195, v19
    s_waitcnt lgkmcnt(3)
    v_mfma_f32_32x32x16_bf16 v[208:223], v[48:51], v[80:83], v[208:223]
    v_max3_f32 v19, v196, v197, v19
    v_max3_f32 v19, v198, v199, v19
    s_waitcnt lgkmcnt(2)
    v_mfma_f32_32x32x16_bf16 v[208:223], v[52:55], v[84:87], v[208:223]
    v_max3_f32 v19, v200, v201, v19
    s_waitcnt lgkmcnt(1)
    v_mfma_f32_32x32x16_bf16 v[208:223], v[56:59], v[88:91], v[208:223]
    v_max3_f32 v19, v202, v203, v19
    s_waitcnt lgkmcnt(0)
    v_mfma_f32_32x32x16_bf16 v[208:223], v[60:63], v[92:95], v[208:223]
    v_max3_f32 v19, v204, v205, v19
    v_max3_f32 v19, v206, v207, v19
    s_nop 7
    s_nop 1
    v_max3_f32 v19, v208, v209, v19
    v_max3_f32 v19, v210, v211, v19
    v_max3_f32 v19, v212, v213, v19
    v_max3_f32 v19, v214, v215, v19
    v_max3_f32 v19, v216, v217, v19
    v_max3_f32 v19, v218, v219, v19
    v_max3_f32 v19, v220, v221, v19
    v_max3_f32 v19, v222, v223, v19
    v_mov_b32 v22, v19
    s_nop 1
    v_permlane32_swap_b32 v19, v22
    v_max_f32 v19, v19, v22
    v_mul_f32 v20, s44, v19
    v_mov_b32 v18, v19
    v_fma_f32 v160, v160, s44, -v20
    v_fma_f32 v161, v161, s44, -v20
    v_exp_f32 v160, v160
    v_exp_f32 v161, v161
    v_fma_f32 v162, v162, s44, -v20
    v_fma_f32 v163, v163, s44, -v20
    v_cvt_pk_bf16_f32 v160, v160, v161
    v_exp_f32 v162, v162
    v_exp_f32 v163, v163
    v_fma_f32 v164, v164, s44, -v20
    v_fma_f32 v165, v165, s44, -v20
    v_cvt_pk_bf16_f32 v161, v162, v163
    v_exp_f32 v164, v164
    v_exp_f32 v165, v165
    v_fma_f32 v166, v166, s44, -v20
    v_fma_f32 v167, v167, s44, -v20
    v_exp_f32 v166, v166
    v_exp_f32 v167, v167
    v_cvt_pk_bf16_f32 v162, v164, v165
    v_cvt_pk_bf16_f32 v163, v166, v167
    s_waitcnt vmcnt(12)
    s_barrier
    ds_read_b64_tr_b16 v[32:33], v17 offset:16384
    ds_read_b64_tr_b16 v[34:35], v17 offset:18432
    ds_read_b64_tr_b16 v[36:37], v17 offset:16640
    ds_read_b64_tr_b16 v[38:39], v17 offset:18688
    ds_read_b64_tr_b16 v[40:41], v17 offset:16896
    ds_read_b64_tr_b16 v[42:43], v17 offset:18944
    ds_read_b64_tr_b16 v[44:45], v17 offset:17152
    ds_read_b64_tr_b16 v[46:47], v17 offset:19200
    ds_read_b64_tr_b16 v[48:49], v17 offset:20480
    ds_read_b64_tr_b16 v[50:51], v17 offset:22528
    ds_read_b64_tr_b16 v[52:53], v17 offset:20736
    ds_read_b64_tr_b16 v[54:55], v17 offset:22784
    v_mfma_f32_16x16x32_bf16 v[24:27], v[28:31], v[160:163], 0
    s_waitcnt lgkmcnt(10)
    v_mfma_f32_32x32x16_bf16 v[96:111], v[32:35], v[160:163], 0
    ds_read_b64_tr_b16 v[56:57], v17 offset:20992
    ds_read_b64_tr_b16 v[58:59], v17 offset:23040
    s_add_u32 m0, s69, 114688
    s_xor_b32 s41, s70, 2048
    buffer_load_dwordx4 v5, s[8:11], s41 offen offset:0 nt lds
    v_fma_f32 v168, v168, s44, -v20
    v_fma_f32 v169, v169, s44, -v20
    v_exp_f32 v168, v168
    v_exp_f32 v169, v169
    v_fma_f32 v170, v170, s44, -v20
    s_waitcnt lgkmcnt(10)
    v_mfma_f32_32x32x16_bf16 v[112:127], v[36:39], v[160:163], 0
    ds_read_b64_tr_b16 v[60:61], v17 offset:21248
    ds_read_b64_tr_b16 v[62:63], v17 offset:23296
    v_fma_f32 v171, v171, s44, -v20
    v_cvt_pk_bf16_f32 v168, v168, v169
    v_exp_f32 v170, v170
    v_exp_f32 v171, v171
    v_fma_f32 v172, v172, s44, -v20
    s_waitcnt lgkmcnt(10)
    v_mfma_f32_32x32x16_bf16 v[128:143], v[40:43], v[160:163], 0
    ds_read_b64_tr_b16 v[32:33], v17 offset:24576
    ds_read_b64_tr_b16 v[34:35], v17 offset:26624
    s_add_u32 s41, s41, 7168
    buffer_load_dwordx4 v5, s[8:11], s41 offen offset:1024 nt lds
    v_fma_f32 v173, v173, s44, -v20
    v_cvt_pk_bf16_f32 v169, v170, v171
    v_exp_f32 v172, v172
    v_exp_f32 v173, v173
    v_fma_f32 v174, v174, s44, -v20
    s_waitcnt lgkmcnt(10)
    v_mfma_f32_32x32x16_bf16 v[144:159], v[44:47], v[160:163], 0
    ds_read_b64_tr_b16 v[36:37], v17 offset:24832
    ds_read_b64_tr_b16 v[38:39], v17 offset:26880
    v_fma_f32 v175, v175, s44, -v20
    v_exp_f32 v174, v174
    v_exp_f32 v175, v175
    v_cvt_pk_bf16_f32 v170, v172, v173
    v_cvt_pk_bf16_f32 v171, v174, v175
    s_nop 1
    v_mfma_f32_16x16x32_bf16 v[24:27], v[28:31], v[168:171], v[24:27]
    s_waitcnt lgkmcnt(10)
    v_mfma_f32_32x32x16_bf16 v[96:111], v[48:51], v[168:171], v[96:111]
    ds_read_b64_tr_b16 v[40:41], v17 offset:25088
    ds_read_b64_tr_b16 v[42:43], v17 offset:27136
    s_add_u32 s41, s41, 7168
    buffer_load_dwordx4 v5, s[8:11], s41 offen offset:2048 nt lds
    v_fma_f32 v176, v176, s44, -v20
    v_fma_f32 v177, v177, s44, -v20
    v_exp_f32 v176, v176
    v_exp_f32 v177, v177
    v_fma_f32 v178, v178, s44, -v20
    s_waitcnt lgkmcnt(10)
    v_mfma_f32_32x32x16_bf16 v[112:127], v[52:55], v[168:171], v[112:127]
    ds_read_b64_tr_b16 v[44:45], v17 offset:25344
    ds_read_b64_tr_b16 v[46:47], v17 offset:27392
    v_fma_f32 v179, v179, s44, -v20
    v_cvt_pk_bf16_f32 v176, v176, v177
    v_exp_f32 v178, v178
    v_exp_f32 v179, v179
    v_fma_f32 v180, v180, s44, -v20
    s_waitcnt lgkmcnt(10)
    v_mfma_f32_32x32x16_bf16 v[128:143], v[56:59], v[168:171], v[128:143]
    ds_read_b64_tr_b16 v[48:49], v17 offset:28672
    ds_read_b64_tr_b16 v[50:51], v17 offset:30720
    s_add_u32 s41, s41, 7168
    buffer_load_dwordx4 v5, s[8:11], s41 offen offset:3072 nt lds
    v_fma_f32 v181, v181, s44, -v20
    v_cvt_pk_bf16_f32 v177, v178, v179
    v_exp_f32 v180, v180
    v_exp_f32 v181, v181
    v_fma_f32 v182, v182, s44, -v20
    s_waitcnt lgkmcnt(10)
    v_mfma_f32_32x32x16_bf16 v[144:159], v[60:63], v[168:171], v[144:159]
    ds_read_b64_tr_b16 v[52:53], v17 offset:28928
    ds_read_b64_tr_b16 v[54:55], v17 offset:30976
    v_fma_f32 v183, v183, s44, -v20
    v_exp_f32 v182, v182
    v_exp_f32 v183, v183
    v_cvt_pk_bf16_f32 v178, v180, v181
    v_cvt_pk_bf16_f32 v179, v182, v183
    s_nop 1
    v_mfma_f32_16x16x32_bf16 v[24:27], v[28:31], v[176:179], v[24:27]
    s_waitcnt lgkmcnt(10)
    v_mfma_f32_32x32x16_bf16 v[96:111], v[32:35], v[176:179], v[96:111]
    ds_read_b64_tr_b16 v[56:57], v17 offset:29184
    ds_read_b64_tr_b16 v[58:59], v17 offset:31232
    v_fma_f32 v184, v184, s44, -v20
    v_fma_f32 v185, v185, s44, -v20
    v_exp_f32 v184, v184
    v_exp_f32 v185, v185
    v_fma_f32 v186, v186, s44, -v20
    s_waitcnt lgkmcnt(10)
    v_mfma_f32_32x32x16_bf16 v[112:127], v[36:39], v[176:179], v[112:127]
    ds_read_b64_tr_b16 v[60:61], v17 offset:29440
    ds_read_b64_tr_b16 v[62:63], v17 offset:31488
    v_fma_f32 v187, v187, s44, -v20
    v_cvt_pk_bf16_f32 v184, v184, v185
    v_exp_f32 v186, v186
    v_exp_f32 v187, v187
    v_fma_f32 v188, v188, s44, -v20
    s_waitcnt lgkmcnt(10)
    v_mfma_f32_32x32x16_bf16 v[128:143], v[40:43], v[176:179], v[128:143]
    v_fma_f32 v189, v189, s44, -v20
    v_cvt_pk_bf16_f32 v185, v186, v187
    v_exp_f32 v188, v188
    v_exp_f32 v189, v189
    v_fma_f32 v190, v190, s44, -v20
    s_waitcnt lgkmcnt(8)
    v_mfma_f32_32x32x16_bf16 v[144:159], v[44:47], v[176:179], v[144:159]
    v_fma_f32 v191, v191, s44, -v20
    v_exp_f32 v190, v190
    v_exp_f32 v191, v191
    v_cvt_pk_bf16_f32 v186, v188, v189
    v_cvt_pk_bf16_f32 v187, v190, v191
    s_nop 1
    v_mfma_f32_16x16x32_bf16 v[24:27], v[28:31], v[184:187], v[24:27]
    s_waitcnt lgkmcnt(6)
    v_mfma_f32_32x32x16_bf16 v[96:111], v[48:51], v[184:187], v[96:111]
    v_fma_f32 v192, v192, s44, -v20
    v_fma_f32 v193, v193, s44, -v20
    v_exp_f32 v192, v192
    v_exp_f32 v193, v193
    v_fma_f32 v194, v194, s44, -v20
    s_waitcnt lgkmcnt(4)
    v_mfma_f32_32x32x16_bf16 v[112:127], v[52:55], v[184:187], v[112:127]
    v_fma_f32 v195, v195, s44, -v20
    v_cvt_pk_bf16_f32 v192, v192, v193
    v_exp_f32 v194, v194
    v_exp_f32 v195, v195
    v_fma_f32 v196, v196, s44, -v20
    s_waitcnt lgkmcnt(2)
    v_mfma_f32_32x32x16_bf16 v[128:143], v[56:59], v[184:187], v[128:143]
    v_fma_f32 v197, v197, s44, -v20
    v_cvt_pk_bf16_f32 v193, v194, v195
    v_exp_f32 v196, v196
    v_exp_f32 v197, v197
    v_fma_f32 v198, v198, s44, -v20
    s_waitcnt lgkmcnt(0)
    v_mfma_f32_32x32x16_bf16 v[144:159], v[60:63], v[184:187], v[144:159]
    v_fma_f32 v199, v199, s44, -v20
    v_exp_f32 v198, v198
    v_exp_f32 v199, v199
    v_cvt_pk_bf16_f32 v194, v196, v197
    v_cvt_pk_bf16_f32 v195, v198, v199
    s_waitcnt vmcnt(12)
    s_barrier
    ds_read_b64_tr_b16 v[32:33], v15 offset:16384
    ds_read_b64_tr_b16 v[34:35], v15 offset:18432
    ds_read_b64_tr_b16 v[36:37], v15 offset:16640
    ds_read_b64_tr_b16 v[38:39], v15 offset:18688
    ds_read_b64_tr_b16 v[40:41], v15 offset:16896
    ds_read_b64_tr_b16 v[42:43], v15 offset:18944
    ds_read_b64_tr_b16 v[44:45], v15 offset:17152
    ds_read_b64_tr_b16 v[46:47], v15 offset:19200
    ds_read_b64_tr_b16 v[48:49], v15 offset:20480
    ds_read_b64_tr_b16 v[50:51], v15 offset:22528
    ds_read_b64_tr_b16 v[52:53], v15 offset:20736
    ds_read_b64_tr_b16 v[54:55], v15 offset:22784
    v_mfma_f32_16x16x32_bf16 v[24:27], v[28:31], v[192:195], v[24:27]
    s_waitcnt lgkmcnt(10)
    v_mfma_f32_32x32x16_bf16 v[96:111], v[32:35], v[192:195], v[96:111]
    ds_read_b64_tr_b16 v[56:57], v15 offset:20992
    ds_read_b64_tr_b16 v[58:59], v15 offset:23040
    s_add_u32 m0, s69, 131072
    s_xor_b32 s41, s70, 3072
    buffer_load_dwordx4 v5, s[8:11], s41 offen offset:0 nt lds
    v_fma_f32 v200, v200, s44, -v20
    v_fma_f32 v201, v201, s44, -v20
    v_exp_f32 v200, v200
    v_exp_f32 v201, v201
    v_fma_f32 v202, v202, s44, -v20
    s_waitcnt lgkmcnt(10)
    v_mfma_f32_32x32x16_bf16 v[112:127], v[36:39], v[192:195], v[112:127]
    ds_read_b64_tr_b16 v[60:61], v15 offset:21248
    ds_read_b64_tr_b16 v[62:63], v15 offset:23296
    v_fma_f32 v203, v203, s44, -v20
    v_cvt_pk_bf16_f32 v200, v200, v201
    v_exp_f32 v202, v202
    v_exp_f32 v203, v203
    v_fma_f32 v204, v204, s44, -v20
    s_waitcnt lgkmcnt(10)
    v_mfma_f32_32x32x16_bf16 v[128:143], v[40:43], v[192:195], v[128:143]
    ds_read_b64_tr_b16 v[32:33], v15 offset:24576
    ds_read_b64_tr_b16 v[34:35], v15 offset:26624
    s_add_u32 s41, s41, 7168
    buffer_load_dwordx4 v5, s[8:11], s41 offen offset:1024 nt lds
    v_fma_f32 v205, v205, s44, -v20
    v_cvt_pk_bf16_f32 v201, v202, v203
    v_exp_f32 v204, v204
    v_exp_f32 v205, v205
    v_fma_f32 v206, v206, s44, -v20
    s_waitcnt lgkmcnt(10)
    v_mfma_f32_32x32x16_bf16 v[144:159], v[44:47], v[192:195], v[144:159]
    ds_read_b64_tr_b16 v[36:37], v15 offset:24832
    ds_read_b64_tr_b16 v[38:39], v15 offset:26880
    v_fma_f32 v207, v207, s44, -v20
    v_exp_f32 v206, v206
    v_exp_f32 v207, v207
    v_cvt_pk_bf16_f32 v202, v204, v205
    v_cvt_pk_bf16_f32 v203, v206, v207
    s_nop 1
    v_mfma_f32_16x16x32_bf16 v[24:27], v[28:31], v[200:203], v[24:27]
    s_waitcnt lgkmcnt(10)
    v_mfma_f32_32x32x16_bf16 v[96:111], v[48:51], v[200:203], v[96:111]
    ds_read_b64_tr_b16 v[40:41], v15 offset:25088
    ds_read_b64_tr_b16 v[42:43], v15 offset:27136
    s_add_u32 s41, s41, 7168
    buffer_load_dwordx4 v5, s[8:11], s41 offen offset:2048 nt lds
    v_fma_f32 v208, v208, s44, -v20
    v_fma_f32 v209, v209, s44, -v20
    v_exp_f32 v208, v208
    v_exp_f32 v209, v209
    v_fma_f32 v210, v210, s44, -v20
    s_waitcnt lgkmcnt(10)
    v_mfma_f32_32x32x16_bf16 v[112:127], v[52:55], v[200:203], v[112:127]
    ds_read_b64_tr_b16 v[44:45], v15 offset:25344
    ds_read_b64_tr_b16 v[46:47], v15 offset:27392
    v_fma_f32 v211, v211, s44, -v20
    v_cvt_pk_bf16_f32 v208, v208, v209
    v_exp_f32 v210, v210
    v_exp_f32 v211, v211
    v_fma_f32 v212, v212, s44, -v20
    s_waitcnt lgkmcnt(10)
    v_mfma_f32_32x32x16_bf16 v[128:143], v[56:59], v[200:203], v[128:143]
    ds_read_b64_tr_b16 v[48:49], v15 offset:28672
    ds_read_b64_tr_b16 v[50:51], v15 offset:30720
    s_add_u32 s41, s41, 7168
    buffer_load_dwordx4 v5, s[8:11], s41 offen offset:3072 nt lds
    v_fma_f32 v213, v213, s44, -v20
    v_cvt_pk_bf16_f32 v209, v210, v211
    v_exp_f32 v212, v212
    v_exp_f32 v213, v213
    v_fma_f32 v214, v214, s44, -v20
    s_waitcnt lgkmcnt(10)
    v_mfma_f32_32x32x16_bf16 v[144:159], v[60:63], v[200:203], v[144:159]
    ds_read_b64_tr_b16 v[52:53], v15 offset:28928
    ds_read_b64_tr_b16 v[54:55], v15 offset:30976
    v_fma_f32 v215, v215, s44, -v20
    v_exp_f32 v214, v214
    v_exp_f32 v215, v215
    v_cvt_pk_bf16_f32 v210, v212, v213
    v_cvt_pk_bf16_f32 v211, v214, v215
    s_nop 1
    v_mfma_f32_16x16x32_bf16 v[24:27], v[28:31], v[208:211], v[24:27]
    s_waitcnt lgkmcnt(10)
    v_mfma_f32_32x32x16_bf16 v[96:111], v[32:35], v[208:211], v[96:111]
    ds_read_b64_tr_b16 v[56:57], v15 offset:29184
    ds_read_b64_tr_b16 v[58:59], v15 offset:31232
    v_fma_f32 v216, v216, s44, -v20
    v_fma_f32 v217, v217, s44, -v20
    v_exp_f32 v216, v216
    v_exp_f32 v217, v217
    v_fma_f32 v218, v218, s44, -v20
    s_waitcnt lgkmcnt(10)
    v_mfma_f32_32x32x16_bf16 v[112:127], v[36:39], v[208:211], v[112:127]
    ds_read_b64_tr_b16 v[60:61], v15 offset:29440
    ds_read_b64_tr_b16 v[62:63], v15 offset:31488
    v_fma_f32 v219, v219, s44, -v20
    v_cvt_pk_bf16_f32 v216, v216, v217
    v_exp_f32 v218, v218
    v_exp_f32 v219, v219
    v_fma_f32 v220, v220, s44, -v20
    s_waitcnt lgkmcnt(10)
    v_mfma_f32_32x32x16_bf16 v[128:143], v[40:43], v[208:211], v[128:143]
    v_fma_f32 v221, v221, s44, -v20
    v_cvt_pk_bf16_f32 v217, v218, v219
    v_exp_f32 v220, v220
    v_exp_f32 v221, v221
    v_fma_f32 v222, v222, s44, -v20
    s_waitcnt lgkmcnt(8)
    v_mfma_f32_32x32x16_bf16 v[144:159], v[44:47], v[208:211], v[144:159]
    v_fma_f32 v223, v223, s44, -v20
    v_exp_f32 v222, v222
    v_exp_f32 v223, v223
    v_cvt_pk_bf16_f32 v218, v220, v221
    v_cvt_pk_bf16_f32 v219, v222, v223
    s_nop 1
    v_mfma_f32_16x16x32_bf16 v[24:27], v[28:31], v[216:219], v[24:27]
    s_waitcnt lgkmcnt(6)
    v_mfma_f32_32x32x16_bf16 v[96:111], v[48:51], v[216:219], v[96:111]
    s_waitcnt lgkmcnt(4)
    v_mfma_f32_32x32x16_bf16 v[112:127], v[52:55], v[216:219], v[112:127]
    s_waitcnt lgkmcnt(2)
    v_mfma_f32_32x32x16_bf16 v[128:143], v[56:59], v[216:219], v[128:143]
    s_waitcnt lgkmcnt(0)
    v_mfma_f32_32x32x16_bf16 v[144:159], v[60:63], v[216:219], v[144:159]
    s_waitcnt vmcnt(12)
    s_barrier
    s_cmp_ge_u32 s68, 2
    s_cbranch_scc0 a_t3
    v_lshlrev_b32 v22, 7, v0
    buffer_load_dword v4, v22, s[24:27], s40 offen offset:0
a_t3:
    s_nop 1
    ds_read_b128 v[32:35], v9 offset:32768
    ds_read_b128 v[36:39], v10 offset:32768
    ds_read_b128 v[40:43], v9 offset:33024
    ds_read_b128 v[44:47], v10 offset:33024
    ds_read_b128 v[48:51], v9 offset:33280
    ds_read_b128 v[52:55], v10 offset:33280
    s_waitcnt lgkmcnt(5)
    v_mfma_f32_32x32x16_bf16 v[160:175], v[32:35], v[64:67], 0
    ds_read_b128 v[56:59], v9 offset:33536
    s_add_u32 m0, s69, 65536
    s_xor_b32 s41, s70, 4096
    buffer_load_dwordx4 v5, s[4:7], s41 offen offset:0 nt lds
    s_waitcnt lgkmcnt(5)
    v_mfma_f32_32x32x16_bf16 v[160:175], v[36:39], v[68:71], v[160:175]
    ds_read_b128 v[60:63], v10 offset:33536
    s_waitcnt lgkmcnt(5)
    v_mfma_f32_32x32x16_bf16 v[160:175], v[40:43], v[72:75], v[160:175]
    ds_read_b128 v[32:35], v9 offset:40960
    s_add_u32 s41, s41, 7168
    buffer_load_dwordx4 v6, s[4:7], s41 offen offset:1024 nt lds
    s_waitcnt lgkmcnt(5)
    v_mfma_f32_32x32x16_bf16 v[160:175], v[44:47], v[76:79], v[160:175]
    ds_read_b128 v[36:39], v10 offset:40960
    s_waitcnt lgkmcnt(5)
    v_mfma_f32_32x32x16_bf16 v[160:175], v[48:51], v[80:83], v[160:175]
    ds_read_b128 v[40:43], v9 offset:41216
    s_add_u32 s41, s41, 7168
    buffer_load_dwordx4 v7, s[4:7], s41 offen offset:2048 nt lds
    s_waitcnt lgkmcnt(5)
    v_mfma_f32_32x32x16_bf16 v[160:175], v[52:55], v[84:87], v[160:175]
    ds_read_b128 v[44:47], v10 offset:41216
    s_waitcnt lgkmcnt(5)
    v_mfma_f32_32x32x16_bf16 v[160:175], v[56:59], v[88:91], v[160:175]
    ds_read_b128 v[48:51], v9 offset:41472
    s_add_u32 s41, s41, 7168
    buffer_load_dwordx4 v8, s[4:7], s41 offen offset:3072 nt lds
    s_waitcnt lgkmcnt(5)
    v_mfma_f32_32x32x16_bf16 v[160:175], v[60:63], v[92:95], v[160:175]
    ds_read_b128 v[52:55], v10 offset:41472
    s_waitcnt lgkmcnt(5)
    v_mfma_f32_32x32x16_bf16 v[176:191], v[32:35], v[64:67], 0
    ds_read_b128 v[56:59], v9 offset:41728
    s_waitcnt lgkmcnt(5)
    v_mfma_f32_32x32x16_bf16 v[176:191], v[36:39], v[68:71], v[176:191]
    ds_read_b128 v[60:63], v10 offset:41728
    s_waitcnt lgkmcnt(5)
    v_mfma_f32_32x32x16_bf16 v[176:191], v[40:43], v[72:75], v[176:191]
    s_nop 2
    v_max3_f32 v19, v160, v161, v18
    s_waitcnt lgkmcnt(4)
    v_mfma_f32_32x32x16_bf16 v[176:191], v[44:47], v[76:79], v[176:191]
    v_max3_f32 v19, v162, v163, v19
    s_waitcnt lgkmcnt(3)
    v_mfma_f32_32x32x16_bf16 v[176:191], v[48:51], v[80:83], v[176:191]
    v_max3_f32 v19, v164, v165, v19
    v_max3_f32 v19, v166, v167, v19
    s_waitcnt lgkmcnt(2)
    v_mfma_f32_32x32x16_bf16 v[176:191], v[52:55], v[84:87], v[176:191]
    v_max3_f32 v19, v168, v169, v19
    s_waitcnt lgkmcnt(1)
    v_mfma_f32_32x32x16_bf16 v[176:191], v[56:59], v[88:91], v[176:191]
    v_max3_f32 v19, v170, v171, v19
    s_waitcnt lgkmcnt(0)
    v_mfma_f32_32x32x16_bf16 v[176:191], v[60:63], v[92:95], v[176:191]
    v_max3_f32 v19, v172, v173, v19
    v_max3_f32 v19, v174, v175, v19
    s_waitcnt vmcnt(12)
    s_barrier
    ds_read_b128 v[32:35], v9 offset:49152
    ds_read_b128 v[36:39], v10 offset:49152
    ds_read_b128 v[40:43], v9 offset:49408
    ds_read_b128 v[44:47], v10 offset:49408
    ds_read_b128 v[48:51], v9 offset:49664
    ds_read_b128 v[52:55], v10 offset:49664
    s_waitcnt lgkmcnt(5)
    v_mfma_f32_32x32x16_bf16 v[192:207], v[32:35], v[64:67], 0
    ds_read_b128 v[56:59], v9 offset:49920
    s_add_u32 m0, s69, 147456
    s_xor_b32 s41, s70, 5120
    buffer_load_dwordx4 v5, s[4:7], s41 offen offset:0 nt lds
    s_waitcnt lgkmcnt(5)
    v_mfma_f32_32x32x16_bf16 v[192:207], v[36:39], v[68:71], v[192:207]
    ds_read_b128 v[60:63], v10 offset:49920
    v_max3_f32 v19, v176, v177, v19
    s_waitcnt lgkmcnt(5)
    v_mfma_f32_32x32x16_bf16 v[192:207], v[40:43], v[72:75], v[192:207]
    ds_read_b128 v[32:35], v9 offset:57344
    s_add_u32 s41, s41, 7168
    buffer_load_dwordx4 v6, s[4:7], s41 offen offset:1024 nt lds
    v_max3_f32 v19, v178, v179, v19
    s_waitcnt lgkmcnt(5)
    v_mfma_f32_32x32x16_bf16 v[192:207], v[44:47], v[76:79], v[192:207]
    ds_read_b128 v[36:39], v10 offset:57344
    v_max3_f32 v19, v180, v181, v19
    s_waitcnt lgkmcnt(5)
    v_mfma_f32_32x32x16_bf16 v[192:207], v[48:51], v[80:83], v[192:207]
    ds_read_b128 v[40:43], v9 offset:57600
    s_add_u32 s41, s41, 7168
    buffer_load_dwordx4 v7, s[4:7], s41 offen offset:2048 nt lds
    v_max3_f32 v19, v182, v183, v19
    s_waitcnt lgkmcnt(5)
    v_mfma_f32_32x32x16_bf16 v[192:207], v[52:55], v[84:87], v[192:207]
    ds_read_b128 v[44:47], v10 offset:57600
    s_waitcnt lgkmcnt(5)
    v_mfma_f32_32x32x16_bf16 v[192:207], v[56:59], v[88:91], v[192:207]
    ds_read_b128 v[48:51], v9 offset:57856
    s_add_u32 s41, s41, 7168
    buffer_load_dwordx4 v8, s[4:7], s41 offen offset:3072 nt lds
    v_max3_f32 v19, v184, v185, v19
    s_waitcnt lgkmcnt(5)
    v_mfma_f32_32x32x16_bf16 v[192:207], v[60:63], v[92:95], v[192:207]
    ds_read_b128 v[52:55], v10 offset:57856
    v_max3_f32 v19, v186, v187, v19
    s_waitcnt lgkmcnt(5)
    v_mfma_f32_32x32x16_bf16 v[208:223], v[32:35], v[64:67], 0
    ds_read_b128 v[56:59], v9 offset:58112
    v_max3_f32 v19, v188, v189, v19
    s_waitcnt lgkmcnt(5)
    v_mfma_f32_32x32x16_bf16 v[208:223], v[36:39], v[68:71], v[208:223]
    ds_read_b128 v[60:63], v10 offset:58112
    v_max3_f32 v19, v190, v191, v19
    s_waitcnt lgkmcnt(5)
    v_mfma_f32_32x32x16_bf16 v[208:223], v[40:43], v[72:75], v[208:223]
    v_max3_f32 v19, v192, v193, v19
    s_waitcnt lgkmcnt(4)
    v_mfma_f32_32x32x16_bf16 v[208:223], v[44:47], v[76:79], v[208:223]
    v_max3_f32 v19, v194, v195, v19
    s_waitcnt lgkmcnt(3)
    v_mfma_f32_32x32x16_bf16 v[208:223], v[48:51], v[80:83], v[208:223]
    v_max3_f32 v19, v196, v197, v19
    v_max3_f32 v19, v198, v199, v19
    s_waitcnt lgkmcnt(2)
    v_mfma_f32_32x32x16_bf16 v[208:223], v[52:55], v[84:87], v[208:223]
    v_max3_f32 v19, v200, v201, v19
    s_waitcnt lgkmcnt(1)
    v_mfma_f32_32x32x16_bf16 v[208:223], v[56:59], v[88:91], v[208:223]
    v_max3_f32 v19, v202, v203, v19
    s_waitcnt lgkmcnt(0)
    v_mfma_f32_32x32x16_bf16 v[208:223], v[60:63], v[92:95], v[208:223]
    v_max3_f32 v19, v204, v205, v19
    v_max3_f32 v19, v206, v207, v19
    s_nop 7
    s_nop 1
    v_max3_f32 v19, v208, v209, v19
    v_max3_f32 v19, v210, v211, v19
    v_max3_f32 v19, v212, v213, v19
    v_max3_f32 v19, v214, v215, v19
    v_max3_f32 v19, v216, v217, v19
    v_max3_f32 v19, v218, v219, v19
    v_max3_f32 v19, v220, v221, v19
    v_max3_f32 v19, v222, v223, v19
    v_mov_b32 v22, v19
    s_nop 1
    v_permlane32_swap_b32 v19, v22
    v_max_f32 v19, v19, v22
    v_mul_f32 v20, s44, v19
    v_fma_f32 v2, v18, s44, -v20
    v_exp_f32 v2, v2
    v_mov_b32 v18, v19
    v_fma_f32 v160, v160, s44, -v20
    v_fma_f32 v161, v161, s44, -v20
    v_exp_f32 v160, v160
    v_exp_f32 v161, v161
    v_fma_f32 v162, v162, s44, -v20
    v_fma_f32 v163, v163, s44, -v20
    v_cvt_pk_bf16_f32 v160, v160, v161
    v_exp_f32 v162, v162
    v_exp_f32 v163, v163
    v_fma_f32 v164, v164, s44, -v20
    v_fma_f32 v165, v165, s44, -v20
    v_cvt_pk_bf16_f32 v161, v162, v163
    v_exp_f32 v164, v164
    v_exp_f32 v165, v165
    v_fma_f32 v166, v166, s44, -v20
    v_fma_f32 v167, v167, s44, -v20
    v_exp_f32 v166, v166
    v_exp_f32 v167, v167
    v_cvt_pk_bf16_f32 v162, v164, v165
    v_cvt_pk_bf16_f32 v163, v166, v167
    v_mul_f32 v24, v24, v2
    v_mul_f32 v96, v96, v2
    v_mul_f32 v97, v97, v2
    v_mul_f32 v98, v98, v2
    v_mul_f32 v99, v99, v2
    v_mul_f32 v100, v100, v2
    v_mul_f32 v101, v101, v2
    v_mul_f32 v102, v102, v2
    v_mul_f32 v103, v103, v2
    v_mul_f32 v104, v104, v2
    v_mul_f32 v105, v105, v2
    v_mul_f32 v106, v106, v2
    v_mul_f32 v107, v107, v2
    v_mul_f32 v108, v108, v2
    v_mul_f32 v109, v109, v2
    v_mul_f32 v110, v110, v2
    v_mul_f32 v111, v111, v2
    s_waitcnt vmcnt(12)
    s_barrier
    ds_read_b64_tr_b16 v[32:33], v16 offset:49152
    ds_read_b64_tr_b16 v[34:35], v16 offset:51200
    ds_read_b64_tr_b16 v[36:37], v16 offset:49408
    ds_read_b64_tr_b16 v[38:39], v16 offset:51456
    ds_read_b64_tr_b16 v[40:41], v16 offset:49664
    ds_read_b64_tr_b16 v[42:43], v16 offset:51712
    ds_read_b64_tr_b16 v[44:45], v16 offset:49920
    ds_read_b64_tr_b16 v[46:47], v16 offset:51968
    ds_read_b64_tr_b16 v[48:49], v16 offset:53248
    ds_read_b64_tr_b16 v[50:51], v16 offset:55296
    ds_read_b64_tr_b16 v[52:53], v16 offset:53504
    ds_read_b64_tr_b16 v[54:55], v16 offset:55552
    v_mfma_f32_16x16x32_bf16 v[24:27], v[28:31], v[160:163], v[24:27]
    s_waitcnt lgkmcnt(10)
    v_mfma_f32_32x32x16_bf16 v[96:111], v[32:35], v[160:163], v[96:111]
    ds_read_b64_tr_b16 v[56:57], v16 offset:53760
    ds_read_b64_tr_b16 v[58:59], v16 offset:55808
    s_add_u32 m0, s69, 49152
    s_xor_b32 s41, s70, 4096
    buffer_load_dwordx4 v5, s[8:11], s41 offen offset:0 nt lds
    v_fma_f32 v168, v168, s44, -v20
    v_fma_f32 v169, v169, s44, -v20
    v_exp_f32 v168, v168
    v_exp_f32 v169, v169
    v_fma_f32 v170, v170, s44, -v20
    v_mul_f32 v112, v112, v2
    v_mul_f32 v113, v113, v2
    v_mul_f32 v114, v114, v2
    v_mul_f32 v115, v115, v2
    v_mul_f32 v116, v116, v2
    v_mul_f32 v117, v117, v2
    v_mul_f32 v118, v118, v2
    v_mul_f32 v119, v119, v2
    v_mul_f32 v120, v120, v2
    v_mul_f32 v121, v121, v2
    v_mul_f32 v122, v122, v2
    v_mul_f32 v123, v123, v2
    v_mul_f32 v124, v124, v2
    v_mul_f32 v125, v125, v2
    v_mul_f32 v126, v126, v2
    v_mul_f32 v127, v127, v2
    s_waitcnt lgkmcnt(10)
    s_nop 0
    v_mfma_f32_32x32x16_bf16 v[112:127], v[36:39], v[160:163], v[112:127]
    ds_read_b64_tr_b16 v[60:61], v16 offset:54016
    ds_read_b64_tr_b16 v[62:63], v16 offset:56064
    v_fma_f32 v171, v171, s44, -v20
    v_cvt_pk_bf16_f32 v168, v168, v169
    v_exp_f32 v170, v170
    v_exp_f32 v171, v171
    v_fma_f32 v172, v172, s44, -v20
    v_mul_f32 v128, v128, v2
    v_mul_f32 v129, v129, v2
    v_mul_f32 v130, v130, v2
    v_mul_f32 v131, v131, v2
    v_mul_f32 v132, v132, v2
    v_mul_f32 v133, v133, v2
    v_mul_f32 v134, v134, v2
    v_mul_f32 v135, v135, v2
    v_mul_f32 v136, v136, v2
    v_mul_f32 v137, v137, v2
    v_mul_f32 v138, v138, v2
    v_mul_f32 v139, v139, v2
    v_mul_f32 v140, v140, v2
    v_mul_f32 v141, v141, v2
    v_mul_f32 v142, v142, v2
    v_mul_f32 v143, v143, v2
    s_waitcnt lgkmcnt(10)
    s_nop 0
    v_mfma_f32_32x32x16_bf16 v[128:143], v[40:43], v[160:163], v[128:143]
    ds_read_b64_tr_b16 v[32:33], v16 offset:57344
    ds_read_b64_tr_b16 v[34:35], v16 offset:59392
    s_add_u32 s41, s41, 7168
    buffer_load_dwordx4 v5, s[8:11], s41 offen offset:1024 nt lds
    v_fma_f32 v173, v173, s44, -v20
    v_cvt_pk_bf16_f32 v169, v170, v171
    v_exp_f32 v172, v172
    v_exp_f32 v173, v173
    v_fma_f32 v174, v174, s44, -v20
    v_mul_f32 v144, v144, v2
    v_mul_f32 v145, v145, v2
    v_mul_f32 v146, v146, v2
    v_mul_f32 v147, v147, v2
    v_mul_f32 v148, v148, v2
    v_mul_f32 v149, v149, v2
    v_mul_f32 v150, v150, v2
    v_mul_f32 v151, v151, v2
    v_mul_f32 v152, v152, v2
    v_mul_f32 v153, v153, v2
    v_mul_f32 v154, v154, v2
    v_mul_f32 v155, v155, v2
    v_mul_f32 v156, v156, v2
    v_mul_f32 v157, v157, v2
    v_mul_f32 v158, v158, v2
    v_mul_f32 v159, v159, v2
    s_waitcnt lgkmcnt(10)
    s_nop 0
    v_mfma_f32_32x32x16_bf16 v[144:159], v[44:47], v[160:163], v[144:159]
    ds_read_b64_tr_b16 v[36:37], v16 offset:57600
    ds_read_b64_tr_b16 v[38:39], v16 offset:59648
    v_fma_f32 v175, v175, s44, -v20
    v_exp_f32 v174, v174
    v_exp_f32 v175, v175
    v_cvt_pk_bf16_f32 v170, v172, v173
    v_cvt_pk_bf16_f32 v171, v174, v175
    s_nop 1
    v_mfma_f32_16x16x32_bf16 v[24:27], v[28:31], v[168:171], v[24:27]
    s_waitcnt lgkmcnt(10)
    v_mfma_f32_32x32x16_bf16 v[96:111], v[48:51], v[168:171], v[96:111]
    ds_read_b64_tr_b16 v[40:41], v16 offset:57856
    ds_read_b64_tr_b16 v[42:43], v16 offset:59904
    s_add_u32 s41, s41, 7168
    buffer_load_dwordx4 v5, s[8:11], s41 offen offset:2048 nt lds
    v_fma_f32 v176, v176, s44, -v20
    v_fma_f32 v177, v177, s44, -v20
    v_exp_f32 v176, v176
    v_exp_f32 v177, v177
    v_fma_f32 v178, v178, s44, -v20
    s_waitcnt lgkmcnt(10)
    v_mfma_f32_32x32x16_bf16 v[112:127], v[52:55], v[168:171], v[112:127]
    ds_read_b64_tr_b16 v[44:45], v16 offset:58112
    ds_read_b64_tr_b16 v[46:47], v16 offset:60160
    v_fma_f32 v179, v179, s44, -v20
    v_cvt_pk_bf16_f32 v176, v176, v177
    v_exp_f32 v178, v178
    v_exp_f32 v179, v179
    v_fma_f32 v180, v180, s44, -v20
    s_waitcnt lgkmcnt(10)
    v_mfma_f32_32x32x16_bf16 v[128:143], v[56:59], v[168:171], v[128:143]
    ds_read_b64_tr_b16 v[48:49], v16 offset:61440
    ds_read_b64_tr_b16 v[50:51], v16 offset:63488
    s_add_u32 s41, s41, 7168
    buffer_load_dwordx4 v5, s[8:11], s41 offen offset:3072 nt lds
    v_fma_f32 v181, v181, s44, -v20
    v_cvt_pk_bf16_f32 v177, v178, v179
    v_exp_f32 v180, v180
    v_exp_f32 v181, v181
    v_fma_f32 v182, v182, s44, -v20
    s_waitcnt lgkmcnt(10)
    v_mfma_f32_32x32x16_bf16 v[144:159], v[60:63], v[168:171], v[144:159]
    ds_read_b64_tr_b16 v[52:53], v16 offset:61696
    ds_read_b64_tr_b16 v[54:55], v16 offset:63744
    v_fma_f32 v183, v183, s44, -v20
    v_exp_f32 v182, v182
    v_exp_f32 v183, v183
    v_cvt_pk_bf16_f32 v178, v180, v181
    v_cvt_pk_bf16_f32 v179, v182, v183
    s_nop 1
    v_mfma_f32_16x16x32_bf16 v[24:27], v[28:31], v[176:179], v[24:27]
    s_waitcnt lgkmcnt(10)
    v_mfma_f32_32x32x16_bf16 v[96:111], v[32:35], v[176:179], v[96:111]
    ds_read_b64_tr_b16 v[56:57], v16 offset:61952
    ds_read_b64_tr_b16 v[58:59], v16 offset:64000
    v_fma_f32 v184, v184, s44, -v20
    v_fma_f32 v185, v185, s44, -v20
    v_exp_f32 v184, v184
    v_exp_f32 v185, v185
    v_fma_f32 v186, v186, s44, -v20
    s_waitcnt lgkmcnt(10)
    v_mfma_f32_32x32x16_bf16 v[112:127], v[36:39], v[176:179], v[112:127]
    ds_read_b64_tr_b16 v[60:61], v16 offset:62208
    ds_read_b64_tr_b16 v[62:63], v16 offset:64256
    v_fma_f32 v187, v187, s44, -v20
    v_cvt_pk_bf16_f32 v184, v184, v185
    v_exp_f32 v186, v186
    v_exp_f32 v187, v187
    v_fma_f32 v188, v188, s44, -v20
    s_waitcnt lgkmcnt(10)
    v_mfma_f32_32x32x16_bf16 v[128:143], v[40:43], v[176:179], v[128:143]
    v_fma_f32 v189, v189, s44, -v20
    v_cvt_pk_bf16_f32 v185, v186, v187
    v_exp_f32 v188, v188
    v_exp_f32 v189, v189
    v_fma_f32 v190, v190, s44, -v20
    s_waitcnt lgkmcnt(8)
    v_mfma_f32_32x32x16_bf16 v[144:159], v[44:47], v[176:179], v[144:159]
    v_fma_f32 v191, v191, s44, -v20
    v_exp_f32 v190, v190
    v_exp_f32 v191, v191
    v_cvt_pk_bf16_f32 v186, v188, v189
    v_cvt_pk_bf16_f32 v187, v190, v191
    s_nop 1
    v_mfma_f32_16x16x32_bf16 v[24:27], v[28:31], v[184:187], v[24:27]
    s_waitcnt lgkmcnt(6)
    v_mfma_f32_32x32x16_bf16 v[96:111], v[48:51], v[184:187], v[96:111]
    v_fma_f32 v192, v192, s44, -v20
    v_fma_f32 v193, v193, s44, -v20
    v_exp_f32 v192, v192
    v_exp_f32 v193, v193
    v_fma_f32 v194, v194, s44, -v20
    s_waitcnt lgkmcnt(4)
    v_mfma_f32_32x32x16_bf16 v[112:127], v[52:55], v[184:187], v[112:127]
    v_fma_f32 v195, v195, s44, -v20
    v_cvt_pk_bf16_f32 v192, v192, v193
    v_exp_f32 v194, v194
    v_exp_f32 v195, v195
    v_fma_f32 v196, v196, s44, -v20
    s_waitcnt lgkmcnt(2)
    v_mfma_f32_32x32x16_bf16 v[128:143], v[56:59], v[184:187], v[128:143]
    v_fma_f32 v197, v197, s44, -v20
    v_cvt_pk_bf16_f32 v193, v194, v195
    v_exp_f32 v196, v196
    v_exp_f32 v197, v197
    v_fma_f32 v198, v198, s44, -v20
    s_waitcnt lgkmcnt(0)
    v_mfma_f32_32x32x16_bf16 v[144:159], v[60:63], v[184:187], v[144:159]
    v_fma_f32 v199, v199, s44, -v20
    v_exp_f32 v198, v198
    v_exp_f32 v199, v199
    v_cvt_pk_bf16_f32 v194, v196, v197
    v_cvt_pk_bf16_f32 v195, v198, v199
    s_waitcnt vmcnt(12)
    s_barrier
    ds_read_b64_tr_b16 v[32:33], v17 offset:0
    ds_read_b64_tr_b16 v[34:35], v17 offset:2048
    ds_read_b64_tr_b16 v[36:37], v17 offset:256
    ds_read_b64_tr_b16 v[38:39], v17 offset:2304
    ds_read_b64_tr_b16 v[40:41], v17 offset:512
    ds_read_b64_tr_b16 v[42:43], v17 offset:2560
    ds_read_b64_tr_b16 v[44:45], v17 offset:768
    ds_read_b64_tr_b16 v[46:47], v17 offset:2816
    ds_read_b64_tr_b16 v[48:49], v17 offset:4096
    ds_read_b64_tr_b16 v[50:51], v17 offset:6144
    ds_read_b64_tr_b16 v[52:53], v17 offset:4352
    ds_read_b64_tr_b16 v[54:55], v17 offset:6400
    v_mfma_f32_16x16x32_bf16 v[24:27], v[28:31], v[192:195], v[24:27]
    s_waitcnt lgkmcnt(10)
    v_mfma_f32_32x32x16_bf16 v[96:111], v[32:35], v[192:195], v[96:111]
    ds_read_b64_tr_b16 v[56:57], v17 offset:4608
    ds_read_b64_tr_b16 v[58:59], v17 offset:6656
    s_add_u32 m0, s69, 81920
    s_xor_b32 s41, s70, 5120
    buffer_load_dwordx4 v5, s[8:11], s41 offen offset:0 nt lds
    v_fma_f32 v200, v200, s44, -v20
    v_fma_f32 v201, v201, s44, -v20
    v_exp_f32 v200, v200
    v_exp_f32 v201, v201
    v_fma_f32 v202, v202, s44, -v20
    s_waitcnt lgkmcnt(10)
    v_mfma_f32_32x32x16_bf16 v[112:127], v[36:39], v[192:195], v[112:127]
    ds_read_b64_tr_b16 v[60:61], v17 offset:4864
    ds_read_b64_tr_b16 v[62:63], v17 offset:6912
    v_fma_f32 v203, v203, s44, -v20
    v_cvt_pk_bf16_f32 v200, v200, v201
    v_exp_f32 v202, v202
    v_exp_f32 v203, v203
    v_fma_f32 v204, v204, s44, -v20
    s_waitcnt lgkmcnt(10)
    v_mfma_f32_32x32x16_bf16 v[128:143], v[40:43], v[192:195], v[128:143]
    ds_read_b64_tr_b16 v[32:33], v17 offset:8192
    ds_read_b64_tr_b16 v[34:35], v17 offset:10240
    s_add_u32 s41, s41, 7168
    buffer_load_dwordx4 v5, s[8:11], s41 offen offset:1024 nt lds
    v_fma_f32 v205, v205, s44, -v20
    v_cvt_pk_bf16_f32 v201, v202, v203
    v_exp_f32 v204, v204
    v_exp_f32 v205, v205
    v_fma_f32 v206, v206, s44, -v20
    s_waitcnt lgkmcnt(10)
    v_mfma_f32_32x32x16_bf16 v[144:159], v[44:47], v[192:195], v[144:159]
    ds_read_b64_tr_b16 v[36:37], v17 offset:8448
    ds_read_b64_tr_b16 v[38:39], v17 offset:10496
    v_fma_f32 v207, v207, s44, -v20
    v_exp_f32 v206, v206
    v_exp_f32 v207, v207
    v_cvt_pk_bf16_f32 v202, v204, v205
    v_cvt_pk_bf16_f32 v203, v206, v207
    s_nop 1
    v_mfma_f32_16x16x32_bf16 v[24:27], v[28:31], v[200:203], v[24:27]
    s_waitcnt lgkmcnt(10)
    v_mfma_f32_32x32x16_bf16 v[96:111], v[48:51], v[200:203], v[96:111]
    ds_read_b64_tr_b16 v[40:41], v17 offset:8704
    ds_read_b64_tr_b16 v[42:43], v17 offset:10752
    s_add_u32 s41, s41, 7168
    buffer_load_dwordx4 v5, s[8:11], s41 offen offset:2048 nt lds
    v_fma_f32 v208, v208, s44, -v20
    v_fma_f32 v209, v209, s44, -v20
    v_exp_f32 v208, v208
    v_exp_f32 v209, v209
    v_fma_f32 v210, v210, s44, -v20
    s_waitcnt lgkmcnt(10)
    v_mfma_f32_32x32x16_bf16 v[112:127], v[52:55], v[200:203], v[112:127]
    ds_read_b64_tr_b16 v[44:45], v17 offset:8960
    ds_read_b64_tr_b16 v[46:47], v17 offset:11008
    v_fma_f32 v211, v211, s44, -v20
    v_cvt_pk_bf16_f32 v208, v208, v209
    v_exp_f32 v210, v210
    v_exp_f32 v211, v211
    v_fma_f32 v212, v212, s44, -v20
    s_waitcnt lgkmcnt(10)
    v_mfma_f32_32x32x16_bf16 v[128:143], v[56:59], v[200:203], v[128:143]
    ds_read_b64_tr_b16 v[48:49], v17 offset:12288
    ds_read_b64_tr_b16 v[50:51], v17 offset:14336
    s_add_u32 s41, s41, 7168
    buffer_load_dwordx4 v5, s[8:11], s41 offen offset:3072 nt lds
    v_fma_f32 v213, v213, s44, -v20
    v_cvt_pk_bf16_f32 v209, v210, v211
    v_exp_f32 v212, v212
    v_exp_f32 v213, v213
    v_fma_f32 v214, v214, s44, -v20
    s_waitcnt lgkmcnt(10)
    v_mfma_f32_32x32x16_bf16 v[144:159], v[60:63], v[200:203], v[144:159]
    ds_read_b64_tr_b16 v[52:53], v17 offset:12544
    ds_read_b64_tr_b16 v[54:55], v17 offset:14592
    v_fma_f32 v215, v215, s44, -v20
    v_exp_f32 v214, v214
    v_exp_f32 v215, v215
    v_cvt_pk_bf16_f32 v210, v212, v213
    v_cvt_pk_bf16_f32 v211, v214, v215
    s_nop 1
    v_mfma_f32_16x16x32_bf16 v[24:27], v[28:31], v[208:211], v[24:27]
    s_waitcnt lgkmcnt(10)
    v_mfma_f32_32x32x16_bf16 v[96:111], v[32:35], v[208:211], v[96:111]
    ds_read_b64_tr_b16 v[56:57], v17 offset:12800
    ds_read_b64_tr_b16 v[58:59], v17 offset:14848
    v_fma_f32 v216, v216, s44, -v20
    v_fma_f32 v217, v217, s44, -v20
    v_exp_f32 v216, v216
    v_exp_f32 v217, v217
    v_fma_f32 v218, v218, s44, -v20
    s_waitcnt lgkmcnt(10)
    v_mfma_f32_32x32x16_bf16 v[112:127], v[36:39], v[208:211], v[112:127]
    ds_read_b64_tr_b16 v[60:61], v17 offset:13056
    ds_read_b64_tr_b16 v[62:63], v17 offset:15104
    v_fma_f32 v219, v219, s44, -v20
    v_cvt_pk_bf16_f32 v216, v216, v217
    v_exp_f32 v218, v218
    v_exp_f32 v219, v219
    v_fma_f32 v220, v220, s44, -v20
    s_waitcnt lgkmcnt(10)
    v_mfma_f32_32x32x16_bf16 v[128:143], v[40:43], v[208:211], v[128:143]
    v_fma_f32 v221, v221, s44, -v20
    v_cvt_pk_bf16_f32 v217, v218, v219
    v_exp_f32 v220, v220
    v_exp_f32 v221, v221
    v_fma_f32 v222, v222, s44, -v20
    s_waitcnt lgkmcnt(8)
    v_mfma_f32_32x32x16_bf16 v[144:159], v[44:47], v[208:211], v[144:159]
    v_fma_f32 v223, v223, s44, -v20
    v_exp_f32 v222, v222
    v_exp_f32 v223, v223
    v_cvt_pk_bf16_f32 v218, v220, v221
    v_cvt_pk_bf16_f32 v219, v222, v223
    s_nop 1
    v_mfma_f32_16x16x32_bf16 v[24:27], v[28:31], v[216:219], v[24:27]
    s_waitcnt lgkmcnt(6)
    v_mfma_f32_32x32x16_bf16 v[96:111], v[48:51], v[216:219], v[96:111]
    s_waitcnt lgkmcnt(4)
    v_mfma_f32_32x32x16_bf16 v[112:127], v[52:55], v[216:219], v[112:127]
    s_waitcnt lgkmcnt(2)
    v_mfma_f32_32x32x16_bf16 v[128:143], v[56:59], v[216:219], v[128:143]
    s_waitcnt lgkmcnt(0)
    v_mfma_f32_32x32x16_bf16 v[144:159], v[60:63], v[216:219], v[144:159]
    s_waitcnt vmcnt(12)
    s_barrier
    ds_read_b128 v[32:35], v11 offset:0
    ds_read_b128 v[36:39], v12 offset:0
    ds_read_b128 v[40:43], v11 offset:256
    ds_read_b128 v[44:47], v12 offset:256
    ds_read_b128 v[48:51], v11 offset:512
    ds_read_b128 v[52:55], v12 offset:512
    s_waitcnt lgkmcnt(5)
    v_mfma_f32_32x32x16_bf16 v[160:175], v[32:35], v[64:67], 0
    ds_read_b128 v[56:59], v11 offset:768
    s_add_u32 m0, s69, 131072
    s_xor_b32 s41, s70, 6144
    buffer_load_dwordx4 v5, s[4:7], s41 offen offset:0 nt lds
    s_waitcnt lgkmcnt(5)
    v_mfma_f32_32x32x16_bf16 v[160:175], v[36:39], v[68:71], v[160:175]
    ds_read_b128 v[60:63], v12 offset:768
    s_waitcnt lgkmcnt(5)
    v_mfma_f32_32x32x16_bf16 v[160:175], v[40:43], v[72:75], v[160:175]
    ds_read_b128 v[32:35], v11 offset:8192
    s_add_u32 s41, s41, 7168
    buffer_load_dwordx4 v6, s[4:7], s41 offen offset:1024 nt lds
    s_waitcnt lgkmcnt(5)
    v_mfma_f32_32x32x16_bf16 v[160:175], v[44:47], v[76:79], v[160:175]
    ds_read_b128 v[36:39], v12 offset:8192
    s_waitcnt lgkmcnt(5)
    v_mfma_f32_32x32x16_bf16 v[160:175], v[48:51], v[80:83], v[160:175]
    ds_read_b128 v[40:43], v11 offset:8448
    s_add_u32 s41, s41, 7168
    buffer_load_dwordx4 v7, s[4:7], s41 offen offset:2048 nt lds
    s_waitcnt lgkmcnt(5)
    v_mfma_f32_32x32x16_bf16 v[160:175], v[52:55], v[84:87], v[160:175]
    ds_read_b128 v[44:47], v12 offset:8448
    s_waitcnt lgkmcnt(5)
    v_mfma_f32_32x32x16_bf16 v[160:175], v[56:59], v[88:91], v[160:175]
    ds_read_b128 v[48:51], v11 offset:8704
    s_add_u32 s41, s41, 7168
    buffer_load_dwordx4 v8, s[4:7], s41 offen offset:3072 nt lds
    s_waitcnt lgkmcnt(5)
    v_mfma_f32_32x32x16_bf16 v[160:175], v[60:63], v[92:95], v[160:175]
    ds_read_b128 v[52:55], v12 offset:8704
    s_waitcnt lgkmcnt(5)
    v_mfma_f32_32x32x16_bf16 v[176:191], v[32:35], v[64:67], 0
    ds_read_b128 v[56:59], v11 offset:8960
    s_waitcnt lgkmcnt(5)
    v_mfma_f32_32x32x16_bf16 v[176:191], v[36:39], v[68:71], v[176:191]
    ds_read_b128 v[60:63], v12 offset:8960
    s_waitcnt lgkmcnt(5)
    v_mfma_f32_32x32x16_bf16 v[176:191], v[40:43], v[72:75], v[176:191]
    s_nop 2
    v_max3_f32 v19, v160, v161, v18
    s_waitcnt lgkmcnt(4)
    v_mfma_f32_32x32x16_bf16 v[176:191], v[44:47], v[76:79], v[176:191]
    v_max3_f32 v19, v162, v163, v19
    s_waitcnt lgkmcnt(3)
    v_mfma_f32_32x32x16_bf16 v[176:191], v[48:51], v[80:83], v[176:191]
    v_max3_f32 v19, v164, v165, v19
    v_max3_f32 v19, v166, v167, v19
    s_waitcnt lgkmcnt(2)
    v_mfma_f32_32x32x16_bf16 v[176:191], v[52:55], v[84:87], v[176:191]
    v_max3_f32 v19, v168, v169, v19
    s_waitcnt lgkmcnt(1)
    v_mfma_f32_32x32x16_bf16 v[176:191], v[56:59], v[88:91], v[176:191]
    v_max3_f32 v19, v170, v171, v19
    s_waitcnt lgkmcnt(0)
    v_mfma_f32_32x32x16_bf16 v[176:191], v[60:63], v[92:95], v[176:191]
    v_max3_f32 v19, v172, v173, v19
    v_max3_f32 v19, v174, v175, v19
    s_waitcnt vmcnt(12)
    s_barrier
    ds_read_b128 v[32:35], v13 offset:16384
    ds_read_b128 v[36:39], v14 offset:16384
    ds_read_b128 v[40:43], v13 offset:16640
    ds_read_b128 v[44:47], v14 offset:16640
    ds_read_b128 v[48:51], v13 offset:16896
    ds_read_b128 v[52:55], v14 offset:16896
    s_waitcnt lgkmcnt(5)
    v_mfma_f32_32x32x16_bf16 v[192:207], v[32:35], v[64:67], 0
    ds_read_b128 v[56:59], v13 offset:17152
    s_add_u32 m0, s69, 65536
    s_xor_b32 s41, s70, 7168
    buffer_load_dwordx4 v5, s[4:7], s41 offen offset:0 nt lds
    s_waitcnt lgkmcnt(5)
    v_mfma_f32_32x32x16_bf16 v[192:207], v[36:39], v[68:71], v[192:207]
    ds_read_b128 v[60:63], v14 offset:17152
    v_max3_f32 v19, v176, v177, v19
    s_waitcnt lgkmcnt(5)
    v_mfma_f32_32x32x16_bf16 v[192:207], v[40:43], v[72:75], v[192:207]
    ds_read_b128 v[32:35], v13 offset:24576
    s_add_u32 s41, s41, 7168
    buffer_load_dwordx4 v6, s[4:7], s41 offen offset:1024 nt lds
    v_max3_f32 v19, v178, v179, v19
    s_waitcnt lgkmcnt(5)
    v_mfma_f32_32x32x16_bf16 v[192:207], v[44:47], v[76:79], v[192:207]
    ds_read_b128 v[36:39], v14 offset:24576
    v_max3_f32 v19, v180, v181, v19
    s_waitcnt lgkmcnt(5)
    v_mfma_f32_32x32x16_bf16 v[192:207], v[48:51], v[80:83], v[192:207]
    ds_read_b128 v[40:43], v13 offset:24832
    s_add_u32 s41, s41, 7168
    buffer_load_dwordx4 v7, s[4:7], s41 offen offset:2048 nt lds
    v_max3_f32 v19, v182, v183, v19
    s_waitcnt lgkmcnt(5)
    v_mfma_f32_32x32x16_bf16 v[192:207], v[52:55], v[84:87], v[192:207]
    ds_read_b128 v[44:47], v14 offset:24832
    s_waitcnt lgkmcnt(5)
    v_mfma_f32_32x32x16_bf16 v[192:207], v[56:59], v[88:91], v[192:207]
    ds_read_b128 v[48:51], v13 offset:25088
    s_add_u32 s41, s41, 7168
    buffer_load_dwordx4 v8, s[4:7], s41 offen offset:3072 nt lds
    v_max3_f32 v19, v184, v185, v19
    s_waitcnt lgkmcnt(5)
    v_mfma_f32_32x32x16_bf16 v[192:207], v[60:63], v[92:95], v[192:207]
    ds_read_b128 v[52:55], v14 offset:25088
    v_max3_f32 v19, v186, v187, v19
    s_waitcnt lgkmcnt(5)
    v_mfma_f32_32x32x16_bf16 v[208:223], v[32:35], v[64:67], 0
    ds_read_b128 v[56:59], v13 offset:25344
    v_max3_f32 v19, v188, v189, v19
    s_waitcnt lgkmcnt(5)
    v_mfma_f32_32x32x16_bf16 v[208:223], v[36:39], v[68:71], v[208:223]
    ds_read_b128 v[60:63], v14 offset:25344
    v_max3_f32 v19, v190, v191, v19
    s_waitcnt lgkmcnt(5)
    v_mfma_f32_32x32x16_bf16 v[208:223], v[40:43], v[72:75], v[208:223]
    v_max3_f32 v19, v192, v193, v19
    s_waitcnt lgkmcnt(4)
    v_mfma_f32_32x32x16_bf16 v[208:223], v[44:47], v[76:79], v[208:223]
    v_max3_f32 v19, v194, v195, v19
    s_waitcnt lgkmcnt(3)
    v_mfma_f32_32x32x16_bf16 v[208:223], v[48:51], v[80:83], v[208:223]
    v_max3_f32 v19, v196, v197, v19
    v_max3_f32 v19, v198, v199, v19
    s_waitcnt lgkmcnt(2)
    v_mfma_f32_32x32x16_bf16 v[208:223], v[52:55], v[84:87], v[208:223]
    v_max3_f32 v19, v200, v201, v19
    s_waitcnt lgkmcnt(1)
    v_mfma_f32_32x32x16_bf16 v[208:223], v[56:59], v[88:91], v[208:223]
    v_max3_f32 v19, v202, v203, v19
    s_waitcnt lgkmcnt(0)
    v_mfma_f32_32x32x16_bf16 v[208:223], v[60:63], v[92:95], v[208:223]
    v_max3_f32 v19, v204, v205, v19
    v_max3_f32 v19, v206, v207, v19
    s_nop 7
    s_nop 1
    v_max3_f32 v19, v208, v209, v19
    v_max3_f32 v19, v210, v211, v19
    v_max3_f32 v19, v212, v213, v19
    v_max3_f32 v19, v214, v215, v19
    v_max3_f32 v19, v216, v217, v19
    v_max3_f32 v19, v218, v219, v19
    v_max3_f32 v19, v220, v221, v19
    v_max3_f32 v19, v222, v223, v19
    v_mov_b32 v22, v19
    s_nop 1
    v_permlane32_swap_b32 v19, v22
    v_max_f32 v19, v19, v22
    v_mul_f32 v20, s44, v19
    v_fma_f32 v2, v18, s44, -v20
    v_exp_f32 v2, v2
    v_mov_b32 v18, v19
    v_fma_f32 v160, v160, s44, -v20
    v_fma_f32 v161, v161, s44, -v20
    v_exp_f32 v160, v160
    v_exp_f32 v161, v161
    v_fma_f32 v162, v162, s44, -v20
    v_fma_f32 v163, v163, s44, -v20
    v_cvt_pk_bf16_f32 v160, v160, v161
    v_exp_f32 v162, v162
    v_exp_f32 v163, v163
    v_fma_f32 v164, v164, s44, -v20
    v_fma_f32 v165, v165, s44, -v20
    v_cvt_pk_bf16_f32 v161, v162, v163
    v_exp_f32 v164, v164
    v_exp_f32 v165, v165
    v_fma_f32 v166, v166, s44, -v20
    v_fma_f32 v167, v167, s44, -v20
    v_exp_f32 v166, v166
    v_exp_f32 v167, v167
    v_cvt_pk_bf16_f32 v162, v164, v165
    v_cvt_pk_bf16_f32 v163, v166, v167
    v_mul_f32 v24, v24, v2
    v_mul_f32 v96, v96, v2
    v_mul_f32 v97, v97, v2
    v_mul_f32 v98, v98, v2
    v_mul_f32 v99, v99, v2
    v_mul_f32 v100, v100, v2
    v_mul_f32 v101, v101, v2
    v_mul_f32 v102, v102, v2
    v_mul_f32 v103, v103, v2
    v_mul_f32 v104, v104, v2
    v_mul_f32 v105, v105, v2
    v_mul_f32 v106, v106, v2
    v_mul_f32 v107, v107, v2
    v_mul_f32 v108, v108, v2
    v_mul_f32 v109, v109, v2
    v_mul_f32 v110, v110, v2
    v_mul_f32 v111, v111, v2
    s_waitcnt vmcnt(12)
    s_barrier
    ds_read_b64_tr_b16 v[32:33], v15 offset:49152
    ds_read_b64_tr_b16 v[34:35], v15 offset:51200
    ds_read_b64_tr_b16 v[36:37], v15 offset:49408
    ds_read_b64_tr_b16 v[38:39], v15 offset:51456
    ds_read_b64_tr_b16 v[40:41], v15 offset:49664
    ds_read_b64_tr_b16 v[42:43], v15 offset:51712
    ds_read_b64_tr_b16 v[44:45], v15 offset:49920
    ds_read_b64_tr_b16 v[46:47], v15 offset:51968
    ds_read_b64_tr_b16 v[48:49], v15 offset:53248
    ds_read_b64_tr_b16 v[50:51], v15 offset:55296
    ds_read_b64_tr_b16 v[52:53], v15 offset:53504
    ds_read_b64_tr_b16 v[54:55], v15 offset:55552
    v_mfma_f32_16x16x32_bf16 v[24:27], v[28:31], v[160:163], v[24:27]
    s_waitcnt lgkmcnt(10)
    v_mfma_f32_32x32x16_bf16 v[96:111], v[32:35], v[160:163], v[96:111]
    ds_read_b64_tr_b16 v[56:57], v15 offset:53760
    ds_read_b64_tr_b16 v[58:59], v15 offset:55808
    s_add_u32 m0, s69, 16384
    s_xor_b32 s41, s70, 6144
    buffer_load_dwordx4 v5, s[8:11], s41 offen offset:0 nt lds
    v_fma_f32 v168, v168, s44, -v20
    v_fma_f32 v169, v169, s44, -v20
    v_exp_f32 v168, v168
    v_exp_f32 v169, v169
    v_fma_f32 v170, v170, s44, -v20
    v_mul_f32 v112, v112, v2
    v_mul_f32 v113, v113, v2
    v_mul_f32 v114, v114, v2
    v_mul_f32 v115, v115, v2
    v_mul_f32 v116, v116, v2
    v_mul_f32 v117, v117, v2
    v_mul_f32 v118, v118, v2
    v_mul_f32 v119, v119, v2
    v_mul_f32 v120, v120, v2
    v_mul_f32 v121, v121, v2
    v_mul_f32 v122, v122, v2
    v_mul_f32 v123, v123, v2
    v_mul_f32 v124, v124, v2
    v_mul_f32 v125, v125, v2
    v_mul_f32 v126, v126, v2
    v_mul_f32 v127, v127, v2
    s_waitcnt lgkmcnt(10)
    s_nop 0
    v_mfma_f32_32x32x16_bf16 v[112:127], v[36:39], v[160:163], v[112:127]
    ds_read_b64_tr_b16 v[60:61], v15 offset:54016
    ds_read_b64_tr_b16 v[62:63], v15 offset:56064
    v_fma_f32 v171, v171, s44, -v20
    v_cvt_pk_bf16_f32 v168, v168, v169
    v_exp_f32 v170, v170
    v_exp_f32 v171, v171
    v_fma_f32 v172, v172, s44, -v20
    v_mul_f32 v128, v128, v2
    v_mul_f32 v129, v129, v2
    v_mul_f32 v130, v130, v2
    v_mul_f32 v131, v131, v2
    v_mul_f32 v132, v132, v2
    v_mul_f32 v133, v133, v2
    v_mul_f32 v134, v134, v2
    v_mul_f32 v135, v135, v2
    v_mul_f32 v136, v136, v2
    v_mul_f32 v137, v137, v2
    v_mul_f32 v138, v138, v2
    v_mul_f32 v139, v139, v2
    v_mul_f32 v140, v140, v2
    v_mul_f32 v141, v141, v2
    v_mul_f32 v142, v142, v2
    v_mul_f32 v143, v143, v2
    s_waitcnt lgkmcnt(10)
    s_nop 0
    v_mfma_f32_32x32x16_bf16 v[128:143], v[40:43], v[160:163], v[128:143]
    ds_read_b64_tr_b16 v[32:33], v15 offset:57344
    ds_read_b64_tr_b16 v[34:35], v15 offset:59392
    s_add_u32 s41, s41, 7168
    buffer_load_dwordx4 v5, s[8:11], s41 offen offset:1024 nt lds
    v_fma_f32 v173, v173, s44, -v20
    v_cvt_pk_bf16_f32 v169, v170, v171
    v_exp_f32 v172, v172
    v_exp_f32 v173, v173
    v_fma_f32 v174, v174, s44, -v20
    v_mul_f32 v144, v144, v2
    v_mul_f32 v145, v145, v2
    v_mul_f32 v146, v146, v2
    v_mul_f32 v147, v147, v2
    v_mul_f32 v148, v148, v2
    v_mul_f32 v149, v149, v2
    v_mul_f32 v150, v150, v2
    v_mul_f32 v151, v151, v2
    v_mul_f32 v152, v152, v2
    v_mul_f32 v153, v153, v2
    v_mul_f32 v154, v154, v2
    v_mul_f32 v155, v155, v2
    v_mul_f32 v156, v156, v2
    v_mul_f32 v157, v157, v2
    v_mul_f32 v158, v158, v2
    v_mul_f32 v159, v159, v2
    s_waitcnt lgkmcnt(10)
    s_nop 0
    v_mfma_f32_32x32x16_bf16 v[144:159], v[44:47], v[160:163], v[144:159]
    ds_read_b64_tr_b16 v[36:37], v15 offset:57600
    ds_read_b64_tr_b16 v[38:39], v15 offset:59648
    v_fma_f32 v175, v175, s44, -v20
    v_exp_f32 v174, v174
    v_exp_f32 v175, v175
    v_cvt_pk_bf16_f32 v170, v172, v173
    v_cvt_pk_bf16_f32 v171, v174, v175
    s_nop 1
    v_mfma_f32_16x16x32_bf16 v[24:27], v[28:31], v[168:171], v[24:27]
    s_waitcnt lgkmcnt(10)
    v_mfma_f32_32x32x16_bf16 v[96:111], v[48:51], v[168:171], v[96:111]
    ds_read_b64_tr_b16 v[40:41], v15 offset:57856
    ds_read_b64_tr_b16 v[42:43], v15 offset:59904
    s_add_u32 s41, s41, 7168
    buffer_load_dwordx4 v5, s[8:11], s41 offen offset:2048 nt lds
    v_fma_f32 v176, v176, s44, -v20
    v_fma_f32 v177, v177, s44, -v20
    v_exp_f32 v176, v176
    v_exp_f32 v177, v177
    v_fma_f32 v178, v178, s44, -v20
    s_waitcnt lgkmcnt(10)
    v_mfma_f32_32x32x16_bf16 v[112:127], v[52:55], v[168:171], v[112:127]
    ds_read_b64_tr_b16 v[44:45], v15 offset:58112
    ds_read_b64_tr_b16 v[46:47], v15 offset:60160
    v_fma_f32 v179, v179, s44, -v20
    v_cvt_pk_bf16_f32 v176, v176, v177
    v_exp_f32 v178, v178
    v_exp_f32 v179, v179
    v_fma_f32 v180, v180, s44, -v20
    s_waitcnt lgkmcnt(10)
    v_mfma_f32_32x32x16_bf16 v[128:143], v[56:59], v[168:171], v[128:143]
    ds_read_b64_tr_b16 v[48:49], v15 offset:61440
    ds_read_b64_tr_b16 v[50:51], v15 offset:63488
    s_add_u32 s41, s41, 7168
    buffer_load_dwordx4 v5, s[8:11], s41 offen offset:3072 nt lds
    v_fma_f32 v181, v181, s44, -v20
    v_cvt_pk_bf16_f32 v177, v178, v179
    v_exp_f32 v180, v180
    v_exp_f32 v181, v181
    v_fma_f32 v182, v182, s44, -v20
    s_waitcnt lgkmcnt(10)
    v_mfma_f32_32x32x16_bf16 v[144:159], v[60:63], v[168:171], v[144:159]
    ds_read_b64_tr_b16 v[52:53], v15 offset:61696
    ds_read_b64_tr_b16 v[54:55], v15 offset:63744
    v_fma_f32 v183, v183, s44, -v20
    v_exp_f32 v182, v182
    v_exp_f32 v183, v183
    v_cvt_pk_bf16_f32 v178, v180, v181
    v_cvt_pk_bf16_f32 v179, v182, v183
    s_nop 1
    v_mfma_f32_16x16x32_bf16 v[24:27], v[28:31], v[176:179], v[24:27]
    s_waitcnt lgkmcnt(10)
    v_mfma_f32_32x32x16_bf16 v[96:111], v[32:35], v[176:179], v[96:111]
    ds_read_b64_tr_b16 v[56:57], v15 offset:61952
    ds_read_b64_tr_b16 v[58:59], v15 offset:64000
    v_fma_f32 v184, v184, s44, -v20
    v_fma_f32 v185, v185, s44, -v20
    v_exp_f32 v184, v184
    v_exp_f32 v185, v185
    v_fma_f32 v186, v186, s44, -v20
    s_waitcnt lgkmcnt(10)
    v_mfma_f32_32x32x16_bf16 v[112:127], v[36:39], v[176:179], v[112:127]
    ds_read_b64_tr_b16 v[60:61], v15 offset:62208
    ds_read_b64_tr_b16 v[62:63], v15 offset:64256
    v_fma_f32 v187, v187, s44, -v20
    v_cvt_pk_bf16_f32 v184, v184, v185
    v_exp_f32 v186, v186
    v_exp_f32 v187, v187
    v_fma_f32 v188, v188, s44, -v20
    s_waitcnt lgkmcnt(10)
    v_mfma_f32_32x32x16_bf16 v[128:143], v[40:43], v[176:179], v[128:143]
    v_fma_f32 v189, v189, s44, -v20
    v_cvt_pk_bf16_f32 v185, v186, v187
    v_exp_f32 v188, v188
    v_exp_f32 v189, v189
    v_fma_f32 v190, v190, s44, -v20
    s_waitcnt lgkmcnt(8)
    v_mfma_f32_32x32x16_bf16 v[144:159], v[44:47], v[176:179], v[144:159]
    v_fma_f32 v191, v191, s44, -v20
    v_exp_f32 v190, v190
    v_exp_f32 v191, v191
    v_cvt_pk_bf16_f32 v186, v188, v189
    v_cvt_pk_bf16_f32 v187, v190, v191
    s_nop 1
    v_mfma_f32_16x16x32_bf16 v[24:27], v[28:31], v[184:187], v[24:27]
    s_waitcnt lgkmcnt(6)
    v_mfma_f32_32x32x16_bf16 v[96:111], v[48:51], v[184:187], v[96:111]
    v_fma_f32 v192, v192, s44, -v20
    v_fma_f32 v193, v193, s44, -v20
    v_exp_f32 v192, v192
    v_exp_f32 v193, v193
    v_fma_f32 v194, v194, s44, -v20
    s_waitcnt lgkmcnt(4)
    v_mfma_f32_32x32x16_bf16 v[112:127], v[52:55], v[184:187], v[112:127]
    v_fma_f32 v195, v195, s44, -v20
    v_cvt_pk_bf16_f32 v192, v192, v193
    v_exp_f32 v194, v194
    v_exp_f32 v195, v195
    v_fma_f32 v196, v196, s44, -v20
    s_waitcnt lgkmcnt(2)
    v_mfma_f32_32x32x16_bf16 v[128:143], v[56:59], v[184:187], v[128:143]
    v_fma_f32 v197, v197, s44, -v20
    v_cvt_pk_bf16_f32 v193, v194, v195
    v_exp_f32 v196, v196
    v_exp_f32 v197, v197
    v_fma_f32 v198, v198, s44, -v20
    s_waitcnt lgkmcnt(0)
    v_mfma_f32_32x32x16_bf16 v[144:159], v[60:63], v[184:187], v[144:159]
    v_fma_f32 v199, v199, s44, -v20
    v_exp_f32 v198, v198
    v_exp_f32 v199, v199
    v_cvt_pk_bf16_f32 v194, v196, v197
    v_cvt_pk_bf16_f32 v195, v198, v199
    s_waitcnt vmcnt(12)
    s_barrier
    ds_read_b64_tr_b16 v[32:33], v16 offset:16384
    ds_read_b64_tr_b16 v[34:35], v16 offset:18432
    ds_read_b64_tr_b16 v[36:37], v16 offset:16640
    ds_read_b64_tr_b16 v[38:39], v16 offset:18688
    ds_read_b64_tr_b16 v[40:41], v16 offset:16896
    ds_read_b64_tr_b16 v[42:43], v16 offset:18944
    ds_read_b64_tr_b16 v[44:45], v16 offset:17152
    ds_read_b64_tr_b16 v[46:47], v16 offset:19200
    ds_read_b64_tr_b16 v[48:49], v16 offset:20480
    ds_read_b64_tr_b16 v[50:51], v16 offset:22528
    ds_read_b64_tr_b16 v[52:53], v16 offset:20736
    ds_read_b64_tr_b16 v[54:55], v16 offset:22784
    v_mfma_f32_16x16x32_bf16 v[24:27], v[28:31], v[192:195], v[24:27]
    s_waitcnt lgkmcnt(10)
    v_mfma_f32_32x32x16_bf16 v[96:111], v[32:35], v[192:195], v[96:111]
    ds_read_b64_tr_b16 v[56:57], v16 offset:20992
    ds_read_b64_tr_b16 v[58:59], v16 offset:23040
    s_add_u32 m0, s69, 49152
    s_xor_b32 s41, s70, 7168
    buffer_load_dwordx4 v5, s[8:11], s41 offen offset:0 nt lds
    v_fma_f32 v200, v200, s44, -v20
    v_fma_f32 v201, v201, s44, -v20
    v_exp_f32 v200, v200
    v_exp_f32 v201, v201
    v_fma_f32 v202, v202, s44, -v20
    s_waitcnt lgkmcnt(10)
    v_mfma_f32_32x32x16_bf16 v[112:127], v[36:39], v[192:195], v[112:127]
    ds_read_b64_tr_b16 v[60:61], v16 offset:21248
    ds_read_b64_tr_b16 v[62:63], v16 offset:23296
    v_fma_f32 v203, v203, s44, -v20
    v_cvt_pk_bf16_f32 v200, v200, v201
    v_exp_f32 v202, v202
    v_exp_f32 v203, v203
    v_fma_f32 v204, v204, s44, -v20
    s_waitcnt lgkmcnt(10)
    v_mfma_f32_32x32x16_bf16 v[128:143], v[40:43], v[192:195], v[128:143]
    ds_read_b64_tr_b16 v[32:33], v16 offset:24576
    ds_read_b64_tr_b16 v[34:35], v16 offset:26624
    s_add_u32 s41, s41, 7168
    buffer_load_dwordx4 v5, s[8:11], s41 offen offset:1024 nt lds
    v_fma_f32 v205, v205, s44, -v20
    v_cvt_pk_bf16_f32 v201, v202, v203
    v_exp_f32 v204, v204
    v_exp_f32 v205, v205
    v_fma_f32 v206, v206, s44, -v20
    s_waitcnt lgkmcnt(10)
    v_mfma_f32_32x32x16_bf16 v[144:159], v[44:47], v[192:195], v[144:159]
    ds_read_b64_tr_b16 v[36:37], v16 offset:24832
    ds_read_b64_tr_b16 v[38:39], v16 offset:26880
    v_fma_f32 v207, v207, s44, -v20
    v_exp_f32 v206, v206
    v_exp_f32 v207, v207
    v_cvt_pk_bf16_f32 v202, v204, v205
    v_cvt_pk_bf16_f32 v203, v206, v207
    s_nop 1
    v_mfma_f32_16x16x32_bf16 v[24:27], v[28:31], v[200:203], v[24:27]
    s_waitcnt lgkmcnt(10)
    v_mfma_f32_32x32x16_bf16 v[96:111], v[48:51], v[200:203], v[96:111]
    ds_read_b64_tr_b16 v[40:41], v16 offset:25088
    ds_read_b64_tr_b16 v[42:43], v16 offset:27136
    s_add_u32 s41, s41, 7168
    buffer_load_dwordx4 v5, s[8:11], s41 offen offset:2048 nt lds
    v_fma_f32 v208, v208, s44, -v20
    v_fma_f32 v209, v209, s44, -v20
    v_exp_f32 v208, v208
    v_exp_f32 v209, v209
    v_fma_f32 v210, v210, s44, -v20
    s_waitcnt lgkmcnt(10)
    v_mfma_f32_32x32x16_bf16 v[112:127], v[52:55], v[200:203], v[112:127]
    ds_read_b64_tr_b16 v[44:45], v16 offset:25344
    ds_read_b64_tr_b16 v[46:47], v16 offset:27392
    v_fma_f32 v211, v211, s44, -v20
    v_cvt_pk_bf16_f32 v208, v208, v209
    v_exp_f32 v210, v210
    v_exp_f32 v211, v211
    v_fma_f32 v212, v212, s44, -v20
    s_waitcnt lgkmcnt(10)
    v_mfma_f32_32x32x16_bf16 v[128:143], v[56:59], v[200:203], v[128:143]
    ds_read_b64_tr_b16 v[48:49], v16 offset:28672
    ds_read_b64_tr_b16 v[50:51], v16 offset:30720
    s_add_u32 s41, s41, 7168
    buffer_load_dwordx4 v5, s[8:11], s41 offen offset:3072 nt lds
    v_fma_f32 v213, v213, s44, -v20
    v_cvt_pk_bf16_f32 v209, v210, v211
    v_exp_f32 v212, v212
    v_exp_f32 v213, v213
    v_fma_f32 v214, v214, s44, -v20
    s_waitcnt lgkmcnt(10)
    v_mfma_f32_32x32x16_bf16 v[144:159], v[60:63], v[200:203], v[144:159]
    ds_read_b64_tr_b16 v[52:53], v16 offset:28928
    ds_read_b64_tr_b16 v[54:55], v16 offset:30976
    v_fma_f32 v215, v215, s44, -v20
    v_exp_f32 v214, v214
    v_exp_f32 v215, v215
    v_cvt_pk_bf16_f32 v210, v212, v213
    v_cvt_pk_bf16_f32 v211, v214, v215
    s_nop 1
    v_mfma_f32_16x16x32_bf16 v[24:27], v[28:31], v[208:211], v[24:27]
    s_waitcnt lgkmcnt(10)
    v_mfma_f32_32x32x16_bf16 v[96:111], v[32:35], v[208:211], v[96:111]
    ds_read_b64_tr_b16 v[56:57], v16 offset:29184
    ds_read_b64_tr_b16 v[58:59], v16 offset:31232
    v_fma_f32 v216, v216, s44, -v20
    v_fma_f32 v217, v217, s44, -v20
    v_exp_f32 v216, v216
    v_exp_f32 v217, v217
    v_fma_f32 v218, v218, s44, -v20
    s_waitcnt lgkmcnt(10)
    v_mfma_f32_32x32x16_bf16 v[112:127], v[36:39], v[208:211], v[112:127]
    ds_read_b64_tr_b16 v[60:61], v16 offset:29440
    ds_read_b64_tr_b16 v[62:63], v16 offset:31488
    v_fma_f32 v219, v219, s44, -v20
    v_cvt_pk_bf16_f32 v216, v216, v217
    v_exp_f32 v218, v218
    v_exp_f32 v219, v219
    v_fma_f32 v220, v220, s44, -v20
    s_waitcnt lgkmcnt(10)
    v_mfma_f32_32x32x16_bf16 v[128:143], v[40:43], v[208:211], v[128:143]
    v_fma_f32 v221, v221, s44, -v20
    v_cvt_pk_bf16_f32 v217, v218, v219
    v_exp_f32 v220, v220
    v_exp_f32 v221, v221
    v_fma_f32 v222, v222, s44, -v20
    s_waitcnt lgkmcnt(8)
    v_mfma_f32_32x32x16_bf16 v[144:159], v[44:47], v[208:211], v[144:159]
    v_fma_f32 v223, v223, s44, -v20
    v_exp_f32 v222, v222
    v_exp_f32 v223, v223
    v_cvt_pk_bf16_f32 v218, v220, v221
    v_cvt_pk_bf16_f32 v219, v222, v223
    s_nop 1
    v_mfma_f32_16x16x32_bf16 v[24:27], v[28:31], v[216:219], v[24:27]
    s_waitcnt lgkmcnt(6)
    v_mfma_f32_32x32x16_bf16 v[96:111], v[48:51], v[216:219], v[96:111]
    s_waitcnt lgkmcnt(4)
    v_mfma_f32_32x32x16_bf16 v[112:127], v[52:55], v[216:219], v[112:127]
    s_waitcnt lgkmcnt(2)
    v_mfma_f32_32x32x16_bf16 v[128:143], v[56:59], v[216:219], v[128:143]
    s_waitcnt lgkmcnt(0)
    v_mfma_f32_32x32x16_bf16 v[144:159], v[60:63], v[216:219], v[144:159]
    s_waitcnt vmcnt(12)
    s_barrier
    ds_read_b128 v[32:35], v13 offset:0
    ds_read_b128 v[36:39], v14 offset:0
    ds_read_b128 v[40:43], v13 offset:256
    ds_read_b128 v[44:47], v14 offset:256
    ds_read_b128 v[48:51], v13 offset:512
    ds_read_b128 v[52:55], v14 offset:512
    s_waitcnt lgkmcnt(5)
    v_mfma_f32_32x32x16_bf16 v[160:175], v[32:35], v[64:67], 0
    ds_read_b128 v[56:59], v13 offset:768
    s_add_u32 m0, s69, 32768
    s_xor_b32 s41, s71, 0
    buffer_load_dwordx4 v5, s[4:7], s41 offen offset:0 nt lds
    s_waitcnt lgkmcnt(5)
    v_mfma_f32_32x32x16_bf16 v[160:175], v[36:39], v[68:71], v[160:175]
    ds_read_b128 v[60:63], v14 offset:768
    s_waitcnt lgkmcnt(5)
    v_mfma_f32_32x32x16_bf16 v[160:175], v[40:43], v[72:75], v[160:175]
    ds_read_b128 v[32:35], v13 offset:8192
    s_add_u32 s41, s41, 7168
    buffer_load_dwordx4 v6, s[4:7], s41 offen offset:1024 nt lds
    s_waitcnt lgkmcnt(5)
    v_mfma_f32_32x32x16_bf16 v[160:175], v[44:47], v[76:79], v[160:175]
    ds_read_b128 v[36:39], v14 offset:8192
    s_waitcnt lgkmcnt(5)
    v_mfma_f32_32x32x16_bf16 v[160:175], v[48:51], v[80:83], v[160:175]
    ds_read_b128 v[40:43], v13 offset:8448
    s_add_u32 s41, s41, 7168
    buffer_load_dwordx4 v7, s[4:7], s41 offen offset:2048 nt lds
    s_waitcnt lgkmcnt(5)
    v_mfma_f32_32x32x16_bf16 v[160:175], v[52:55], v[84:87], v[160:175]
    ds_read_b128 v[44:47], v14 offset:8448
    s_waitcnt lgkmcnt(5)
    v_mfma_f32_32x32x16_bf16 v[160:175], v[56:59], v[88:91], v[160:175]
    ds_read_b128 v[48:51], v13 offset:8704
    s_add_u32 s41, s41, 7168
    buffer_load_dwordx4 v8, s[4:7], s41 offen offset:3072 nt lds
    s_waitcnt lgkmcnt(5)
    v_mfma_f32_32x32x16_bf16 v[160:175], v[60:63], v[92:95], v[160:175]
    ds_read_b128 v[52:55], v14 offset:8704
    s_waitcnt lgkmcnt(5)
    v_mfma_f32_32x32x16_bf16 v[176:191], v[32:35], v[64:67], 0
    ds_read_b128 v[56:59], v13 offset:8960
    s_waitcnt lgkmcnt(5)
    v_mfma_f32_32x32x16_bf16 v[176:191], v[36:39], v[68:71], v[176:191]
    ds_read_b128 v[60:63], v14 offset:8960
    s_waitcnt lgkmcnt(5)
    v_mfma_f32_32x32x16_bf16 v[176:191], v[40:43], v[72:75], v[176:191]
    s_nop 2
    v_max3_f32 v19, v160, v161, v18
    s_waitcnt lgkmcnt(4)
    v_mfma_f32_32x32x16_bf16 v[176:191], v[44:47], v[76:79], v[176:191]
    v_max3_f32 v19, v162, v163, v19
    s_waitcnt lgkmcnt(3)
    v_mfma_f32_32x32x16_bf16 v[176:191], v[48:51], v[80:83], v[176:191]
    v_max3_f32 v19, v164, v165, v19
    v_max3_f32 v19, v166, v167, v19
    s_waitcnt lgkmcnt(2)
    v_mfma_f32_32x32x16_bf16 v[176:191], v[52:55], v[84:87], v[176:191]
    v_max3_f32 v19, v168, v169, v19
    s_waitcnt lgkmcnt(1)
    v_mfma_f32_32x32x16_bf16 v[176:191], v[56:59], v[88:91], v[176:191]
    v_max3_f32 v19, v170, v171, v19
    s_waitcnt lgkmcnt(0)
    v_mfma_f32_32x32x16_bf16 v[176:191], v[60:63], v[92:95], v[176:191]
    v_max3_f32 v19, v172, v173, v19
    v_max3_f32 v19, v174, v175, v19
    s_waitcnt vmcnt(12)
    s_barrier
    ds_read_b128 v[32:35], v11 offset:0
    ds_read_b128 v[36:39], v12 offset:0
    ds_read_b128 v[40:43], v11 offset:256
    ds_read_b128 v[44:47], v12 offset:256
    ds_read_b128 v[48:51], v11 offset:512
    ds_read_b128 v[52:55], v12 offset:512
    s_waitcnt lgkmcnt(5)
    v_mfma_f32_32x32x16_bf16 v[192:207], v[32:35], v[64:67], 0
    ds_read_b128 v[56:59], v11 offset:768
    s_add_u32 m0, s69, 81920
    s_xor_b32 s41, s71, 1024
    buffer_load_dwordx4 v5, s[4:7], s41 offen offset:0 nt lds
    s_waitcnt lgkmcnt(5)
    v_mfma_f32_32x32x16_bf16 v[192:207], v[36:39], v[68:71], v[192:207]
    ds_read_b128 v[60:63], v12 offset:768
    v_max3_f32 v19, v176, v177, v19
    s_waitcnt lgkmcnt(5)
    v_mfma_f32_32x32x16_bf16 v[192:207], v[40:43], v[72:75], v[192:207]
    ds_read_b128 v[32:35], v11 offset:8192
    s_add_u32 s41, s41, 7168
    buffer_load_dwordx4 v6, s[4:7], s41 offen offset:1024 nt lds
    v_max3_f32 v19, v178, v179, v19
    s_waitcnt lgkmcnt(5)
    v_mfma_f32_32x32x16_bf16 v[192:207], v[44:47], v[76:79], v[192:207]
    ds_read_b128 v[36:39], v12 offset:8192
    v_max3_f32 v19, v180, v181, v19
    s_waitcnt lgkmcnt(5)
    v_mfma_f32_32x32x16_bf16 v[192:207], v[48:51], v[80:83], v[192:207]
    ds_read_b128 v[40:43], v11 offset:8448
    s_add_u32 s41, s41, 7168
    buffer_load_dwordx4 v7, s[4:7], s41 offen offset:2048 nt lds
    v_max3_f32 v19, v182, v183, v19
    s_waitcnt lgkmcnt(5)
    v_mfma_f32_32x32x16_bf16 v[192:207], v[52:55], v[84:87], v[192:207]
    ds_read_b128 v[44:47], v12 offset:8448
    s_waitcnt lgkmcnt(5)
    v_mfma_f32_32x32x16_bf16 v[192:207], v[56:59], v[88:91], v[192:207]
    ds_read_b128 v[48:51], v11 offset:8704
    s_add_u32 s41, s41, 7168
    buffer_load_dwordx4 v8, s[4:7], s41 offen offset:3072 nt lds
    v_max3_f32 v19, v184, v185, v19
    s_waitcnt lgkmcnt(5)
    v_mfma_f32_32x32x16_bf16 v[192:207], v[60:63], v[92:95], v[192:207]
    ds_read_b128 v[52:55], v12 offset:8704
    v_max3_f32 v19, v186, v187, v19
    s_waitcnt lgkmcnt(5)
    v_mfma_f32_32x32x16_bf16 v[208:223], v[32:35], v[64:67], 0
    ds_read_b128 v[56:59], v11 offset:8960
    v_max3_f32 v19, v188, v189, v19
    s_waitcnt lgkmcnt(5)
    v_mfma_f32_32x32x16_bf16 v[208:223], v[36:39], v[68:71], v[208:223]
    ds_read_b128 v[60:63], v12 offset:8960
    v_max3_f32 v19, v190, v191, v19
    s_waitcnt lgkmcnt(5)
    v_mfma_f32_32x32x16_bf16 v[208:223], v[40:43], v[72:75], v[208:223]
    v_max3_f32 v19, v192, v193, v19
    s_waitcnt lgkmcnt(4)
    v_mfma_f32_32x32x16_bf16 v[208:223], v[44:47], v[76:79], v[208:223]
    v_max3_f32 v19, v194, v195, v19
    s_waitcnt lgkmcnt(3)
    v_mfma_f32_32x32x16_bf16 v[208:223], v[48:51], v[80:83], v[208:223]
    v_max3_f32 v19, v196, v197, v19
    v_max3_f32 v19, v198, v199, v19
    s_waitcnt lgkmcnt(2)
    v_mfma_f32_32x32x16_bf16 v[208:223], v[52:55], v[84:87], v[208:223]
    v_max3_f32 v19, v200, v201, v19
    s_waitcnt lgkmcnt(1)
    v_mfma_f32_32x32x16_bf16 v[208:223], v[56:59], v[88:91], v[208:223]
    v_max3_f32 v19, v202, v203, v19
    s_waitcnt lgkmcnt(0)
    v_mfma_f32_32x32x16_bf16 v[208:223], v[60:63], v[92:95], v[208:223]
    v_max3_f32 v19, v204, v205, v19
    v_max3_f32 v19, v206, v207, v19
    s_nop 7
    s_nop 1
    v_max3_f32 v19, v208, v209, v19
    v_max3_f32 v19, v210, v211, v19
    v_max3_f32 v19, v212, v213, v19
    v_max3_f32 v19, v214, v215, v19
    v_max3_f32 v19, v216, v217, v19
    v_max3_f32 v19, v218, v219, v19
    v_max3_f32 v19, v220, v221, v19
    v_max3_f32 v19, v222, v223, v19
    v_mov_b32 v22, v19
    s_nop 1
    v_permlane32_swap_b32 v19, v22
    v_max_f32 v19, v19, v22
    v_mul_f32 v20, s44, v19
    v_fma_f32 v2, v18, s44, -v20
    v_exp_f32 v2, v2
    v_mov_b32 v18, v19
    v_fma_f32 v160, v160, s44, -v20
    v_fma_f32 v161, v161, s44, -v20
    v_exp_f32 v160, v160
    v_exp_f32 v161, v161
    v_fma_f32 v162, v162, s44, -v20
    v_fma_f32 v163, v163, s44, -v20
    v_cvt_pk_bf16_f32 v160, v160, v161
    v_exp_f32 v162, v162
    v_exp_f32 v163, v163
    v_fma_f32 v164, v164, s44, -v20
    v_fma_f32 v165, v165, s44, -v20
    v_cvt_pk_bf16_f32 v161, v162, v163
    v_exp_f32 v164, v164
    v_exp_f32 v165, v165
    v_fma_f32 v166, v166, s44, -v20
    v_fma_f32 v167, v167, s44, -v20
    v_exp_f32 v166, v166
    v_exp_f32 v167, v167
    v_cvt_pk_bf16_f32 v162, v164, v165
    v_cvt_pk_bf16_f32 v163, v166, v167
    v_mul_f32 v24, v24, v2
    v_mul_f32 v96, v96, v2
    v_mul_f32 v97, v97, v2
    v_mul_f32 v98, v98, v2
    v_mul_f32 v99, v99, v2
    v_mul_f32 v100, v100, v2
    v_mul_f32 v101, v101, v2
    v_mul_f32 v102, v102, v2
    v_mul_f32 v103, v103, v2
    v_mul_f32 v104, v104, v2
    v_mul_f32 v105, v105, v2
    v_mul_f32 v106, v106, v2
    v_mul_f32 v107, v107, v2
    v_mul_f32 v108, v108, v2
    v_mul_f32 v109, v109, v2
    v_mul_f32 v110, v110, v2
    v_mul_f32 v111, v111, v2
    s_waitcnt vmcnt(12)
    s_barrier
    ds_read_b64_tr_b16 v[32:33], v15 offset:16384
    ds_read_b64_tr_b16 v[34:35], v15 offset:18432
    ds_read_b64_tr_b16 v[36:37], v15 offset:16640
    ds_read_b64_tr_b16 v[38:39], v15 offset:18688
    ds_read_b64_tr_b16 v[40:41], v15 offset:16896
    ds_read_b64_tr_b16 v[42:43], v15 offset:18944
    ds_read_b64_tr_b16 v[44:45], v15 offset:17152
    ds_read_b64_tr_b16 v[46:47], v15 offset:19200
    ds_read_b64_tr_b16 v[48:49], v15 offset:20480
    ds_read_b64_tr_b16 v[50:51], v15 offset:22528
    ds_read_b64_tr_b16 v[52:53], v15 offset:20736
    ds_read_b64_tr_b16 v[54:55], v15 offset:22784
    v_mfma_f32_16x16x32_bf16 v[24:27], v[28:31], v[160:163], v[24:27]
    s_waitcnt lgkmcnt(10)
    v_mfma_f32_32x32x16_bf16 v[96:111], v[32:35], v[160:163], v[96:111]
    ds_read_b64_tr_b16 v[56:57], v15 offset:20992
    ds_read_b64_tr_b16 v[58:59], v15 offset:23040
    s_add_u32 m0, s69, 131072
    s_xor_b32 s41, s71, 0
    buffer_load_dwordx4 v5, s[8:11], s41 offen offset:0 nt lds
    v_fma_f32 v168, v168, s44, -v20
    v_fma_f32 v169, v169, s44, -v20
    v_exp_f32 v168, v168
    v_exp_f32 v169, v169
    v_fma_f32 v170, v170, s44, -v20
    v_fma_f32 v171, v171, s44, -v20
    v_cvt_pk_bf16_f32 v168, v168, v169
    v_exp_f32 v170, v170
    v_exp_f32 v171, v171
    v_fma_f32 v172, v172, s44, -v20
    v_mul_f32 v112, v112, v2
    v_mul_f32 v113, v113, v2
    v_mul_f32 v114, v114, v2
    v_mul_f32 v115, v115, v2
    v_mul_f32 v116, v116, v2
    v_mul_f32 v117, v117, v2
    v_mul_f32 v118, v118, v2
    v_mul_f32 v119, v119, v2
    v_mul_f32 v120, v120, v2
    v_mul_f32 v121, v121, v2
    v_mul_f32 v122, v122, v2
    v_mul_f32 v123, v123, v2
    v_mul_f32 v124, v124, v2
    v_mul_f32 v125, v125, v2
    v_mul_f32 v126, v126, v2
    v_mul_f32 v127, v127, v2
    s_waitcnt lgkmcnt(10)
    s_nop 0
    v_mfma_f32_32x32x16_bf16 v[112:127], v[36:39], v[160:163], v[112:127]
    ds_read_b64_tr_b16 v[60:61], v15 offset:21248
    ds_read_b64_tr_b16 v[62:63], v15 offset:23296
    v_fma_f32 v173, v173, s44, -v20
    v_cvt_pk_bf16_f32 v169, v170, v171
    v_exp_f32 v172, v172
    v_exp_f32 v173, v173
    v_fma_f32 v174, v174, s44, -v20
    v_fma_f32 v175, v175, s44, -v20
    v_exp_f32 v174, v174
    v_exp_f32 v175, v175
    v_cvt_pk_bf16_f32 v170, v172, v173
    v_cvt_pk_bf16_f32 v171, v174, v175
    v_mul_f32 v128, v128, v2
    v_mul_f32 v129, v129, v2
    v_mul_f32 v130, v130, v2
    v_mul_f32 v131, v131, v2
    v_mul_f32 v132, v132, v2
    v_mul_f32 v133, v133, v2
    v_mul_f32 v134, v134, v2
    v_mul_f32 v135, v135, v2
    v_mul_f32 v136, v136, v2
    v_mul_f32 v137, v137, v2
    v_mul_f32 v138, v138, v2
    v_mul_f32 v139, v139, v2
    v_mul_f32 v140, v140, v2
    v_mul_f32 v141, v141, v2
    v_mul_f32 v142, v142, v2
    v_mul_f32 v143, v143, v2
    s_waitcnt lgkmcnt(10)
    s_nop 0
    v_mfma_f32_32x32x16_bf16 v[128:143], v[40:43], v[160:163], v[128:143]
    ds_read_b64_tr_b16 v[32:33], v15 offset:24576
    ds_read_b64_tr_b16 v[34:35], v15 offset:26624
    s_add_u32 s41, s41, 7168
    buffer_load_dwordx4 v5, s[8:11], s41 offen offset:1024 nt lds
    v_fma_f32 v176, v176, s44, -v20
    v_fma_f32 v177, v177, s44, -v20
    v_exp_f32 v176, v176
    v_exp_f32 v177, v177
    v_fma_f32 v178, v178, s44, -v20
    v_fma_f32 v179, v179, s44, -v20
    v_cvt_pk_bf16_f32 v176, v176, v177
    v_exp_f32 v178, v178
    v_exp_f32 v179, v179
    v_fma_f32 v180, v180, s44, -v20
    v_mul_f32 v144, v144, v2
    v_mul_f32 v145, v145, v2
    v_mul_f32 v146, v146, v2
    v_mul_f32 v147, v147, v2
    v_mul_f32 v148, v148, v2
    v_mul_f32 v149, v149, v2
    v_mul_f32 v150, v150, v2
    v_mul_f32 v151, v151, v2
    v_mul_f32 v152, v152, v2
    v_mul_f32 v153, v153, v2
    v_mul_f32 v154, v154, v2
    v_mul_f32 v155, v155, v2
    v_mul_f32 v156, v156, v2
    v_mul_f32 v157, v157, v2
    v_mul_f32 v158, v158, v2
    v_mul_f32 v159, v159, v2
    s_waitcnt lgkmcnt(10)
    s_nop 0
    v_mfma_f32_32x32x16_bf16 v[144:159], v[44:47], v[160:163], v[144:159]
    ds_read_b64_tr_b16 v[36:37], v15 offset:24832
    ds_read_b64_tr_b16 v[38:39], v15 offset:26880
    v_fma_f32 v181, v181, s44, -v20
    v_cvt_pk_bf16_f32 v177, v178, v179
    v_exp_f32 v180, v180
    v_exp_f32 v181, v181
    v_fma_f32 v182, v182, s44, -v20
    v_fma_f32 v183, v183, s44, -v20
    v_exp_f32 v182, v182
    v_exp_f32 v183, v183
    v_cvt_pk_bf16_f32 v178, v180, v181
    v_cvt_pk_bf16_f32 v179, v182, v183
    v_mfma_f32_16x16x32_bf16 v[24:27], v[28:31], v[168:171], v[24:27]
    s_waitcnt lgkmcnt(10)
    v_mfma_f32_32x32x16_bf16 v[96:111], v[48:51], v[168:171], v[96:111]
    ds_read_b64_tr_b16 v[40:41], v15 offset:25088
    ds_read_b64_tr_b16 v[42:43], v15 offset:27136
    s_add_u32 s41, s41, 7168
    buffer_load_dwordx4 v5, s[8:11], s41 offen offset:2048 nt lds
    v_fma_f32 v184, v184, s44, -v20
    v_fma_f32 v185, v185, s44, -v20
    v_exp_f32 v184, v184
    v_exp_f32 v185, v185
    v_fma_f32 v186, v186, s44, -v20
    v_fma_f32 v187, v187, s44, -v20
    v_cvt_pk_bf16_f32 v184, v184, v185
    v_exp_f32 v186, v186
    v_exp_f32 v187, v187
    v_fma_f32 v188, v188, s44, -v20
    s_waitcnt lgkmcnt(10)
    v_mfma_f32_32x32x16_bf16 v[112:127], v[52:55], v[168:171], v[112:127]
    ds_read_b64_tr_b16 v[44:45], v15 offset:25344
    ds_read_b64_tr_b16 v[46:47], v15 offset:27392
    v_fma_f32 v189, v189, s44, -v20
    v_cvt_pk_bf16_f32 v185, v186, v187
    v_exp_f32 v188, v188
    v_exp_f32 v189, v189
    v_fma_f32 v190, v190, s44, -v20
    v_fma_f32 v191, v191, s44, -v20
    v_exp_f32 v190, v190
    v_exp_f32 v191, v191
    v_cvt_pk_bf16_f32 v186, v188, v189
    v_cvt_pk_bf16_f32 v187, v190, v191
    s_waitcnt lgkmcnt(10)
    v_mfma_f32_32x32x16_bf16 v[128:143], v[56:59], v[168:171], v[128:143]
    ds_read_b64_tr_b16 v[48:49], v15 offset:28672
    ds_read_b64_tr_b16 v[50:51], v15 offset:30720
    s_add_u32 s41, s41, 7168
    buffer_load_dwordx4 v5, s[8:11], s41 offen offset:3072 nt lds
    v_fma_f32 v192, v192, s44, -v20
    v_fma_f32 v193, v193, s44, -v20
    v_exp_f32 v192, v192
    v_exp_f32 v193, v193
    v_fma_f32 v194, v194, s44, -v20
    v_fma_f32 v195, v195, s44, -v20
    v_cvt_pk_bf16_f32 v192, v192, v193
    v_exp_f32 v194, v194
    v_exp_f32 v195, v195
    v_fma_f32 v196, v196, s44, -v20
    s_waitcnt lgkmcnt(10)
    v_mfma_f32_32x32x16_bf16 v[144:159], v[60:63], v[168:171], v[144:159]
    ds_read_b64_tr_b16 v[52:53], v15 offset:28928
    ds_read_b64_tr_b16 v[54:55], v15 offset:30976
    v_fma_f32 v197, v197, s44, -v20
    v_cvt_pk_bf16_f32 v193, v194, v195
    v_exp_f32 v196, v196
    v_exp_f32 v197, v197
    v_fma_f32 v198, v198, s44, -v20
    v_fma_f32 v199, v199, s44, -v20
    v_exp_f32 v198, v198
    v_exp_f32 v199, v199
    v_cvt_pk_bf16_f32 v194, v196, v197
    v_cvt_pk_bf16_f32 v195, v198, v199
    v_mfma_f32_16x16x32_bf16 v[24:27], v[28:31], v[176:179], v[24:27]
    s_waitcnt lgkmcnt(10)
    v_mfma_f32_32x32x16_bf16 v[96:111], v[32:35], v[176:179], v[96:111]
    ds_read_b64_tr_b16 v[56:57], v15 offset:29184
    ds_read_b64_tr_b16 v[58:59], v15 offset:31232
    v_fma_f32 v200, v200, s44, -v20
    v_fma_f32 v201, v201, s44, -v20
    v_exp_f32 v200, v200
    v_exp_f32 v201, v201
    v_fma_f32 v202, v202, s44, -v20
    v_fma_f32 v203, v203, s44, -v20
    v_cvt_pk_bf16_f32 v200, v200, v201
    v_exp_f32 v202, v202
    v_exp_f32 v203, v203
    v_fma_f32 v204, v204, s44, -v20
    s_waitcnt lgkmcnt(10)
    v_mfma_f32_32x32x16_bf16 v[112:127], v[36:39], v[176:179], v[112:127]
    ds_read_b64_tr_b16 v[60:61], v15 offset:29440
    ds_read_b64_tr_b16 v[62:63], v15 offset:31488
    v_fma_f32 v205, v205, s44, -v20
    v_cvt_pk_bf16_f32 v201, v202, v203
    v_exp_f32 v204, v204
    v_exp_f32 v205, v205
    v_fma_f32 v206, v206, s44, -v20
    v_fma_f32 v207, v207, s44, -v20
    v_exp_f32 v206, v206
    v_exp_f32 v207, v207
    v_cvt_pk_bf16_f32 v202, v204, v205
    v_cvt_pk_bf16_f32 v203, v206, v207
    s_waitcnt lgkmcnt(10)
    v_mfma_f32_32x32x16_bf16 v[128:143], v[40:43], v[176:179], v[128:143]
    v_fma_f32 v208, v208, s44, -v20
    v_fma_f32 v209, v209, s44, -v20
    v_exp_f32 v208, v208
    v_exp_f32 v209, v209
    v_fma_f32 v210, v210, s44, -v20
    v_fma_f32 v211, v211, s44, -v20
    v_cvt_pk_bf16_f32 v208, v208, v209
    v_exp_f32 v210, v210
    v_exp_f32 v211, v211
    v_fma_f32 v212, v212, s44, -v20
    s_waitcnt lgkmcnt(8)
    v_mfma_f32_32x32x16_bf16 v[144:159], v[44:47], v[176:179], v[144:159]
    v_fma_f32 v213, v213, s44, -v20
    v_cvt_pk_bf16_f32 v209, v210, v211
    v_exp_f32 v212, v212
    v_exp_f32 v213, v213
    v_fma_f32 v214, v214, s44, -v20
    v_fma_f32 v215, v215, s44, -v20
    v_exp_f32 v214, v214
    v_exp_f32 v215, v215
    v_cvt_pk_bf16_f32 v210, v212, v213
    v_cvt_pk_bf16_f32 v211, v214, v215
    v_mfma_f32_16x16x32_bf16 v[24:27], v[28:31], v[184:187], v[24:27]
    s_waitcnt lgkmcnt(6)
    v_mfma_f32_32x32x16_bf16 v[96:111], v[48:51], v[184:187], v[96:111]
    v_fma_f32 v216, v216, s44, -v20
    v_fma_f32 v217, v217, s44, -v20
    v_exp_f32 v216, v216
    v_exp_f32 v217, v217
    v_fma_f32 v218, v218, s44, -v20
    s_waitcnt lgkmcnt(4)
    v_mfma_f32_32x32x16_bf16 v[112:127], v[52:55], v[184:187], v[112:127]
    v_fma_f32 v219, v219, s44, -v20
    v_cvt_pk_bf16_f32 v216, v216, v217
    v_exp_f32 v218, v218
    v_exp_f32 v219, v219
    v_fma_f32 v220, v220, s44, -v20
    s_waitcnt lgkmcnt(2)
    v_mfma_f32_32x32x16_bf16 v[128:143], v[56:59], v[184:187], v[128:143]
    v_fma_f32 v221, v221, s44, -v20
    v_cvt_pk_bf16_f32 v217, v218, v219
    v_exp_f32 v220, v220
    v_exp_f32 v221, v221
    v_fma_f32 v222, v222, s44, -v20
    s_waitcnt lgkmcnt(0)
    v_mfma_f32_32x32x16_bf16 v[144:159], v[60:63], v[184:187], v[144:159]
    v_fma_f32 v223, v223, s44, -v20
    v_exp_f32 v222, v222
    v_exp_f32 v223, v223
    v_cvt_pk_bf16_f32 v218, v220, v221
    v_cvt_pk_bf16_f32 v219, v222, v223
    s_waitcnt vmcnt(12)
    s_barrier
    ds_read_b64_tr_b16 v[32:33], v15 offset:49152
    ds_read_b64_tr_b16 v[34:35], v15 offset:51200
    ds_read_b64_tr_b16 v[36:37], v15 offset:53248
    ds_read_b64_tr_b16 v[38:39], v15 offset:55296
    ds_read_b64_tr_b16 v[40:41], v15 offset:57344
    ds_read_b64_tr_b16 v[42:43], v15 offset:59392
    ds_read_b64_tr_b16 v[44:45], v15 offset:61440
    ds_read_b64_tr_b16 v[46:47], v15 offset:63488
    ds_read_b64_tr_b16 v[48:49], v15 offset:49408
    ds_read_b64_tr_b16 v[50:51], v15 offset:51456
    ds_read_b64_tr_b16 v[52:53], v15 offset:53504
    ds_read_b64_tr_b16 v[54:55], v15 offset:55552
    v_mfma_f32_16x16x32_bf16 v[24:27], v[28:31], v[192:195], v[24:27]
    v_mfma_f32_16x16x32_bf16 v[24:27], v[28:31], v[200:203], v[24:27]
    v_mfma_f32_16x16x32_bf16 v[24:27], v[28:31], v[208:211], v[24:27]
    v_mfma_f32_16x16x32_bf16 v[24:27], v[28:31], v[216:219], v[24:27]
    s_waitcnt lgkmcnt(10)
    v_mfma_f32_32x32x16_bf16 v[96:111], v[32:35], v[192:195], v[96:111]
    ds_read_b64_tr_b16 v[56:57], v15 offset:57600
    ds_read_b64_tr_b16 v[58:59], v15 offset:59648
    s_add_u32 m0, s69, 147456
    s_xor_b32 s41, s71, 1024
    buffer_load_dwordx4 v5, s[8:11], s41 offen offset:0 nt lds
    s_cmp_lt_u32 s68, 2
    s_cselect_b32 s93, 0, 8
    s_and_b32 s74, s68, 1
    s_add_u32 s93, s93, s74
    s_lshl_b32 s93, s93, 13
    v_add_u32 v22, s93, v23
    s_waitcnt lgkmcnt(10)
    v_mfma_f32_32x32x16_bf16 v[96:111], v[36:39], v[200:203], v[96:111]
    ds_read_b64_tr_b16 v[60:61], v15 offset:61696
    ds_read_b64_tr_b16 v[62:63], v15 offset:63744
    ds_read_b128 v[64:67], v22 offset:0
    s_waitcnt lgkmcnt(11)
    v_mfma_f32_32x32x16_bf16 v[96:111], v[40:43], v[208:211], v[96:111]
    ds_read_b64_tr_b16 v[32:33], v15 offset:49664
    ds_read_b64_tr_b16 v[34:35], v15 offset:51712
    s_add_u32 s41, s41, 7168
    buffer_load_dwordx4 v5, s[8:11], s41 offen offset:1024 nt lds
    v_rcp_f32 v2, v24
    s_cmp_lt_u32 s68, 2
    s_cselect_b32 s93, 12, 2
    s_and_b32 s74, s68, 1
    s_add_u32 s93, s93, s74
    s_lshl_b32 s93, s93, 13
    v_add_u32 v21, s93, v23
    ds_read_b128 v[68:71], v22 offset:1024
    s_waitcnt lgkmcnt(12)
    v_mfma_f32_32x32x16_bf16 v[96:111], v[44:47], v[216:219], v[96:111]
    ds_read_b64_tr_b16 v[36:37], v15 offset:53760
    ds_read_b64_tr_b16 v[38:39], v15 offset:55808
    ds_read_b128 v[72:75], v22 offset:2048
    s_waitcnt lgkmcnt(13)
    v_mfma_f32_32x32x16_bf16 v[112:127], v[48:51], v[192:195], v[112:127]
    ds_read_b64_tr_b16 v[40:41], v15 offset:57856
    ds_read_b64_tr_b16 v[42:43], v15 offset:59904
    s_add_u32 s41, s41, 7168
    buffer_load_dwordx4 v5, s[8:11], s41 offen offset:2048 nt lds
    ds_read_b128 v[76:79], v22 offset:3072
    s_waitcnt lgkmcnt(14)
    v_mfma_f32_32x32x16_bf16 v[112:127], v[52:55], v[200:203], v[112:127]
    ds_read_b64_tr_b16 v[44:45], v15 offset:61952
    ds_read_b64_tr_b16 v[46:47], v15 offset:64000
    v_mul_f32 v96, v96, v2
    v_mul_f32 v97, v97, v2
    v_mul_f32 v98, v98, v2
    v_mul_f32 v99, v99, v2
    v_mul_f32 v100, v100, v2
    v_mul_f32 v101, v101, v2
    v_mul_f32 v102, v102, v2
    v_mul_f32 v103, v103, v2
    v_mul_f32 v104, v104, v2
    v_mul_f32 v105, v105, v2
    ds_read_b128 v[80:83], v22 offset:4096
    s_waitcnt lgkmcnt(15)
    v_mfma_f32_32x32x16_bf16 v[112:127], v[56:59], v[208:211], v[112:127]
    ds_read_b64_tr_b16 v[48:49], v15 offset:49920
    ds_read_b64_tr_b16 v[50:51], v15 offset:51968
    s_add_u32 s41, s41, 7168
    buffer_load_dwordx4 v5, s[8:11], s41 offen offset:3072 nt lds
    v_mul_f32 v106, v106, v2
    v_mul_f32 v107, v107, v2
    v_mul_f32 v108, v108, v2
    v_mul_f32 v109, v109, v2
    v_mul_f32 v110, v110, v2
    v_mul_f32 v111, v111, v2
    v_cvt_pk_bf16_f32 v224, v96, v97
    v_cvt_pk_bf16_f32 v225, v98, v99
    v_cvt_pk_bf16_f32 v226, v100, v101
    v_cvt_pk_bf16_f32 v227, v102, v103
    ds_read_b128 v[84:87], v22 offset:5120
    s_waitcnt lgkmcnt(15)
    v_mfma_f32_32x32x16_bf16 v[112:127], v[60:63], v[216:219], v[112:127]
    ds_read_b64_tr_b16 v[52:53], v15 offset:54016
    ds_read_b64_tr_b16 v[54:55], v15 offset:56064
    v_cvt_pk_bf16_f32 v228, v104, v105
    v_cvt_pk_bf16_f32 v229, v106, v107
    v_cvt_pk_bf16_f32 v230, v108, v109
    v_cvt_pk_bf16_f32 v231, v110, v111
    v_permlane32_swap_b32 v224, v226
    v_permlane32_swap_b32 v225, v227
    v_permlane32_swap_b32 v228, v230
    v_permlane32_swap_b32 v229, v231
    ds_write_b128 v21, v[224:227] offset:0
    ds_write_b128 v21, v[228:231] offset:1024
    ds_read_b128 v[88:91], v22 offset:6144
    ds_read_b128 v[92:95], v22 offset:7168
    s_waitcnt lgkmcnt(15)
    v_mfma_f32_32x32x16_bf16 v[128:143], v[32:35], v[192:195], v[128:143]
    ds_read_b64_tr_b16 v[56:57], v15 offset:58112
    ds_read_b64_tr_b16 v[58:59], v15 offset:60160
    v_mfma_f32_32x32x16_bf16 v[128:143], v[36:39], v[200:203], v[128:143]
    ds_read_b64_tr_b16 v[60:61], v15 offset:62208
    ds_read_b64_tr_b16 v[62:63], v15 offset:64256
    v_mul_f32 v112, v112, v2
    v_mul_f32 v113, v113, v2
    v_mul_f32 v114, v114, v2
    v_mul_f32 v115, v115, v2
    v_mul_f32 v116, v116, v2
    v_mul_f32 v117, v117, v2
    v_mul_f32 v118, v118, v2
    v_mul_f32 v119, v119, v2
    v_mul_f32 v120, v120, v2
    v_mul_f32 v121, v121, v2
    s_waitcnt lgkmcnt(15)
    v_mfma_f32_32x32x16_bf16 v[128:143], v[40:43], v[208:211], v[128:143]
    v_mul_f32 v122, v122, v2
    v_mul_f32 v123, v123, v2
    v_mul_f32 v124, v124, v2
    v_mul_f32 v125, v125, v2
    v_mul_f32 v126, v126, v2
    v_mul_f32 v127, v127, v2
    v_cvt_pk_bf16_f32 v232, v112, v113
    v_cvt_pk_bf16_f32 v233, v114, v115
    v_cvt_pk_bf16_f32 v234, v116, v117
    v_cvt_pk_bf16_f32 v235, v118, v119
    s_waitcnt lgkmcnt(14)
    v_mfma_f32_32x32x16_bf16 v[128:143], v[44:47], v[216:219], v[128:143]
    v_cvt_pk_bf16_f32 v236, v120, v121
    v_cvt_pk_bf16_f32 v237, v122, v123
    v_cvt_pk_bf16_f32 v238, v124, v125
    v_cvt_pk_bf16_f32 v239, v126, v127
    v_permlane32_swap_b32 v232, v234
    v_permlane32_swap_b32 v233, v235
    v_permlane32_swap_b32 v236, v238
    v_permlane32_swap_b32 v237, v239
    ds_write_b128 v21, v[232:235] offset:2048
    ds_write_b128 v21, v[236:239] offset:3072
    s_waitcnt lgkmcnt(13)
    v_mfma_f32_32x32x16_bf16 v[144:159], v[48:51], v[192:195], v[144:159]
    s_waitcnt lgkmcnt(10)
    v_mfma_f32_32x32x16_bf16 v[144:159], v[52:55], v[200:203], v[144:159]
    v_mul_f32 v128, v128, v2
    v_mul_f32 v129, v129, v2
    v_mul_f32 v130, v130, v2
    v_mul_f32 v131, v131, v2
    v_mul_f32 v132, v132, v2
    v_mul_f32 v133, v133, v2
    v_mul_f32 v134, v134, v2
    v_mul_f32 v135, v135, v2
    v_mul_f32 v136, v136, v2
    v_mul_f32 v137, v137, v2
    s_waitcnt lgkmcnt(4)
    v_mfma_f32_32x32x16_bf16 v[144:159], v[56:59], v[208:211], v[144:159]
    v_mul_f32 v138, v138, v2
    v_mul_f32 v139, v139, v2
    v_mul_f32 v140, v140, v2
    v_mul_f32 v141, v141, v2
    v_mul_f32 v142, v142, v2
    v_mul_f32 v143, v143, v2
    v_cvt_pk_bf16_f32 v240, v128, v129
    v_cvt_pk_bf16_f32 v241, v130, v131
    v_cvt_pk_bf16_f32 v242, v132, v133
    v_cvt_pk_bf16_f32 v243, v134, v135
    s_waitcnt lgkmcnt(2)
    v_mfma_f32_32x32x16_bf16 v[144:159], v[60:63], v[216:219], v[144:159]
    v_cvt_pk_bf16_f32 v244, v136, v137
    v_cvt_pk_bf16_f32 v245, v138, v139
    v_cvt_pk_bf16_f32 v246, v140, v141
    v_cvt_pk_bf16_f32 v247, v142, v143
    v_permlane32_swap_b32 v240, v242
    v_permlane32_swap_b32 v241, v243
    v_permlane32_swap_b32 v244, v246
    v_permlane32_swap_b32 v245, v247
    ds_write_b128 v21, v[240:243] offset:4096
    ds_write_b128 v21, v[244:247] offset:5120
    s_nop 1
    v_mul_f32 v144, v144, v2
    v_mul_f32 v145, v145, v2
    v_mul_f32 v146, v146, v2
    v_mul_f32 v147, v147, v2
    v_mul_f32 v148, v148, v2
    v_mul_f32 v149, v149, v2
    v_mul_f32 v150, v150, v2
    v_mul_f32 v151, v151, v2
    v_mul_f32 v152, v152, v2
    v_mul_f32 v153, v153, v2
    v_mul_f32 v154, v154, v2
    v_mul_f32 v155, v155, v2
    v_mul_f32 v156, v156, v2
    v_mul_f32 v157, v157, v2
    v_mul_f32 v158, v158, v2
    v_mul_f32 v159, v159, v2
    v_cvt_pk_bf16_f32 v248, v144, v145
    v_cvt_pk_bf16_f32 v249, v146, v147
    v_cvt_pk_bf16_f32 v250, v148, v149
    v_cvt_pk_bf16_f32 v251, v150, v151
    v_cvt_pk_bf16_f32 v252, v152, v153
    v_cvt_pk_bf16_f32 v253, v154, v155
    v_cvt_pk_bf16_f32 v254, v156, v157
    v_cvt_pk_bf16_f32 v255, v158, v159
    v_permlane32_swap_b32 v248, v250
    v_permlane32_swap_b32 v249, v251
    v_permlane32_swap_b32 v252, v254
    v_permlane32_swap_b32 v253, v255
    ds_write_b128 v21, v[248:251] offset:6144
    ds_write_b128 v21, v[252:255] offset:7168
    s_waitcnt vmcnt(12)
    s_waitcnt lgkmcnt(0)
    s_barrier
    ds_read_b128 v[32:35], v9 offset:32768
    ds_read_b128 v[36:39], v10 offset:32768
    ds_read_b128 v[40:43], v9 offset:33024
    ds_read_b128 v[44:47], v10 offset:33024
    ds_read_b128 v[48:51], v9 offset:33280
    ds_read_b128 v[52:55], v10 offset:33280
    s_waitcnt lgkmcnt(5)
    v_mfma_f32_32x32x16_bf16 v[160:175], v[32:35], v[64:67], 0
    ds_read_b128 v[56:59], v9 offset:33536
    s_add_u32 m0, s69, 0
    s_xor_b32 s41, s71, 2048
    buffer_load_dwordx4 v5, s[4:7], s41 offen offset:0 nt lds
    s_waitcnt lgkmcnt(5)
    v_mfma_f32_32x32x16_bf16 v[160:175], v[36:39], v[68:71], v[160:175]
    ds_read_b128 v[60:63], v10 offset:33536
    s_waitcnt lgkmcnt(5)
    v_mfma_f32_32x32x16_bf16 v[160:175], v[40:43], v[72:75], v[160:175]
    ds_read_b128 v[32:35], v9 offset:40960
    s_add_u32 s41, s41, 7168
    buffer_load_dwordx4 v6, s[4:7], s41 offen offset:1024 nt lds
    s_waitcnt lgkmcnt(5)
    v_mfma_f32_32x32x16_bf16 v[160:175], v[44:47], v[76:79], v[160:175]
    ds_read_b128 v[36:39], v10 offset:40960
    s_waitcnt lgkmcnt(5)
    v_mfma_f32_32x32x16_bf16 v[160:175], v[48:51], v[80:83], v[160:175]
    ds_read_b128 v[40:43], v9 offset:41216
    s_add_u32 s41, s41, 7168
    buffer_load_dwordx4 v7, s[4:7], s41 offen offset:2048 nt lds
    s_waitcnt lgkmcnt(5)
    v_mfma_f32_32x32x16_bf16 v[160:175], v[52:55], v[84:87], v[160:175]
    ds_read_b128 v[44:47], v10 offset:41216
    s_waitcnt lgkmcnt(5)
    v_mfma_f32_32x32x16_bf16 v[160:175], v[56:59], v[88:91], v[160:175]
    ds_read_b128 v[48:51], v9 offset:41472
    s_add_u32 s41, s41, 7168
    buffer_load_dwordx4 v8, s[4:7], s41 offen offset:3072 nt lds
    s_waitcnt lgkmcnt(5)
    v_mfma_f32_32x32x16_bf16 v[160:175], v[60:63], v[92:95], v[160:175]
    ds_read_b128 v[52:55], v10 offset:41472
    s_waitcnt lgkmcnt(5)
    v_mfma_f32_32x32x16_bf16 v[176:191], v[32:35], v[64:67], 0
    ds_read_b128 v[56:59], v9 offset:41728
    s_waitcnt lgkmcnt(5)
    v_mfma_f32_32x32x16_bf16 v[176:191], v[36:39], v[68:71], v[176:191]
    ds_read_b128 v[60:63], v10 offset:41728
    s_waitcnt lgkmcnt(5)
    v_mfma_f32_32x32x16_bf16 v[176:191], v[40:43], v[72:75], v[176:191]
    s_nop 2
    v_max_f32 v19, v160, v161
    s_waitcnt lgkmcnt(4)
    v_mfma_f32_32x32x16_bf16 v[176:191], v[44:47], v[76:79], v[176:191]
    v_max3_f32 v19, v162, v163, v19
    s_waitcnt lgkmcnt(3)
    v_mfma_f32_32x32x16_bf16 v[176:191], v[48:51], v[80:83], v[176:191]
    v_max3_f32 v19, v164, v165, v19
    v_max3_f32 v19, v166, v167, v19
    s_waitcnt lgkmcnt(2)
    v_mfma_f32_32x32x16_bf16 v[176:191], v[52:55], v[84:87], v[176:191]
    v_max3_f32 v19, v168, v169, v19
    s_waitcnt lgkmcnt(1)
    v_mfma_f32_32x32x16_bf16 v[176:191], v[56:59], v[88:91], v[176:191]
    v_max3_f32 v19, v170, v171, v19
    s_waitcnt lgkmcnt(0)
    v_mfma_f32_32x32x16_bf16 v[176:191], v[60:63], v[92:95], v[176:191]
    v_max3_f32 v19, v172, v173, v19
    v_max3_f32 v19, v174, v175, v19
    s_waitcnt vmcnt(12)
    s_barrier
    ds_read_b128 v[32:35], v11 offset:16384
    ds_read_b128 v[36:39], v12 offset:16384
    ds_read_b128 v[40:43], v11 offset:16640
    ds_read_b128 v[44:47], v12 offset:16640
    ds_read_b128 v[48:51], v11 offset:16896
    ds_read_b128 v[52:55], v12 offset:16896
    s_waitcnt lgkmcnt(5)
    v_mfma_f32_32x32x16_bf16 v[192:207], v[32:35], v[64:67], 0
    ds_read_b128 v[56:59], v11 offset:17152
    s_add_u32 m0, s69, 16384
    s_xor_b32 s41, s71, 3072
    buffer_load_dwordx4 v5, s[4:7], s41 offen offset:0 nt lds
    s_waitcnt lgkmcnt(5)
    v_mfma_f32_32x32x16_bf16 v[192:207], v[36:39], v[68:71], v[192:207]
    ds_read_b128 v[60:63], v12 offset:17152
    v_max3_f32 v19, v176, v177, v19
    s_waitcnt lgkmcnt(5)
    v_mfma_f32_32x32x16_bf16 v[192:207], v[40:43], v[72:75], v[192:207]
    ds_read_b128 v[32:35], v11 offset:24576
    s_add_u32 s41, s41, 7168
    buffer_load_dwordx4 v6, s[4:7], s41 offen offset:1024 nt lds
    v_max3_f32 v19, v178, v179, v19
    s_waitcnt lgkmcnt(5)
    v_mfma_f32_32x32x16_bf16 v[192:207], v[44:47], v[76:79], v[192:207]
    ds_read_b128 v[36:39], v12 offset:24576
    v_max3_f32 v19, v180, v181, v19
    s_waitcnt lgkmcnt(5)
    v_mfma_f32_32x32x16_bf16 v[192:207], v[48:51], v[80:83], v[192:207]
    ds_read_b128 v[40:43], v11 offset:24832
    s_add_u32 s41, s41, 7168
    buffer_load_dwordx4 v7, s[4:7], s41 offen offset:2048 nt lds
    v_max3_f32 v19, v182, v183, v19
    s_waitcnt lgkmcnt(5)
    v_mfma_f32_32x32x16_bf16 v[192:207], v[52:55], v[84:87], v[192:207]
    ds_read_b128 v[44:47], v12 offset:24832
    s_waitcnt lgkmcnt(5)
    v_mfma_f32_32x32x16_bf16 v[192:207], v[56:59], v[88:91], v[192:207]
    ds_read_b128 v[48:51], v11 offset:25088
    s_add_u32 s41, s41, 7168
    buffer_load_dwordx4 v8, s[4:7], s41 offen offset:3072 nt lds
    v_max3_f32 v19, v184, v185, v19
    s_waitcnt lgkmcnt(5)
    v_mfma_f32_32x32x16_bf16 v[192:207], v[60:63], v[92:95], v[192:207]
    ds_read_b128 v[52:55], v12 offset:25088
    v_max3_f32 v19, v186, v187, v19
    s_waitcnt lgkmcnt(5)
    v_mfma_f32_32x32x16_bf16 v[208:223], v[32:35], v[64:67], 0
    ds_read_b128 v[56:59], v11 offset:25344
    v_max3_f32 v19, v188, v189, v19
    s_waitcnt lgkmcnt(5)
    v_mfma_f32_32x32x16_bf16 v[208:223], v[36:39], v[68:71], v[208:223]
    ds_read_b128 v[60:63], v12 offset:25344
    v_max3_f32 v19, v190, v191, v19
    s_waitcnt lgkmcnt(5)
    v_mfma_f32_32x32x16_bf16 v[208:223], v[40:43], v[72:75], v[208:223]
    v_max3_f32 v19, v192, v193, v19
    s_waitcnt lgkmcnt(4)
    v_mfma_f32_32x32x16_bf16 v[208:223], v[44:47], v[76:79], v[208:223]
    v_max3_f32 v19, v194, v195, v19
    s_waitcnt lgkmcnt(3)
    v_mfma_f32_32x32x16_bf16 v[208:223], v[48:51], v[80:83], v[208:223]
    v_max3_f32 v19, v196, v197, v19
    v_max3_f32 v19, v198, v199, v19
    s_waitcnt lgkmcnt(2)
    v_mfma_f32_32x32x16_bf16 v[208:223], v[52:55], v[84:87], v[208:223]
    v_max3_f32 v19, v200, v201, v19
    s_waitcnt lgkmcnt(1)
    v_mfma_f32_32x32x16_bf16 v[208:223], v[56:59], v[88:91], v[208:223]
    v_max3_f32 v19, v202, v203, v19
    s_waitcnt lgkmcnt(0)
    v_mfma_f32_32x32x16_bf16 v[208:223], v[60:63], v[92:95], v[208:223]
    v_max3_f32 v19, v204, v205, v19
    v_max3_f32 v19, v206, v207, v19
    s_nop 7
    s_nop 1
    v_max3_f32 v19, v208, v209, v19
    v_max3_f32 v19, v210, v211, v19
    v_max3_f32 v19, v212, v213, v19
    v_max3_f32 v19, v214, v215, v19
    v_max3_f32 v19, v216, v217, v19
    v_max3_f32 v19, v218, v219, v19
    v_max3_f32 v19, v220, v221, v19
    v_max3_f32 v19, v222, v223, v19
    v_mov_b32 v22, v19
    s_nop 1
    v_permlane32_swap_b32 v19, v22
    v_max_f32 v19, v19, v22
    v_mul_f32 v20, s44, v19
    v_mov_b32 v18, v19
    v_fma_f32 v160, v160, s44, -v20
    v_fma_f32 v161, v161, s44, -v20
    v_exp_f32 v160, v160
    v_exp_f32 v161, v161
    v_fma_f32 v162, v162, s44, -v20
    v_fma_f32 v163, v163, s44, -v20
    v_cvt_pk_bf16_f32 v160, v160, v161
    v_exp_f32 v162, v162
    v_exp_f32 v163, v163
    v_fma_f32 v164, v164, s44, -v20
    v_fma_f32 v165, v165, s44, -v20
    v_cvt_pk_bf16_f32 v161, v162, v163
    v_exp_f32 v164, v164
    v_exp_f32 v165, v165
    v_fma_f32 v166, v166, s44, -v20
    v_fma_f32 v167, v167, s44, -v20
    v_exp_f32 v166, v166
    v_exp_f32 v167, v167
    v_cvt_pk_bf16_f32 v162, v164, v165
    v_cvt_pk_bf16_f32 v163, v166, v167
    s_waitcnt vmcnt(12)
    s_barrier
    ds_read_b64_tr_b16 v[32:33], v17 offset:0
    ds_read_b64_tr_b16 v[34:35], v17 offset:2048
    ds_read_b64_tr_b16 v[36:37], v17 offset:256
    ds_read_b64_tr_b16 v[38:39], v17 offset:2304
    ds_read_b64_tr_b16 v[40:41], v17 offset:512
    ds_read_b64_tr_b16 v[42:43], v17 offset:2560
    ds_read_b64_tr_b16 v[44:45], v17 offset:768
    ds_read_b64_tr_b16 v[46:47], v17 offset:2816
    ds_read_b64_tr_b16 v[48:49], v17 offset:4096
    ds_read_b64_tr_b16 v[50:51], v17 offset:6144
    ds_read_b64_tr_b16 v[52:53], v17 offset:4352
    ds_read_b64_tr_b16 v[54:55], v17 offset:6400
    v_mfma_f32_16x16x32_bf16 v[24:27], v[28:31], v[160:163], 0
    s_waitcnt lgkmcnt(10)
    v_mfma_f32_32x32x16_bf16 v[96:111], v[32:35], v[160:163], 0
    ds_read_b64_tr_b16 v[56:57], v17 offset:4608
    ds_read_b64_tr_b16 v[58:59], v17 offset:6656
    s_add_u32 m0, s69, 49152
    s_xor_b32 s41, s71, 2048
    buffer_load_dwordx4 v5, s[8:11], s41 offen offset:0 nt lds
    v_fma_f32 v168, v168, s44, -v20
    v_fma_f32 v169, v169, s44, -v20
    v_exp_f32 v168, v168
    v_exp_f32 v169, v169
    v_fma_f32 v170, v170, s44, -v20
    s_waitcnt lgkmcnt(10)
    v_mfma_f32_32x32x16_bf16 v[112:127], v[36:39], v[160:163], 0
    ds_read_b64_tr_b16 v[60:61], v17 offset:4864
    ds_read_b64_tr_b16 v[62:63], v17 offset:6912
    v_fma_f32 v171, v171, s44, -v20
    v_cvt_pk_bf16_f32 v168, v168, v169
    v_exp_f32 v170, v170
    v_exp_f32 v171, v171
    v_fma_f32 v172, v172, s44, -v20
    s_waitcnt lgkmcnt(10)
    v_mfma_f32_32x32x16_bf16 v[128:143], v[40:43], v[160:163], 0
    ds_read_b64_tr_b16 v[32:33], v17 offset:8192
    ds_read_b64_tr_b16 v[34:35], v17 offset:10240
    s_add_u32 s41, s41, 7168
    buffer_load_dwordx4 v5, s[8:11], s41 offen offset:1024 nt lds
    v_fma_f32 v173, v173, s44, -v20
    v_cvt_pk_bf16_f32 v169, v170, v171
    v_exp_f32 v172, v172
    v_exp_f32 v173, v173
    v_fma_f32 v174, v174, s44, -v20
    s_waitcnt lgkmcnt(10)
    v_mfma_f32_32x32x16_bf16 v[144:159], v[44:47], v[160:163], 0
    ds_read_b64_tr_b16 v[36:37], v17 offset:8448
    ds_read_b64_tr_b16 v[38:39], v17 offset:10496
    v_fma_f32 v175, v175, s44, -v20
    v_exp_f32 v174, v174
    v_exp_f32 v175, v175
    v_cvt_pk_bf16_f32 v170, v172, v173
    v_cvt_pk_bf16_f32 v171, v174, v175
    s_nop 1
    v_mfma_f32_16x16x32_bf16 v[24:27], v[28:31], v[168:171], v[24:27]
    s_waitcnt lgkmcnt(10)
    v_mfma_f32_32x32x16_bf16 v[96:111], v[48:51], v[168:171], v[96:111]
    ds_read_b64_tr_b16 v[40:41], v17 offset:8704
    ds_read_b64_tr_b16 v[42:43], v17 offset:10752
    s_add_u32 s41, s41, 7168
    buffer_load_dwordx4 v5, s[8:11], s41 offen offset:2048 nt lds
    v_fma_f32 v176, v176, s44, -v20
    v_fma_f32 v177, v177, s44, -v20
    v_exp_f32 v176, v176
    v_exp_f32 v177, v177
    v_fma_f32 v178, v178, s44, -v20
    s_waitcnt lgkmcnt(10)
    v_mfma_f32_32x32x16_bf16 v[112:127], v[52:55], v[168:171], v[112:127]
    ds_read_b64_tr_b16 v[44:45], v17 offset:8960
    ds_read_b64_tr_b16 v[46:47], v17 offset:11008
    v_fma_f32 v179, v179, s44, -v20
    v_cvt_pk_bf16_f32 v176, v176, v177
    v_exp_f32 v178, v178
    v_exp_f32 v179, v179
    v_fma_f32 v180, v180, s44, -v20
    s_waitcnt lgkmcnt(10)
    v_mfma_f32_32x32x16_bf16 v[128:143], v[56:59], v[168:171], v[128:143]
    ds_read_b64_tr_b16 v[48:49], v17 offset:12288
    ds_read_b64_tr_b16 v[50:51], v17 offset:14336
    s_add_u32 s41, s41, 7168
    buffer_load_dwordx4 v5, s[8:11], s41 offen offset:3072 nt lds
    v_fma_f32 v181, v181, s44, -v20
    v_cvt_pk_bf16_f32 v177, v178, v179
    v_exp_f32 v180, v180
    v_exp_f32 v181, v181
    v_fma_f32 v182, v182, s44, -v20
    s_waitcnt lgkmcnt(10)
    v_mfma_f32_32x32x16_bf16 v[144:159], v[60:63], v[168:171], v[144:159]
    ds_read_b64_tr_b16 v[52:53], v17 offset:12544
    ds_read_b64_tr_b16 v[54:55], v17 offset:14592
    v_fma_f32 v183, v183, s44, -v20
    v_exp_f32 v182, v182
    v_exp_f32 v183, v183
    v_cvt_pk_bf16_f32 v178, v180, v181
    v_cvt_pk_bf16_f32 v179, v182, v183
    s_nop 1
    v_mfma_f32_16x16x32_bf16 v[24:27], v[28:31], v[176:179], v[24:27]
    s_waitcnt lgkmcnt(10)
    v_mfma_f32_32x32x16_bf16 v[96:111], v[32:35], v[176:179], v[96:111]
    ds_read_b64_tr_b16 v[56:57], v17 offset:12800
    ds_read_b64_tr_b16 v[58:59], v17 offset:14848
    v_fma_f32 v184, v184, s44, -v20
    v_fma_f32 v185, v185, s44, -v20
    v_exp_f32 v184, v184
    v_exp_f32 v185, v185
    v_fma_f32 v186, v186, s44, -v20
    s_waitcnt lgkmcnt(10)
    v_mfma_f32_32x32x16_bf16 v[112:127], v[36:39], v[176:179], v[112:127]
    ds_read_b64_tr_b16 v[60:61], v17 offset:13056
    ds_read_b64_tr_b16 v[62:63], v17 offset:15104
    v_fma_f32 v187, v187, s44, -v20
    v_cvt_pk_bf16_f32 v184, v184, v185
    v_exp_f32 v186, v186
    v_exp_f32 v187, v187
    v_fma_f32 v188, v188, s44, -v20
    s_waitcnt lgkmcnt(10)
    v_mfma_f32_32x32x16_bf16 v[128:143], v[40:43], v[176:179], v[128:143]
    v_fma_f32 v189, v189, s44, -v20
    v_cvt_pk_bf16_f32 v185, v186, v187
    v_exp_f32 v188, v188
    v_exp_f32 v189, v189
    v_fma_f32 v190, v190, s44, -v20
    s_waitcnt lgkmcnt(8)
    v_mfma_f32_32x32x16_bf16 v[144:159], v[44:47], v[176:179], v[144:159]
    v_fma_f32 v191, v191, s44, -v20
    v_exp_f32 v190, v190
    v_exp_f32 v191, v191
    v_cvt_pk_bf16_f32 v186, v188, v189
    v_cvt_pk_bf16_f32 v187, v190, v191
    s_nop 1
    v_mfma_f32_16x16x32_bf16 v[24:27], v[28:31], v[184:187], v[24:27]
    s_waitcnt lgkmcnt(6)
    v_mfma_f32_32x32x16_bf16 v[96:111], v[48:51], v[184:187], v[96:111]
    v_fma_f32 v192, v192, s44, -v20
    v_fma_f32 v193, v193, s44, -v20
    v_exp_f32 v192, v192
    v_exp_f32 v193, v193
    v_fma_f32 v194, v194, s44, -v20
    s_waitcnt lgkmcnt(4)
    v_mfma_f32_32x32x16_bf16 v[112:127], v[52:55], v[184:187], v[112:127]
    v_fma_f32 v195, v195, s44, -v20
    v_cvt_pk_bf16_f32 v192, v192, v193
    v_exp_f32 v194, v194
    v_exp_f32 v195, v195
    v_fma_f32 v196, v196, s44, -v20
    s_waitcnt lgkmcnt(2)
    v_mfma_f32_32x32x16_bf16 v[128:143], v[56:59], v[184:187], v[128:143]
    v_fma_f32 v197, v197, s44, -v20
    v_cvt_pk_bf16_f32 v193, v194, v195
    v_exp_f32 v196, v196
    v_exp_f32 v197, v197
    v_fma_f32 v198, v198, s44, -v20
    s_waitcnt lgkmcnt(0)
    v_mfma_f32_32x32x16_bf16 v[144:159], v[60:63], v[184:187], v[144:159]
    v_fma_f32 v199, v199, s44, -v20
    v_exp_f32 v198, v198
    v_exp_f32 v199, v199
    v_cvt_pk_bf16_f32 v194, v196, v197
    v_cvt_pk_bf16_f32 v195, v198, v199
    s_waitcnt vmcnt(12)
    s_barrier
    ds_read_b64_tr_b16 v[32:33], v17 offset:16384
    ds_read_b64_tr_b16 v[34:35], v17 offset:18432
    ds_read_b64_tr_b16 v[36:37], v17 offset:16640
    ds_read_b64_tr_b16 v[38:39], v17 offset:18688
    ds_read_b64_tr_b16 v[40:41], v17 offset:16896
    ds_read_b64_tr_b16 v[42:43], v17 offset:18944
    ds_read_b64_tr_b16 v[44:45], v17 offset:17152
    ds_read_b64_tr_b16 v[46:47], v17 offset:19200
    ds_read_b64_tr_b16 v[48:49], v17 offset:20480
    ds_read_b64_tr_b16 v[50:51], v17 offset:22528
    ds_read_b64_tr_b16 v[52:53], v17 offset:20736
    ds_read_b64_tr_b16 v[54:55], v17 offset:22784
    v_mfma_f32_16x16x32_bf16 v[24:27], v[28:31], v[192:195], v[24:27]
    s_waitcnt lgkmcnt(10)
    v_mfma_f32_32x32x16_bf16 v[96:111], v[32:35], v[192:195], v[96:111]
    ds_read_b64_tr_b16 v[56:57], v17 offset:20992
    ds_read_b64_tr_b16 v[58:59], v17 offset:23040
    s_add_u32 m0, s69, 65536
    s_xor_b32 s41, s71, 3072
    buffer_load_dwordx4 v5, s[8:11], s41 offen offset:0 nt lds
    v_fma_f32 v200, v200, s44, -v20
    v_fma_f32 v201, v201, s44, -v20
    v_exp_f32 v200, v200
    v_exp_f32 v201, v201
    v_fma_f32 v202, v202, s44, -v20
    s_waitcnt lgkmcnt(10)
    v_mfma_f32_32x32x16_bf16 v[112:127], v[36:39], v[192:195], v[112:127]
    ds_read_b64_tr_b16 v[60:61], v17 offset:21248
    ds_read_b64_tr_b16 v[62:63], v17 offset:23296
    v_fma_f32 v203, v203, s44, -v20
    v_cvt_pk_bf16_f32 v200, v200, v201
    v_exp_f32 v202, v202
    v_exp_f32 v203, v203
    v_fma_f32 v204, v204, s44, -v20
    s_waitcnt lgkmcnt(10)
    v_mfma_f32_32x32x16_bf16 v[128:143], v[40:43], v[192:195], v[128:143]
    ds_read_b64_tr_b16 v[32:33], v17 offset:24576
    ds_read_b64_tr_b16 v[34:35], v17 offset:26624
    s_add_u32 s41, s41, 7168
    buffer_load_dwordx4 v5, s[8:11], s41 offen offset:1024 nt lds
    v_fma_f32 v205, v205, s44, -v20
    v_cvt_pk_bf16_f32 v201, v202, v203
    v_exp_f32 v204, v204
    v_exp_f32 v205, v205
    v_fma_f32 v206, v206, s44, -v20
    s_waitcnt lgkmcnt(10)
    v_mfma_f32_32x32x16_bf16 v[144:159], v[44:47], v[192:195], v[144:159]
    ds_read_b64_tr_b16 v[36:37], v17 offset:24832
    ds_read_b64_tr_b16 v[38:39], v17 offset:26880
    v_fma_f32 v207, v207, s44, -v20
    v_exp_f32 v206, v206
    v_exp_f32 v207, v207
    v_cvt_pk_bf16_f32 v202, v204, v205
    v_cvt_pk_bf16_f32 v203, v206, v207
    s_nop 1
    v_mfma_f32_16x16x32_bf16 v[24:27], v[28:31], v[200:203], v[24:27]
    s_waitcnt lgkmcnt(10)
    v_mfma_f32_32x32x16_bf16 v[96:111], v[48:51], v[200:203], v[96:111]
    ds_read_b64_tr_b16 v[40:41], v17 offset:25088
    ds_read_b64_tr_b16 v[42:43], v17 offset:27136
    s_add_u32 s41, s41, 7168
    buffer_load_dwordx4 v5, s[8:11], s41 offen offset:2048 nt lds
    v_fma_f32 v208, v208, s44, -v20
    v_fma_f32 v209, v209, s44, -v20
    v_exp_f32 v208, v208
    v_exp_f32 v209, v209
    v_fma_f32 v210, v210, s44, -v20
    s_waitcnt lgkmcnt(10)
    v_mfma_f32_32x32x16_bf16 v[112:127], v[52:55], v[200:203], v[112:127]
    ds_read_b64_tr_b16 v[44:45], v17 offset:25344
    ds_read_b64_tr_b16 v[46:47], v17 offset:27392
    v_fma_f32 v211, v211, s44, -v20
    v_cvt_pk_bf16_f32 v208, v208, v209
    v_exp_f32 v210, v210
    v_exp_f32 v211, v211
    v_fma_f32 v212, v212, s44, -v20
    s_waitcnt lgkmcnt(10)
    v_mfma_f32_32x32x16_bf16 v[128:143], v[56:59], v[200:203], v[128:143]
    ds_read_b64_tr_b16 v[48:49], v17 offset:28672
    ds_read_b64_tr_b16 v[50:51], v17 offset:30720
    s_add_u32 s41, s41, 7168
    buffer_load_dwordx4 v5, s[8:11], s41 offen offset:3072 nt lds
    v_fma_f32 v213, v213, s44, -v20
    v_cvt_pk_bf16_f32 v209, v210, v211
    v_exp_f32 v212, v212
    v_exp_f32 v213, v213
    v_fma_f32 v214, v214, s44, -v20
    s_waitcnt lgkmcnt(10)
    v_mfma_f32_32x32x16_bf16 v[144:159], v[60:63], v[200:203], v[144:159]
    ds_read_b64_tr_b16 v[52:53], v17 offset:28928
    ds_read_b64_tr_b16 v[54:55], v17 offset:30976
    v_fma_f32 v215, v215, s44, -v20
    v_exp_f32 v214, v214
    v_exp_f32 v215, v215
    v_cvt_pk_bf16_f32 v210, v212, v213
    v_cvt_pk_bf16_f32 v211, v214, v215
    s_nop 1
    v_mfma_f32_16x16x32_bf16 v[24:27], v[28:31], v[208:211], v[24:27]
    s_waitcnt lgkmcnt(10)
    v_mfma_f32_32x32x16_bf16 v[96:111], v[32:35], v[208:211], v[96:111]
    ds_read_b64_tr_b16 v[56:57], v17 offset:29184
    ds_read_b64_tr_b16 v[58:59], v17 offset:31232
    v_fma_f32 v216, v216, s44, -v20
    v_fma_f32 v217, v217, s44, -v20
    v_exp_f32 v216, v216
    v_exp_f32 v217, v217
    v_fma_f32 v218, v218, s44, -v20
    s_waitcnt lgkmcnt(10)
    v_mfma_f32_32x32x16_bf16 v[112:127], v[36:39], v[208:211], v[112:127]
    ds_read_b64_tr_b16 v[60:61], v17 offset:29440
    ds_read_b64_tr_b16 v[62:63], v17 offset:31488
    v_fma_f32 v219, v219, s44, -v20
    v_cvt_pk_bf16_f32 v216, v216, v217
    v_exp_f32 v218, v218
    v_exp_f32 v219, v219
    v_fma_f32 v220, v220, s44, -v20
    s_waitcnt lgkmcnt(10)
    v_mfma_f32_32x32x16_bf16 v[128:143], v[40:43], v[208:211], v[128:143]
    v_fma_f32 v221, v221, s44, -v20
    v_cvt_pk_bf16_f32 v217, v218, v219
    v_exp_f32 v220, v220
    v_exp_f32 v221, v221
    v_fma_f32 v222, v222, s44, -v20
    s_waitcnt lgkmcnt(8)
    v_mfma_f32_32x32x16_bf16 v[144:159], v[44:47], v[208:211], v[144:159]
    v_fma_f32 v223, v223, s44, -v20
    v_exp_f32 v222, v222
    v_exp_f32 v223, v223
    v_cvt_pk_bf16_f32 v218, v220, v221
    v_cvt_pk_bf16_f32 v219, v222, v223
    s_nop 1
    v_mfma_f32_16x16x32_bf16 v[24:27], v[28:31], v[216:219], v[24:27]
    s_waitcnt lgkmcnt(6)
    v_mfma_f32_32x32x16_bf16 v[96:111], v[48:51], v[216:219], v[96:111]
    s_waitcnt lgkmcnt(4)
    v_mfma_f32_32x32x16_bf16 v[112:127], v[52:55], v[216:219], v[112:127]
    s_waitcnt lgkmcnt(2)
    v_mfma_f32_32x32x16_bf16 v[128:143], v[56:59], v[216:219], v[128:143]
    s_waitcnt lgkmcnt(0)
    v_mfma_f32_32x32x16_bf16 v[144:159], v[60:63], v[216:219], v[144:159]
    s_waitcnt vmcnt(12)
    s_barrier
    ds_read_b128 v[32:35], v9 offset:0
    ds_read_b128 v[36:39], v10 offset:0
    ds_read_b128 v[40:43], v9 offset:256
    ds_read_b128 v[44:47], v10 offset:256
    ds_read_b128 v[48:51], v9 offset:512
    ds_read_b128 v[52:55], v10 offset:512
    s_waitcnt lgkmcnt(5)
    v_mfma_f32_32x32x16_bf16 v[160:175], v[32:35], v[64:67], 0
    ds_read_b128 v[56:59], v9 offset:768
    s_add_u32 m0, s69, 81920
    s_xor_b32 s41, s71, 4096
    buffer_load_dwordx4 v5, s[4:7], s41 offen offset:0 nt lds
    s_waitcnt lgkmcnt(5)
    v_mfma_f32_32x32x16_bf16 v[160:175], v[36:39], v[68:71], v[160:175]
    ds_read_b128 v[60:63], v10 offset:768
    s_waitcnt lgkmcnt(5)
    v_mfma_f32_32x32x16_bf16 v[160:175], v[40:43], v[72:75], v[160:175]
    ds_read_b128 v[32:35], v9 offset:8192
    s_add_u32 s41, s41, 7168
    buffer_load_dwordx4 v6, s[4:7], s41 offen offset:1024 nt lds
    s_waitcnt lgkmcnt(5)
    v_mfma_f32_32x32x16_bf16 v[160:175], v[44:47], v[76:79], v[160:175]
    ds_read_b128 v[36:39], v10 offset:8192
    s_waitcnt lgkmcnt(5)
    v_mfma_f32_32x32x16_bf16 v[160:175], v[48:51], v[80:83], v[160:175]
    ds_read_b128 v[40:43], v9 offset:8448
    s_add_u32 s41, s41, 7168
    buffer_load_dwordx4 v7, s[4:7], s41 offen offset:2048 nt lds
    s_waitcnt lgkmcnt(5)
    v_mfma_f32_32x32x16_bf16 v[160:175], v[52:55], v[84:87], v[160:175]
    ds_read_b128 v[44:47], v10 offset:8448
    s_waitcnt lgkmcnt(5)
    v_mfma_f32_32x32x16_bf16 v[160:175], v[56:59], v[88:91], v[160:175]
    ds_read_b128 v[48:51], v9 offset:8704
    s_add_u32 s41, s41, 7168
    buffer_load_dwordx4 v8, s[4:7], s41 offen offset:3072 nt lds
    s_waitcnt lgkmcnt(5)
    v_mfma_f32_32x32x16_bf16 v[160:175], v[60:63], v[92:95], v[160:175]
    ds_read_b128 v[52:55], v10 offset:8704
    s_waitcnt lgkmcnt(5)
    v_mfma_f32_32x32x16_bf16 v[176:191], v[32:35], v[64:67], 0
    ds_read_b128 v[56:59], v9 offset:8960
    s_waitcnt lgkmcnt(5)
    v_mfma_f32_32x32x16_bf16 v[176:191], v[36:39], v[68:71], v[176:191]
    ds_read_b128 v[60:63], v10 offset:8960
    s_waitcnt lgkmcnt(5)
    v_mfma_f32_32x32x16_bf16 v[176:191], v[40:43], v[72:75], v[176:191]
    s_nop 2
    v_max3_f32 v19, v160, v161, v18
    s_waitcnt lgkmcnt(4)
    v_mfma_f32_32x32x16_bf16 v[176:191], v[44:47], v[76:79], v[176:191]
    v_max3_f32 v19, v162, v163, v19
    s_waitcnt lgkmcnt(3)
    v_mfma_f32_32x32x16_bf16 v[176:191], v[48:51], v[80:83], v[176:191]
    v_max3_f32 v19, v164, v165, v19
    v_max3_f32 v19, v166, v167, v19
    s_waitcnt lgkmcnt(2)
    v_mfma_f32_32x32x16_bf16 v[176:191], v[52:55], v[84:87], v[176:191]
    v_max3_f32 v19, v168, v169, v19
    s_waitcnt lgkmcnt(1)
    v_mfma_f32_32x32x16_bf16 v[176:191], v[56:59], v[88:91], v[176:191]
    v_max3_f32 v19, v170, v171, v19
    s_waitcnt lgkmcnt(0)
    v_mfma_f32_32x32x16_bf16 v[176:191], v[60:63], v[92:95], v[176:191]
    v_max3_f32 v19, v172, v173, v19
    v_max3_f32 v19, v174, v175, v19
    s_waitcnt vmcnt(12)
    s_barrier
    ds_read_b128 v[32:35], v9 offset:16384
    ds_read_b128 v[36:39], v10 offset:16384
    ds_read_b128 v[40:43], v9 offset:16640
    ds_read_b128 v[44:47], v10 offset:16640
    ds_read_b128 v[48:51], v9 offset:16896
    ds_read_b128 v[52:55], v10 offset:16896
    s_waitcnt lgkmcnt(5)
    v_mfma_f32_32x32x16_bf16 v[192:207], v[32:35], v[64:67], 0
    ds_read_b128 v[56:59], v9 offset:17152
    s_add_u32 m0, s69, 0
    s_xor_b32 s41, s71, 5120
    buffer_load_dwordx4 v5, s[4:7], s41 offen offset:0 nt lds
    s_waitcnt lgkmcnt(5)
    v_mfma_f32_32x32x16_bf16 v[192:207], v[36:39], v[68:71], v[192:207]
    ds_read_b128 v[60:63], v10 offset:17152
    v_max3_f32 v19, v176, v177, v19
    s_waitcnt lgkmcnt(5)
    v_mfma_f32_32x32x16_bf16 v[192:207], v[40:43], v[72:75], v[192:207]
    ds_read_b128 v[32:35], v9 offset:24576
    s_add_u32 s41, s41, 7168
    buffer_load_dwordx4 v6, s[4:7], s41 offen offset:1024 nt lds
    v_max3_f32 v19, v178, v179, v19
    s_waitcnt lgkmcnt(5)
    v_mfma_f32_32x32x16_bf16 v[192:207], v[44:47], v[76:79], v[192:207]
    ds_read_b128 v[36:39], v10 offset:24576
    v_max3_f32 v19, v180, v181, v19
    s_waitcnt lgkmcnt(5)
    v_mfma_f32_32x32x16_bf16 v[192:207], v[48:51], v[80:83], v[192:207]
    ds_read_b128 v[40:43], v9 offset:24832
    s_add_u32 s41, s41, 7168
    buffer_load_dwordx4 v7, s[4:7], s41 offen offset:2048 nt lds
    v_max3_f32 v19, v182, v183, v19
    s_waitcnt lgkmcnt(5)
    v_mfma_f32_32x32x16_bf16 v[192:207], v[52:55], v[84:87], v[192:207]
    ds_read_b128 v[44:47], v10 offset:24832
    s_waitcnt lgkmcnt(5)
    v_mfma_f32_32x32x16_bf16 v[192:207], v[56:59], v[88:91], v[192:207]
    ds_read_b128 v[48:51], v9 offset:25088
    s_add_u32 s41, s41, 7168
    buffer_load_dwordx4 v8, s[4:7], s41 offen offset:3072 nt lds
    v_max3_f32 v19, v184, v185, v19
    s_waitcnt lgkmcnt(5)
    v_mfma_f32_32x32x16_bf16 v[192:207], v[60:63], v[92:95], v[192:207]
    ds_read_b128 v[52:55], v10 offset:25088
    v_max3_f32 v19, v186, v187, v19
    s_waitcnt lgkmcnt(5)
    v_mfma_f32_32x32x16_bf16 v[208:223], v[32:35], v[64:67], 0
    ds_read_b128 v[56:59], v9 offset:25344
    v_max3_f32 v19, v188, v189, v19
    s_waitcnt lgkmcnt(5)
    v_mfma_f32_32x32x16_bf16 v[208:223], v[36:39], v[68:71], v[208:223]
    ds_read_b128 v[60:63], v10 offset:25344
    v_max3_f32 v19, v190, v191, v19
    s_waitcnt lgkmcnt(5)
    v_mfma_f32_32x32x16_bf16 v[208:223], v[40:43], v[72:75], v[208:223]
    v_max3_f32 v19, v192, v193, v19
    s_waitcnt lgkmcnt(4)
    v_mfma_f32_32x32x16_bf16 v[208:223], v[44:47], v[76:79], v[208:223]
    v_max3_f32 v19, v194, v195, v19
    s_waitcnt lgkmcnt(3)
    v_mfma_f32_32x32x16_bf16 v[208:223], v[48:51], v[80:83], v[208:223]
    v_max3_f32 v19, v196, v197, v19
    v_max3_f32 v19, v198, v199, v19
    s_waitcnt lgkmcnt(2)
    v_mfma_f32_32x32x16_bf16 v[208:223], v[52:55], v[84:87], v[208:223]
    v_max3_f32 v19, v200, v201, v19
    s_waitcnt lgkmcnt(1)
    v_mfma_f32_32x32x16_bf16 v[208:223], v[56:59], v[88:91], v[208:223]
    v_max3_f32 v19, v202, v203, v19
    s_waitcnt lgkmcnt(0)
    v_mfma_f32_32x32x16_bf16 v[208:223], v[60:63], v[92:95], v[208:223]
    v_max3_f32 v19, v204, v205, v19
    v_max3_f32 v19, v206, v207, v19
    s_nop 7
    s_nop 1
    v_max3_f32 v19, v208, v209, v19
    v_max3_f32 v19, v210, v211, v19
    v_max3_f32 v19, v212, v213, v19
    v_max3_f32 v19, v214, v215, v19
    v_max3_f32 v19, v216, v217, v19
    v_max3_f32 v19, v218, v219, v19
    v_max3_f32 v19, v220, v221, v19
    v_max3_f32 v19, v222, v223, v19
    v_mov_b32 v22, v19
    s_nop 1
    v_permlane32_swap_b32 v19, v22
    v_max_f32 v19, v19, v22
    v_mul_f32 v20, s44, v19
    v_fma_f32 v2, v18, s44, -v20
    v_exp_f32 v2, v2
    v_mov_b32 v18, v19
    v_fma_f32 v160, v160, s44, -v20
    v_fma_f32 v161, v161, s44, -v20
    v_exp_f32 v160, v160
    v_exp_f32 v161, v161
    v_fma_f32 v162, v162, s44, -v20
    v_fma_f32 v163, v163, s44, -v20
    v_cvt_pk_bf16_f32 v160, v160, v161
    v_exp_f32 v162, v162
    v_exp_f32 v163, v163
    v_fma_f32 v164, v164, s44, -v20
    v_fma_f32 v165, v165, s44, -v20
    v_cvt_pk_bf16_f32 v161, v162, v163
    v_exp_f32 v164, v164
    v_exp_f32 v165, v165
    v_fma_f32 v166, v166, s44, -v20
    v_fma_f32 v167, v167, s44, -v20
    v_exp_f32 v166, v166
    v_exp_f32 v167, v167
    v_cvt_pk_bf16_f32 v162, v164, v165
    v_cvt_pk_bf16_f32 v163, v166, v167
    v_mul_f32 v24, v24, v2
    v_mul_f32 v96, v96, v2
    v_mul_f32 v97, v97, v2
    v_mul_f32 v98, v98, v2
    v_mul_f32 v99, v99, v2
    v_mul_f32 v100, v100, v2
    v_mul_f32 v101, v101, v2
    v_mul_f32 v102, v102, v2
    v_mul_f32 v103, v103, v2
    v_mul_f32 v104, v104, v2
    v_mul_f32 v105, v105, v2
    v_mul_f32 v106, v106, v2
    v_mul_f32 v107, v107, v2
    v_mul_f32 v108, v108, v2
    v_mul_f32 v109, v109, v2
    v_mul_f32 v110, v110, v2
    v_mul_f32 v111, v111, v2
    s_waitcnt vmcnt(12)
    s_barrier
    ds_read_b64_tr_b16 v[32:33], v15 offset:49152
    ds_read_b64_tr_b16 v[34:35], v15 offset:51200
    ds_read_b64_tr_b16 v[36:37], v15 offset:49408
    ds_read_b64_tr_b16 v[38:39], v15 offset:51456
    ds_read_b64_tr_b16 v[40:41], v15 offset:49664
    ds_read_b64_tr_b16 v[42:43], v15 offset:51712
    ds_read_b64_tr_b16 v[44:45], v15 offset:49920
    ds_read_b64_tr_b16 v[46:47], v15 offset:51968
    ds_read_b64_tr_b16 v[48:49], v15 offset:53248
    ds_read_b64_tr_b16 v[50:51], v15 offset:55296
    ds_read_b64_tr_b16 v[52:53], v15 offset:53504
    ds_read_b64_tr_b16 v[54:55], v15 offset:55552
    v_mfma_f32_16x16x32_bf16 v[24:27], v[28:31], v[160:163], v[24:27]
    s_waitcnt lgkmcnt(10)
    v_mfma_f32_32x32x16_bf16 v[96:111], v[32:35], v[160:163], v[96:111]
    ds_read_b64_tr_b16 v[56:57], v15 offset:53760
    ds_read_b64_tr_b16 v[58:59], v15 offset:55808
    s_add_u32 m0, s69, 16384
    s_xor_b32 s41, s71, 4096
    buffer_load_dwordx4 v5, s[8:11], s41 offen offset:0 nt lds
    v_fma_f32 v168, v168, s44, -v20
    v_fma_f32 v169, v169, s44, -v20
    v_exp_f32 v168, v168
    v_exp_f32 v169, v169
    v_fma_f32 v170, v170, s44, -v20
    v_mul_f32 v112, v112, v2
    v_mul_f32 v113, v113, v2
    v_mul_f32 v114, v114, v2
    v_mul_f32 v115, v115, v2
    v_mul_f32 v116, v116, v2
    v_mul_f32 v117, v117, v2
    v_mul_f32 v118, v118, v2
    v_mul_f32 v119, v119, v2
    v_mul_f32 v120, v120, v2
    v_mul_f32 v121, v121, v2
    v_mul_f32 v122, v122, v2
    v_mul_f32 v123, v123, v2
    v_mul_f32 v124, v124, v2
    v_mul_f32 v125, v125, v2
    v_mul_f32 v126, v126, v2
    v_mul_f32 v127, v127, v2
    s_waitcnt lgkmcnt(10)
    s_nop 0
    v_mfma_f32_32x32x16_bf16 v[112:127], v[36:39], v[160:163], v[112:127]
    ds_read_b64_tr_b16 v[60:61], v15 offset:54016
    ds_read_b64_tr_b16 v[62:63], v15 offset:56064
    v_fma_f32 v171, v171, s44, -v20
    v_cvt_pk_bf16_f32 v168, v168, v169
    v_exp_f32 v170, v170
    v_exp_f32 v171, v171
    v_fma_f32 v172, v172, s44, -v20
    v_mul_f32 v128, v128, v2
    v_mul_f32 v129, v129, v2
    v_mul_f32 v130, v130, v2
    v_mul_f32 v131, v131, v2
    v_mul_f32 v132, v132, v2
    v_mul_f32 v133, v133, v2
    v_mul_f32 v134, v134, v2
    v_mul_f32 v135, v135, v2
    v_mul_f32 v136, v136, v2
    v_mul_f32 v137, v137, v2
    v_mul_f32 v138, v138, v2
    v_mul_f32 v139, v139, v2
    v_mul_f32 v140, v140, v2
    v_mul_f32 v141, v141, v2
    v_mul_f32 v142, v142, v2
    v_mul_f32 v143, v143, v2
    s_waitcnt lgkmcnt(10)
    s_nop 0
    v_mfma_f32_32x32x16_bf16 v[128:143], v[40:43], v[160:163], v[128:143]
    ds_read_b64_tr_b16 v[32:33], v15 offset:57344
    ds_read_b64_tr_b16 v[34:35], v15 offset:59392
    s_add_u32 s41, s41, 7168
    buffer_load_dwordx4 v5, s[8:11], s41 offen offset:1024 nt lds
    v_fma_f32 v173, v173, s44, -v20
    v_cvt_pk_bf16_f32 v169, v170, v171
    v_exp_f32 v172, v172
    v_exp_f32 v173, v173
    v_fma_f32 v174, v174, s44, -v20
    v_mul_f32 v144, v144, v2
    v_mul_f32 v145, v145, v2
    v_mul_f32 v146, v146, v2
    v_mul_f32 v147, v147, v2
    v_mul_f32 v148, v148, v2
    v_mul_f32 v149, v149, v2
    v_mul_f32 v150, v150, v2
    v_mul_f32 v151, v151, v2
    v_mul_f32 v152, v152, v2
    v_mul_f32 v153, v153, v2
    v_mul_f32 v154, v154, v2
    v_mul_f32 v155, v155, v2
    v_mul_f32 v156, v156, v2
    v_mul_f32 v157, v157, v2
    v_mul_f32 v158, v158, v2
    v_mul_f32 v159, v159, v2
    s_waitcnt lgkmcnt(10)
    s_nop 0
    v_mfma_f32_32x32x16_bf16 v[144:159], v[44:47], v[160:163], v[144:159]
    ds_read_b64_tr_b16 v[36:37], v15 offset:57600
    ds_read_b64_tr_b16 v[38:39], v15 offset:59648
    v_fma_f32 v175, v175, s44, -v20
    v_exp_f32 v174, v174
    v_exp_f32 v175, v175
    v_cvt_pk_bf16_f32 v170, v172, v173
    v_cvt_pk_bf16_f32 v171, v174, v175
    s_nop 1
    v_mfma_f32_16x16x32_bf16 v[24:27], v[28:31], v[168:171], v[24:27]
    s_waitcnt lgkmcnt(10)
    v_mfma_f32_32x32x16_bf16 v[96:111], v[48:51], v[168:171], v[96:111]
    ds_read_b64_tr_b16 v[40:41], v15 offset:57856
    ds_read_b64_tr_b16 v[42:43], v15 offset:59904
    s_add_u32 s41, s41, 7168
    buffer_load_dwordx4 v5, s[8:11], s41 offen offset:2048 nt lds
    v_fma_f32 v176, v176, s44, -v20
    v_fma_f32 v177, v177, s44, -v20
    v_exp_f32 v176, v176
    v_exp_f32 v177, v177
    v_fma_f32 v178, v178, s44, -v20
    s_waitcnt lgkmcnt(10)
    v_mfma_f32_32x32x16_bf16 v[112:127], v[52:55], v[168:171], v[112:127]
    ds_read_b64_tr_b16 v[44:45], v15 offset:58112
    ds_read_b64_tr_b16 v[46:47], v15 offset:60160
    v_fma_f32 v179, v179, s44, -v20
    v_cvt_pk_bf16_f32 v176, v176, v177
    v_exp_f32 v178, v178
    v_exp_f32 v179, v179
    v_fma_f32 v180, v180, s44, -v20
    s_waitcnt lgkmcnt(10)
    v_mfma_f32_32x32x16_bf16 v[128:143], v[56:59], v[168:171], v[128:143]
    ds_read_b64_tr_b16 v[48:49], v15 offset:61440
    ds_read_b64_tr_b16 v[50:51], v15 offset:63488
    s_add_u32 s41, s41, 7168
    buffer_load_dwordx4 v5, s[8:11], s41 offen offset:3072 nt lds
    v_fma_f32 v181, v181, s44, -v20
    v_cvt_pk_bf16_f32 v177, v178, v179
    v_exp_f32 v180, v180
    v_exp_f32 v181, v181
    v_fma_f32 v182, v182, s44, -v20
    s_waitcnt lgkmcnt(10)
    v_mfma_f32_32x32x16_bf16 v[144:159], v[60:63], v[168:171], v[144:159]
    ds_read_b64_tr_b16 v[52:53], v15 offset:61696
    ds_read_b64_tr_b16 v[54:55], v15 offset:63744
    v_fma_f32 v183, v183, s44, -v20
    v_exp_f32 v182, v182
    v_exp_f32 v183, v183
    v_cvt_pk_bf16_f32 v178, v180, v181
    v_cvt_pk_bf16_f32 v179, v182, v183
    s_nop 1
    v_mfma_f32_16x16x32_bf16 v[24:27], v[28:31], v[176:179], v[24:27]
    s_waitcnt lgkmcnt(10)
    v_mfma_f32_32x32x16_bf16 v[96:111], v[32:35], v[176:179], v[96:111]
    ds_read_b64_tr_b16 v[56:57], v15 offset:61952
    ds_read_b64_tr_b16 v[58:59], v15 offset:64000
    v_fma_f32 v184, v184, s44, -v20
    v_fma_f32 v185, v185, s44, -v20
    v_exp_f32 v184, v184
    v_exp_f32 v185, v185
    v_fma_f32 v186, v186, s44, -v20
    s_waitcnt lgkmcnt(10)
    v_mfma_f32_32x32x16_bf16 v[112:127], v[36:39], v[176:179], v[112:127]
    ds_read_b64_tr_b16 v[60:61], v15 offset:62208
    ds_read_b64_tr_b16 v[62:63], v15 offset:64256
    v_fma_f32 v187, v187, s44, -v20
    v_cvt_pk_bf16_f32 v184, v184, v185
    v_exp_f32 v186, v186
    v_exp_f32 v187, v187
    v_fma_f32 v188, v188, s44, -v20
    s_waitcnt lgkmcnt(10)
    v_mfma_f32_32x32x16_bf16 v[128:143], v[40:43], v[176:179], v[128:143]
    v_fma_f32 v189, v189, s44, -v20
    v_cvt_pk_bf16_f32 v185, v186, v187
    v_exp_f32 v188, v188
    v_exp_f32 v189, v189
    v_fma_f32 v190, v190, s44, -v20
    s_waitcnt lgkmcnt(8)
    v_mfma_f32_32x32x16_bf16 v[144:159], v[44:47], v[176:179], v[144:159]
    v_fma_f32 v191, v191, s44, -v20
    v_exp_f32 v190, v190
    v_exp_f32 v191, v191
    v_cvt_pk_bf16_f32 v186, v188, v189
    v_cvt_pk_bf16_f32 v187, v190, v191
    s_nop 1
    v_mfma_f32_16x16x32_bf16 v[24:27], v[28:31], v[184:187], v[24:27]
    s_waitcnt lgkmcnt(6)
    v_mfma_f32_32x32x16_bf16 v[96:111], v[48:51], v[184:187], v[96:111]
    v_fma_f32 v192, v192, s44, -v20
    v_fma_f32 v193, v193, s44, -v20
    v_exp_f32 v192, v192
    v_exp_f32 v193, v193
    v_fma_f32 v194, v194, s44, -v20
    s_waitcnt lgkmcnt(4)
    v_mfma_f32_32x32x16_bf16 v[112:127], v[52:55], v[184:187], v[112:127]
    v_fma_f32 v195, v195, s44, -v20
    v_cvt_pk_bf16_f32 v192, v192, v193
    v_exp_f32 v194, v194
    v_exp_f32 v195, v195
    v_fma_f32 v196, v196, s44, -v20
    s_waitcnt lgkmcnt(2)
    v_mfma_f32_32x32x16_bf16 v[128:143], v[56:59], v[184:187], v[128:143]
    v_fma_f32 v197, v197, s44, -v20
    v_cvt_pk_bf16_f32 v193, v194, v195
    v_exp_f32 v196, v196
    v_exp_f32 v197, v197
    v_fma_f32 v198, v198, s44, -v20
    s_waitcnt lgkmcnt(0)
    v_mfma_f32_32x32x16_bf16 v[144:159], v[60:63], v[184:187], v[144:159]
    v_fma_f32 v199, v199, s44, -v20
    v_exp_f32 v198, v198
    v_exp_f32 v199, v199
    v_cvt_pk_bf16_f32 v194, v196, v197
    v_cvt_pk_bf16_f32 v195, v198, v199
    s_waitcnt vmcnt(12)
    s_barrier
    ds_read_b64_tr_b16 v[32:33], v16 offset:0
    ds_read_b64_tr_b16 v[34:35], v16 offset:2048
    ds_read_b64_tr_b16 v[36:37], v16 offset:256
    ds_read_b64_tr_b16 v[38:39], v16 offset:2304
    ds_read_b64_tr_b16 v[40:41], v16 offset:512
    ds_read_b64_tr_b16 v[42:43], v16 offset:2560
    ds_read_b64_tr_b16 v[44:45], v16 offset:768
    ds_read_b64_tr_b16 v[46:47], v16 offset:2816
    ds_read_b64_tr_b16 v[48:49], v16 offset:4096
    ds_read_b64_tr_b16 v[50:51], v16 offset:6144
    ds_read_b64_tr_b16 v[52:53], v16 offset:4352
    ds_read_b64_tr_b16 v[54:55], v16 offset:6400
    v_mfma_f32_16x16x32_bf16 v[24:27], v[28:31], v[192:195], v[24:27]
    s_waitcnt lgkmcnt(10)
    v_mfma_f32_32x32x16_bf16 v[96:111], v[32:35], v[192:195], v[96:111]
    ds_read_b64_tr_b16 v[56:57], v16 offset:4608
    ds_read_b64_tr_b16 v[58:59], v16 offset:6656
    s_add_u32 m0, s69, 114688
    s_xor_b32 s41, s71, 5120
    buffer_load_dwordx4 v5, s[8:11], s41 offen offset:0 nt lds
    v_fma_f32 v200, v200, s44, -v20
    v_fma_f32 v201, v201, s44, -v20
    v_exp_f32 v200, v200
    v_exp_f32 v201, v201
    v_fma_f32 v202, v202, s44, -v20
    s_waitcnt lgkmcnt(10)
    v_mfma_f32_32x32x16_bf16 v[112:127], v[36:39], v[192:195], v[112:127]
    ds_read_b64_tr_b16 v[60:61], v16 offset:4864
    ds_read_b64_tr_b16 v[62:63], v16 offset:6912
    v_fma_f32 v203, v203, s44, -v20
    v_cvt_pk_bf16_f32 v200, v200, v201
    v_exp_f32 v202, v202
    v_exp_f32 v203, v203
    v_fma_f32 v204, v204, s44, -v20
    s_waitcnt lgkmcnt(10)
    v_mfma_f32_32x32x16_bf16 v[128:143], v[40:43], v[192:195], v[128:143]
    ds_read_b64_tr_b16 v[32:33], v16 offset:8192
    ds_read_b64_tr_b16 v[34:35], v16 offset:10240
    s_add_u32 s41, s41, 7168
    buffer_load_dwordx4 v5, s[8:11], s41 offen offset:1024 nt lds
    v_fma_f32 v205, v205, s44, -v20
    v_cvt_pk_bf16_f32 v201, v202, v203
    v_exp_f32 v204, v204
    v_exp_f32 v205, v205
    v_fma_f32 v206, v206, s44, -v20
    s_waitcnt lgkmcnt(10)
    v_mfma_f32_32x32x16_bf16 v[144:159], v[44:47], v[192:195], v[144:159]
    ds_read_b64_tr_b16 v[36:37], v16 offset:8448
    ds_read_b64_tr_b16 v[38:39], v16 offset:10496
    v_fma_f32 v207, v207, s44, -v20
    v_exp_f32 v206, v206
    v_exp_f32 v207, v207
    v_cvt_pk_bf16_f32 v202, v204, v205
    v_cvt_pk_bf16_f32 v203, v206, v207
    s_nop 1
    v_mfma_f32_16x16x32_bf16 v[24:27], v[28:31], v[200:203], v[24:27]
    s_waitcnt lgkmcnt(10)
    v_mfma_f32_32x32x16_bf16 v[96:111], v[48:51], v[200:203], v[96:111]
    ds_read_b64_tr_b16 v[40:41], v16 offset:8704
    ds_read_b64_tr_b16 v[42:43], v16 offset:10752
    s_add_u32 s41, s41, 7168
    buffer_load_dwordx4 v5, s[8:11], s41 offen offset:2048 nt lds
    v_fma_f32 v208, v208, s44, -v20
    v_fma_f32 v209, v209, s44, -v20
    v_exp_f32 v208, v208
    v_exp_f32 v209, v209
    v_fma_f32 v210, v210, s44, -v20
    s_waitcnt lgkmcnt(10)
    v_mfma_f32_32x32x16_bf16 v[112:127], v[52:55], v[200:203], v[112:127]
    ds_read_b64_tr_b16 v[44:45], v16 offset:8960
    ds_read_b64_tr_b16 v[46:47], v16 offset:11008
    v_fma_f32 v211, v211, s44, -v20
    v_cvt_pk_bf16_f32 v208, v208, v209
    v_exp_f32 v210, v210
    v_exp_f32 v211, v211
    v_fma_f32 v212, v212, s44, -v20
    s_waitcnt lgkmcnt(10)
    v_mfma_f32_32x32x16_bf16 v[128:143], v[56:59], v[200:203], v[128:143]
    ds_read_b64_tr_b16 v[48:49], v16 offset:12288
    ds_read_b64_tr_b16 v[50:51], v16 offset:14336
    s_add_u32 s41, s41, 7168
    buffer_load_dwordx4 v5, s[8:11], s41 offen offset:3072 nt lds
    v_fma_f32 v213, v213, s44, -v20
    v_cvt_pk_bf16_f32 v209, v210, v211
    v_exp_f32 v212, v212
    v_exp_f32 v213, v213
    v_fma_f32 v214, v214, s44, -v20
    s_waitcnt lgkmcnt(10)
    v_mfma_f32_32x32x16_bf16 v[144:159], v[60:63], v[200:203], v[144:159]
    ds_read_b64_tr_b16 v[52:53], v16 offset:12544
    ds_read_b64_tr_b16 v[54:55], v16 offset:14592
    v_fma_f32 v215, v215, s44, -v20
    v_exp_f32 v214, v214
    v_exp_f32 v215, v215
    v_cvt_pk_bf16_f32 v210, v212, v213
    v_cvt_pk_bf16_f32 v211, v214, v215
    s_nop 1
    v_mfma_f32_16x16x32_bf16 v[24:27], v[28:31], v[208:211], v[24:27]
    s_waitcnt lgkmcnt(10)
    v_mfma_f32_32x32x16_bf16 v[96:111], v[32:35], v[208:211], v[96:111]
    ds_read_b64_tr_b16 v[56:57], v16 offset:12800
    ds_read_b64_tr_b16 v[58:59], v16 offset:14848
    v_fma_f32 v216, v216, s44, -v20
    v_fma_f32 v217, v217, s44, -v20
    v_exp_f32 v216, v216
    v_exp_f32 v217, v217
    v_fma_f32 v218, v218, s44, -v20
    s_waitcnt lgkmcnt(10)
    v_mfma_f32_32x32x16_bf16 v[112:127], v[36:39], v[208:211], v[112:127]
    ds_read_b64_tr_b16 v[60:61], v16 offset:13056
    ds_read_b64_tr_b16 v[62:63], v16 offset:15104
    v_fma_f32 v219, v219, s44, -v20
    v_cvt_pk_bf16_f32 v216, v216, v217
    v_exp_f32 v218, v218
    v_exp_f32 v219, v219
    v_fma_f32 v220, v220, s44, -v20
    s_waitcnt lgkmcnt(10)
    v_mfma_f32_32x32x16_bf16 v[128:143], v[40:43], v[208:211], v[128:143]
    v_fma_f32 v221, v221, s44, -v20
    v_cvt_pk_bf16_f32 v217, v218, v219
    v_exp_f32 v220, v220
    v_exp_f32 v221, v221
    v_fma_f32 v222, v222, s44, -v20
    s_waitcnt lgkmcnt(8)
    v_mfma_f32_32x32x16_bf16 v[144:159], v[44:47], v[208:211], v[144:159]
    v_fma_f32 v223, v223, s44, -v20
    v_exp_f32 v222, v222
    v_exp_f32 v223, v223
    v_cvt_pk_bf16_f32 v218, v220, v221
    v_cvt_pk_bf16_f32 v219, v222, v223
    s_nop 1
    v_mfma_f32_16x16x32_bf16 v[24:27], v[28:31], v[216:219], v[24:27]
    s_waitcnt lgkmcnt(6)
    v_mfma_f32_32x32x16_bf16 v[96:111], v[48:51], v[216:219], v[96:111]
    s_waitcnt lgkmcnt(4)
    v_mfma_f32_32x32x16_bf16 v[112:127], v[52:55], v[216:219], v[112:127]
    s_waitcnt lgkmcnt(2)
    v_mfma_f32_32x32x16_bf16 v[128:143], v[56:59], v[216:219], v[128:143]
    s_waitcnt lgkmcnt(0)
    v_mfma_f32_32x32x16_bf16 v[144:159], v[60:63], v[216:219], v[144:159]
    s_waitcnt vmcnt(12)
    s_barrier
    ds_read_b128 v[32:35], v11 offset:16384
    ds_read_b128 v[36:39], v12 offset:16384
    ds_read_b128 v[40:43], v11 offset:16640
    ds_read_b128 v[44:47], v12 offset:16640
    ds_read_b128 v[48:51], v11 offset:16896
    ds_read_b128 v[52:55], v12 offset:16896
    s_waitcnt lgkmcnt(5)
    v_mfma_f32_32x32x16_bf16 v[160:175], v[32:35], v[64:67], 0
    ds_read_b128 v[56:59], v11 offset:17152
    s_add_u32 m0, s69, 131072
    s_xor_b32 s41, s71, 6144
    buffer_load_dwordx4 v5, s[4:7], s41 offen offset:0 nt lds
    s_waitcnt lgkmcnt(5)
    v_mfma_f32_32x32x16_bf16 v[160:175], v[36:39], v[68:71], v[160:175]
    ds_read_b128 v[60:63], v12 offset:17152
    s_waitcnt lgkmcnt(5)
    v_mfma_f32_32x32x16_bf16 v[160:175], v[40:43], v[72:75], v[160:175]
    ds_read_b128 v[32:35], v11 offset:24576
    s_add_u32 s41, s41, 7168
    buffer_load_dwordx4 v6, s[4:7], s41 offen offset:1024 nt lds
    s_waitcnt lgkmcnt(5)
    v_mfma_f32_32x32x16_bf16 v[160:175], v[44:47], v[76:79], v[160:175]
    ds_read_b128 v[36:39], v12 offset:24576
    s_waitcnt lgkmcnt(5)
    v_mfma_f32_32x32x16_bf16 v[160:175], v[48:51], v[80:83], v[160:175]
    ds_read_b128 v[40:43], v11 offset:24832
    s_add_u32 s41, s41, 7168
    buffer_load_dwordx4 v7, s[4:7], s41 offen offset:2048 nt lds
    s_waitcnt lgkmcnt(5)
    v_mfma_f32_32x32x16_bf16 v[160:175], v[52:55], v[84:87], v[160:175]
    ds_read_b128 v[44:47], v12 offset:24832
    s_waitcnt lgkmcnt(5)
    v_mfma_f32_32x32x16_bf16 v[160:175], v[56:59], v[88:91], v[160:175]
    ds_read_b128 v[48:51], v11 offset:25088
    s_add_u32 s41, s41, 7168
    buffer_load_dwordx4 v8, s[4:7], s41 offen offset:3072 nt lds
    s_waitcnt lgkmcnt(5)
    v_mfma_f32_32x32x16_bf16 v[160:175], v[60:63], v[92:95], v[160:175]
    ds_read_b128 v[52:55], v12 offset:25088
    s_waitcnt lgkmcnt(5)
    v_mfma_f32_32x32x16_bf16 v[176:191], v[32:35], v[64:67], 0
    ds_read_b128 v[56:59], v11 offset:25344
    s_waitcnt lgkmcnt(5)
    v_mfma_f32_32x32x16_bf16 v[176:191], v[36:39], v[68:71], v[176:191]
    ds_read_b128 v[60:63], v12 offset:25344
    s_waitcnt lgkmcnt(5)
    v_mfma_f32_32x32x16_bf16 v[176:191], v[40:43], v[72:75], v[176:191]
    s_nop 2
    v_max3_f32 v19, v160, v161, v18
    s_waitcnt lgkmcnt(4)
    v_mfma_f32_32x32x16_bf16 v[176:191], v[44:47], v[76:79], v[176:191]
    v_max3_f32 v19, v162, v163, v19
    s_waitcnt lgkmcnt(3)
    v_mfma_f32_32x32x16_bf16 v[176:191], v[48:51], v[80:83], v[176:191]
    v_max3_f32 v19, v164, v165, v19
    v_max3_f32 v19, v166, v167, v19
    s_waitcnt lgkmcnt(2)
    v_mfma_f32_32x32x16_bf16 v[176:191], v[52:55], v[84:87], v[176:191]
    v_max3_f32 v19, v168, v169, v19
    s_waitcnt lgkmcnt(1)
    v_mfma_f32_32x32x16_bf16 v[176:191], v[56:59], v[88:91], v[176:191]
    v_max3_f32 v19, v170, v171, v19
    s_waitcnt lgkmcnt(0)
    v_mfma_f32_32x32x16_bf16 v[176:191], v[60:63], v[92:95], v[176:191]
    v_max3_f32 v19, v172, v173, v19
    v_max3_f32 v19, v174, v175, v19
    s_waitcnt vmcnt(12)
    s_barrier
    ds_read_b128 v[32:35], v9 offset:0
    ds_read_b128 v[36:39], v10 offset:0
    ds_read_b128 v[40:43], v9 offset:256
    ds_read_b128 v[44:47], v10 offset:256
    ds_read_b128 v[48:51], v9 offset:512
    ds_read_b128 v[52:55], v10 offset:512
    s_waitcnt lgkmcnt(5)
    v_mfma_f32_32x32x16_bf16 v[192:207], v[32:35], v[64:67], 0
    ds_read_b128 v[56:59], v9 offset:768
    s_waitcnt lgkmcnt(5)
    v_mfma_f32_32x32x16_bf16 v[192:207], v[36:39], v[68:71], v[192:207]
    ds_read_b128 v[60:63], v10 offset:768
    v_max3_f32 v19, v176, v177, v19
    s_waitcnt lgkmcnt(5)
    v_mfma_f32_32x32x16_bf16 v[192:207], v[40:43], v[72:75], v[192:207]
    ds_read_b128 v[32:35], v9 offset:8192
    v_max3_f32 v19, v178, v179, v19
    s_waitcnt lgkmcnt(5)
    v_mfma_f32_32x32x16_bf16 v[192:207], v[44:47], v[76:79], v[192:207]
    ds_read_b128 v[36:39], v10 offset:8192
    v_max3_f32 v19, v180, v181, v19
    s_waitcnt lgkmcnt(5)
    v_mfma_f32_32x32x16_bf16 v[192:207], v[48:51], v[80:83], v[192:207]
    ds_read_b128 v[40:43], v9 offset:8448
    v_max3_f32 v19, v182, v183, v19
    s_waitcnt lgkmcnt(5)
    v_mfma_f32_32x32x16_bf16 v[192:207], v[52:55], v[84:87], v[192:207]
    ds_read_b128 v[44:47], v10 offset:8448
    s_waitcnt lgkmcnt(5)
    v_mfma_f32_32x32x16_bf16 v[192:207], v[56:59], v[88:91], v[192:207]
    ds_read_b128 v[48:51], v9 offset:8704
    v_max3_f32 v19, v184, v185, v19
    s_waitcnt lgkmcnt(5)
    v_mfma_f32_32x32x16_bf16 v[192:207], v[60:63], v[92:95], v[192:207]
    ds_read_b128 v[52:55], v10 offset:8704
    v_max3_f32 v19, v186, v187, v19
    s_waitcnt lgkmcnt(5)
    v_mfma_f32_32x32x16_bf16 v[208:223], v[32:35], v[64:67], 0
    ds_read_b128 v[56:59], v9 offset:8960
    v_max3_f32 v19, v188, v189, v19
    s_waitcnt lgkmcnt(5)
    v_mfma_f32_32x32x16_bf16 v[208:223], v[36:39], v[68:71], v[208:223]
    ds_read_b128 v[60:63], v10 offset:8960
    v_max3_f32 v19, v190, v191, v19
    s_waitcnt lgkmcnt(5)
    v_mfma_f32_32x32x16_bf16 v[208:223], v[40:43], v[72:75], v[208:223]
    v_max3_f32 v19, v192, v193, v19
    s_waitcnt lgkmcnt(4)
    v_mfma_f32_32x32x16_bf16 v[208:223], v[44:47], v[76:79], v[208:223]
    v_max3_f32 v19, v194, v195, v19
    s_waitcnt lgkmcnt(3)
    v_mfma_f32_32x32x16_bf16 v[208:223], v[48:51], v[80:83], v[208:223]
    v_max3_f32 v19, v196, v197, v19
    v_max3_f32 v19, v198, v199, v19
    s_waitcnt lgkmcnt(2)
    v_mfma_f32_32x32x16_bf16 v[208:223], v[52:55], v[84:87], v[208:223]
    v_max3_f32 v19, v200, v201, v19
    s_waitcnt lgkmcnt(1)
    v_mfma_f32_32x32x16_bf16 v[208:223], v[56:59], v[88:91], v[208:223]
    v_max3_f32 v19, v202, v203, v19
    s_waitcnt lgkmcnt(0)
    v_mfma_f32_32x32x16_bf16 v[208:223], v[60:63], v[92:95], v[208:223]
    v_max3_f32 v19, v204, v205, v19
    v_max3_f32 v19, v206, v207, v19
    s_nop 7
    s_nop 1
    v_max3_f32 v19, v208, v209, v19
    v_max3_f32 v19, v210, v211, v19
    v_max3_f32 v19, v212, v213, v19
    v_max3_f32 v19, v214, v215, v19
    v_max3_f32 v19, v216, v217, v19
    v_max3_f32 v19, v218, v219, v19
    v_max3_f32 v19, v220, v221, v19
    v_max3_f32 v19, v222, v223, v19
    v_mov_b32 v22, v19
    s_nop 1
    v_permlane32_swap_b32 v19, v22
    v_max_f32 v19, v19, v22
    v_mul_f32 v20, s44, v19
    v_fma_f32 v2, v18, s44, -v20
    v_exp_f32 v2, v2
    v_mov_b32 v18, v19
    v_fma_f32 v160, v160, s44, -v20
    v_fma_f32 v161, v161, s44, -v20
    v_exp_f32 v160, v160
    v_exp_f32 v161, v161
    v_fma_f32 v162, v162, s44, -v20
    v_fma_f32 v163, v163, s44, -v20
    v_cvt_pk_bf16_f32 v160, v160, v161
    v_exp_f32 v162, v162
    v_exp_f32 v163, v163
    v_fma_f32 v164, v164, s44, -v20
    v_fma_f32 v165, v165, s44, -v20
    v_cvt_pk_bf16_f32 v161, v162, v163
    v_exp_f32 v164, v164
    v_exp_f32 v165, v165
    v_fma_f32 v166, v166, s44, -v20
    v_fma_f32 v167, v167, s44, -v20
    v_exp_f32 v166, v166
    v_exp_f32 v167, v167
    v_cvt_pk_bf16_f32 v162, v164, v165
    v_cvt_pk_bf16_f32 v163, v166, v167
    v_mul_f32 v24, v24, v2
    v_mul_f32 v96, v96, v2
    v_mul_f32 v97, v97, v2
    v_mul_f32 v98, v98, v2
    v_mul_f32 v99, v99, v2
    v_mul_f32 v100, v100, v2
    v_mul_f32 v101, v101, v2
    v_mul_f32 v102, v102, v2
    v_mul_f32 v103, v103, v2
    v_mul_f32 v104, v104, v2
    v_mul_f32 v105, v105, v2
    v_mul_f32 v106, v106, v2
    v_mul_f32 v107, v107, v2
    v_mul_f32 v108, v108, v2
    v_mul_f32 v109, v109, v2
    v_mul_f32 v110, v110, v2
    v_mul_f32 v111, v111, v2
    s_waitcnt vmcnt(8)
    s_barrier
    ds_read_b64_tr_b16 v[32:33], v15 offset:16384
    ds_read_b64_tr_b16 v[34:35], v15 offset:18432
    ds_read_b64_tr_b16 v[36:37], v15 offset:16640
    ds_read_b64_tr_b16 v[38:39], v15 offset:18688
    ds_read_b64_tr_b16 v[40:41], v15 offset:16896
    ds_read_b64_tr_b16 v[42:43], v15 offset:18944
    ds_read_b64_tr_b16 v[44:45], v15 offset:17152
    ds_read_b64_tr_b16 v[46:47], v15 offset:19200
    ds_read_b64_tr_b16 v[48:49], v15 offset:20480
    ds_read_b64_tr_b16 v[50:51], v15 offset:22528
    ds_read_b64_tr_b16 v[52:53], v15 offset:20736
    ds_read_b64_tr_b16 v[54:55], v15 offset:22784
    v_mfma_f32_16x16x32_bf16 v[24:27], v[28:31], v[160:163], v[24:27]
    s_waitcnt lgkmcnt(10)
    v_mfma_f32_32x32x16_bf16 v[96:111], v[32:35], v[160:163], v[96:111]
    ds_read_b64_tr_b16 v[56:57], v15 offset:20992
    ds_read_b64_tr_b16 v[58:59], v15 offset:23040
    s_add_u32 m0, s69, 0
    s_xor_b32 s41, s71, 7168
    buffer_load_dwordx4 v5, s[4:7], s41 offen offset:0 nt lds
    v_fma_f32 v168, v168, s44, -v20
    v_fma_f32 v169, v169, s44, -v20
    v_exp_f32 v168, v168
    v_exp_f32 v169, v169
    v_fma_f32 v170, v170, s44, -v20
    v_mul_f32 v112, v112, v2
    v_mul_f32 v113, v113, v2
    v_mul_f32 v114, v114, v2
    v_mul_f32 v115, v115, v2
    v_mul_f32 v116, v116, v2
    v_mul_f32 v117, v117, v2
    v_mul_f32 v118, v118, v2
    v_mul_f32 v119, v119, v2
    v_mul_f32 v120, v120, v2
    v_mul_f32 v121, v121, v2
    v_mul_f32 v122, v122, v2
    v_mul_f32 v123, v123, v2
    v_mul_f32 v124, v124, v2
    v_mul_f32 v125, v125, v2
    v_mul_f32 v126, v126, v2
    v_mul_f32 v127, v127, v2
    s_waitcnt lgkmcnt(10)
    s_nop 0
    v_mfma_f32_32x32x16_bf16 v[112:127], v[36:39], v[160:163], v[112:127]
    ds_read_b64_tr_b16 v[60:61], v15 offset:21248
    ds_read_b64_tr_b16 v[62:63], v15 offset:23296
    v_fma_f32 v171, v171, s44, -v20
    v_cvt_pk_bf16_f32 v168, v168, v169
    v_exp_f32 v170, v170
    v_exp_f32 v171, v171
    v_fma_f32 v172, v172, s44, -v20
    v_mul_f32 v128, v128, v2
    v_mul_f32 v129, v129, v2
    v_mul_f32 v130, v130, v2
    v_mul_f32 v131, v131, v2
    v_mul_f32 v132, v132, v2
    v_mul_f32 v133, v133, v2
    v_mul_f32 v134, v134, v2
    v_mul_f32 v135, v135, v2
    v_mul_f32 v136, v136, v2
    v_mul_f32 v137, v137, v2
    v_mul_f32 v138, v138, v2
    v_mul_f32 v139, v139, v2
    v_mul_f32 v140, v140, v2
    v_mul_f32 v141, v141, v2
    v_mul_f32 v142, v142, v2
    v_mul_f32 v143, v143, v2
    s_waitcnt lgkmcnt(10)
    s_nop 0
    v_mfma_f32_32x32x16_bf16 v[128:143], v[40:43], v[160:163], v[128:143]
    ds_read_b64_tr_b16 v[32:33], v15 offset:24576
    ds_read_b64_tr_b16 v[34:35], v15 offset:26624
    s_add_u32 s41, s41, 7168
    buffer_load_dwordx4 v6, s[4:7], s41 offen offset:1024 nt lds
    v_fma_f32 v173, v173, s44, -v20
    v_cvt_pk_bf16_f32 v169, v170, v171
    v_exp_f32 v172, v172
    v_exp_f32 v173, v173
    v_fma_f32 v174, v174, s44, -v20
    v_mul_f32 v144, v144, v2
    v_mul_f32 v145, v145, v2
    v_mul_f32 v146, v146, v2
    v_mul_f32 v147, v147, v2
    v_mul_f32 v148, v148, v2
    v_mul_f32 v149, v149, v2
    v_mul_f32 v150, v150, v2
    v_mul_f32 v151, v151, v2
    v_mul_f32 v152, v152, v2
    v_mul_f32 v153, v153, v2
    v_mul_f32 v154, v154, v2
    v_mul_f32 v155, v155, v2
    v_mul_f32 v156, v156, v2
    v_mul_f32 v157, v157, v2
    v_mul_f32 v158, v158, v2
    v_mul_f32 v159, v159, v2
    s_waitcnt lgkmcnt(10)
    s_nop 0
    v_mfma_f32_32x32x16_bf16 v[144:159], v[44:47], v[160:163], v[144:159]
    ds_read_b64_tr_b16 v[36:37], v15 offset:24832
    ds_read_b64_tr_b16 v[38:39], v15 offset:26880
    v_fma_f32 v175, v175, s44, -v20
    v_exp_f32 v174, v174
    v_exp_f32 v175, v175
    v_cvt_pk_bf16_f32 v170, v172, v173
    v_cvt_pk_bf16_f32 v171, v174, v175
    s_nop 1
    v_mfma_f32_16x16x32_bf16 v[24:27], v[28:31], v[168:171], v[24:27]
    s_waitcnt lgkmcnt(10)
    v_mfma_f32_32x32x16_bf16 v[96:111], v[48:51], v[168:171], v[96:111]
    ds_read_b64_tr_b16 v[40:41], v15 offset:25088
    ds_read_b64_tr_b16 v[42:43], v15 offset:27136
    s_add_u32 s41, s41, 7168
    buffer_load_dwordx4 v7, s[4:7], s41 offen offset:2048 nt lds
    v_fma_f32 v176, v176, s44, -v20
    v_fma_f32 v177, v177, s44, -v20
    v_exp_f32 v176, v176
    v_exp_f32 v177, v177
    v_fma_f32 v178, v178, s44, -v20
    s_waitcnt lgkmcnt(10)
    v_mfma_f32_32x32x16_bf16 v[112:127], v[52:55], v[168:171], v[112:127]
    ds_read_b64_tr_b16 v[44:45], v15 offset:25344
    ds_read_b64_tr_b16 v[46:47], v15 offset:27392
    v_fma_f32 v179, v179, s44, -v20
    v_cvt_pk_bf16_f32 v176, v176, v177
    v_exp_f32 v178, v178
    v_exp_f32 v179, v179
    v_fma_f32 v180, v180, s44, -v20
    s_waitcnt lgkmcnt(10)
    v_mfma_f32_32x32x16_bf16 v[128:143], v[56:59], v[168:171], v[128:143]
    ds_read_b64_tr_b16 v[48:49], v15 offset:28672
    ds_read_b64_tr_b16 v[50:51], v15 offset:30720
    s_add_u32 s41, s41, 7168
    buffer_load_dwordx4 v8, s[4:7], s41 offen offset:3072 nt lds
    v_fma_f32 v181, v181, s44, -v20
    v_cvt_pk_bf16_f32 v177, v178, v179
    v_exp_f32 v180, v180
    v_exp_f32 v181, v181
    v_fma_f32 v182, v182, s44, -v20
    s_waitcnt lgkmcnt(10)
    v_mfma_f32_32x32x16_bf16 v[144:159], v[60:63], v[168:171], v[144:159]
    ds_read_b64_tr_b16 v[52:53], v15 offset:28928
    ds_read_b64_tr_b16 v[54:55], v15 offset:30976
    v_fma_f32 v183, v183, s44, -v20
    v_exp_f32 v182, v182
    v_exp_f32 v183, v183
    v_cvt_pk_bf16_f32 v178, v180, v181
    v_cvt_pk_bf16_f32 v179, v182, v183
    s_nop 1
    v_mfma_f32_16x16x32_bf16 v[24:27], v[28:31], v[176:179], v[24:27]
    s_waitcnt lgkmcnt(10)
    v_mfma_f32_32x32x16_bf16 v[96:111], v[32:35], v[176:179], v[96:111]
    ds_read_b64_tr_b16 v[56:57], v15 offset:29184
    ds_read_b64_tr_b16 v[58:59], v15 offset:31232
    v_fma_f32 v184, v184, s44, -v20
    v_fma_f32 v185, v185, s44, -v20
    v_exp_f32 v184, v184
    v_exp_f32 v185, v185
    v_fma_f32 v186, v186, s44, -v20
    s_waitcnt lgkmcnt(10)
    v_mfma_f32_32x32x16_bf16 v[112:127], v[36:39], v[176:179], v[112:127]
    ds_read_b64_tr_b16 v[60:61], v15 offset:29440
    ds_read_b64_tr_b16 v[62:63], v15 offset:31488
    v_fma_f32 v187, v187, s44, -v20
    v_cvt_pk_bf16_f32 v184, v184, v185
    v_exp_f32 v186, v186
    v_exp_f32 v187, v187
    v_fma_f32 v188, v188, s44, -v20
    s_waitcnt lgkmcnt(10)
    v_mfma_f32_32x32x16_bf16 v[128:143], v[40:43], v[176:179], v[128:143]
    v_fma_f32 v189, v189, s44, -v20
    v_cvt_pk_bf16_f32 v185, v186, v187
    v_exp_f32 v188, v188
    v_exp_f32 v189, v189
    v_fma_f32 v190, v190, s44, -v20
    s_waitcnt lgkmcnt(8)
    v_mfma_f32_32x32x16_bf16 v[144:159], v[44:47], v[176:179], v[144:159]
    v_fma_f32 v191, v191, s44, -v20
    v_exp_f32 v190, v190
    v_exp_f32 v191, v191
    v_cvt_pk_bf16_f32 v186, v188, v189
    v_cvt_pk_bf16_f32 v187, v190, v191
    s_nop 1
    v_mfma_f32_16x16x32_bf16 v[24:27], v[28:31], v[184:187], v[24:27]
    s_waitcnt lgkmcnt(6)
    v_mfma_f32_32x32x16_bf16 v[96:111], v[48:51], v[184:187], v[96:111]
    v_fma_f32 v192, v192, s44, -v20
    v_fma_f32 v193, v193, s44, -v20
    v_exp_f32 v192, v192
    v_exp_f32 v193, v193
    v_fma_f32 v194, v194, s44, -v20
    s_waitcnt lgkmcnt(4)
    v_mfma_f32_32x32x16_bf16 v[112:127], v[52:55], v[184:187], v[112:127]
    v_fma_f32 v195, v195, s44, -v20
    v_cvt_pk_bf16_f32 v192, v192, v193
    v_exp_f32 v194, v194
    v_exp_f32 v195, v195
    v_fma_f32 v196, v196, s44, -v20
    s_waitcnt lgkmcnt(2)
    v_mfma_f32_32x32x16_bf16 v[128:143], v[56:59], v[184:187], v[128:143]
    v_fma_f32 v197, v197, s44, -v20
    v_cvt_pk_bf16_f32 v193, v194, v195
    v_exp_f32 v196, v196
    v_exp_f32 v197, v197
    v_fma_f32 v198, v198, s44, -v20
    s_waitcnt lgkmcnt(0)
    v_mfma_f32_32x32x16_bf16 v[144:159], v[60:63], v[184:187], v[144:159]
    v_fma_f32 v199, v199, s44, -v20
    v_exp_f32 v198, v198
    v_exp_f32 v199, v199
    v_cvt_pk_bf16_f32 v194, v196, v197
    v_cvt_pk_bf16_f32 v195, v198, v199
    s_waitcnt vmcnt(8)
    s_barrier
    ds_read_b64_tr_b16 v[32:33], v16 offset:49152
    ds_read_b64_tr_b16 v[34:35], v16 offset:51200
    ds_read_b64_tr_b16 v[36:37], v16 offset:49408
    ds_read_b64_tr_b16 v[38:39], v16 offset:51456
    ds_read_b64_tr_b16 v[40:41], v16 offset:49664
    ds_read_b64_tr_b16 v[42:43], v16 offset:51712
    ds_read_b64_tr_b16 v[44:45], v16 offset:49920
    ds_read_b64_tr_b16 v[46:47], v16 offset:51968
    ds_read_b64_tr_b16 v[48:49], v16 offset:53248
    ds_read_b64_tr_b16 v[50:51], v16 offset:55296
    ds_read_b64_tr_b16 v[52:53], v16 offset:53504
    ds_read_b64_tr_b16 v[54:55], v16 offset:55552
    v_mfma_f32_16x16x32_bf16 v[24:27], v[28:31], v[192:195], v[24:27]
    s_waitcnt lgkmcnt(10)
    v_mfma_f32_32x32x16_bf16 v[96:111], v[32:35], v[192:195], v[96:111]
    ds_read_b64_tr_b16 v[56:57], v16 offset:53760
    ds_read_b64_tr_b16 v[58:59], v16 offset:55808
    s_add_u32 m0, s69, 32768
    s_xor_b32 s41, s71, 6144
    buffer_load_dwordx4 v5, s[8:11], s41 offen offset:0 nt lds
    v_fma_f32 v200, v200, s44, -v20
    v_fma_f32 v201, v201, s44, -v20
    v_exp_f32 v200, v200
    v_exp_f32 v201, v201
    v_fma_f32 v202, v202, s44, -v20
    s_waitcnt lgkmcnt(10)
    v_mfma_f32_32x32x16_bf16 v[112:127], v[36:39], v[192:195], v[112:127]
    ds_read_b64_tr_b16 v[60:61], v16 offset:54016
    ds_read_b64_tr_b16 v[62:63], v16 offset:56064
    v_fma_f32 v203, v203, s44, -v20
    v_cvt_pk_bf16_f32 v200, v200, v201
    v_exp_f32 v202, v202
    v_exp_f32 v203, v203
    v_fma_f32 v204, v204, s44, -v20
    s_waitcnt lgkmcnt(10)
    v_mfma_f32_32x32x16_bf16 v[128:143], v[40:43], v[192:195], v[128:143]
    ds_read_b64_tr_b16 v[32:33], v16 offset:57344
    ds_read_b64_tr_b16 v[34:35], v16 offset:59392
    s_add_u32 s41, s41, 7168
    buffer_load_dwordx4 v5, s[8:11], s41 offen offset:1024 nt lds
    v_fma_f32 v205, v205, s44, -v20
    v_cvt_pk_bf16_f32 v201, v202, v203
    v_exp_f32 v204, v204
    v_exp_f32 v205, v205
    v_fma_f32 v206, v206, s44, -v20
    s_waitcnt lgkmcnt(10)
    v_mfma_f32_32x32x16_bf16 v[144:159], v[44:47], v[192:195], v[144:159]
    ds_read_b64_tr_b16 v[36:37], v16 offset:57600
    ds_read_b64_tr_b16 v[38:39], v16 offset:59648
    v_fma_f32 v207, v207, s44, -v20
    v_exp_f32 v206, v206
    v_exp_f32 v207, v207
    v_cvt_pk_bf16_f32 v202, v204, v205
    v_cvt_pk_bf16_f32 v203, v206, v207
    s_nop 1
    v_mfma_f32_16x16x32_bf16 v[24:27], v[28:31], v[200:203], v[24:27]
    s_waitcnt lgkmcnt(10)
    v_mfma_f32_32x32x16_bf16 v[96:111], v[48:51], v[200:203], v[96:111]
    ds_read_b64_tr_b16 v[40:41], v16 offset:57856
    ds_read_b64_tr_b16 v[42:43], v16 offset:59904
    s_add_u32 s41, s41, 7168
    buffer_load_dwordx4 v5, s[8:11], s41 offen offset:2048 nt lds
    v_fma_f32 v208, v208, s44, -v20
    v_fma_f32 v209, v209, s44, -v20
    v_exp_f32 v208, v208
    v_exp_f32 v209, v209
    v_fma_f32 v210, v210, s44, -v20
    s_waitcnt lgkmcnt(10)
    v_mfma_f32_32x32x16_bf16 v[112:127], v[52:55], v[200:203], v[112:127]
    ds_read_b64_tr_b16 v[44:45], v16 offset:58112
    ds_read_b64_tr_b16 v[46:47], v16 offset:60160
    v_fma_f32 v211, v211, s44, -v20
    v_cvt_pk_bf16_f32 v208, v208, v209
    v_exp_f32 v210, v210
    v_exp_f32 v211, v211
    v_fma_f32 v212, v212, s44, -v20
    s_waitcnt lgkmcnt(10)
    v_mfma_f32_32x32x16_bf16 v[128:143], v[56:59], v[200:203], v[128:143]
    ds_read_b64_tr_b16 v[48:49], v16 offset:61440
    ds_read_b64_tr_b16 v[50:51], v16 offset:63488
    s_add_u32 s41, s41, 7168
    buffer_load_dwordx4 v5, s[8:11], s41 offen offset:3072 nt lds
    v_fma_f32 v213, v213, s44, -v20
    v_cvt_pk_bf16_f32 v209, v210, v211
    v_exp_f32 v212, v212
    v_exp_f32 v213, v213
    v_fma_f32 v214, v214, s44, -v20
    s_waitcnt lgkmcnt(10)
    v_mfma_f32_32x32x16_bf16 v[144:159], v[60:63], v[200:203], v[144:159]
    ds_read_b64_tr_b16 v[52:53], v16 offset:61696
    ds_read_b64_tr_b16 v[54:55], v16 offset:63744
    v_fma_f32 v215, v215, s44, -v20
    v_exp_f32 v214, v214
    v_exp_f32 v215, v215
    v_cvt_pk_bf16_f32 v210, v212, v213
    v_cvt_pk_bf16_f32 v211, v214, v215
    s_nop 1
    v_mfma_f32_16x16x32_bf16 v[24:27], v[28:31], v[208:211], v[24:27]
    s_waitcnt lgkmcnt(10)
    v_mfma_f32_32x32x16_bf16 v[96:111], v[32:35], v[208:211], v[96:111]
    ds_read_b64_tr_b16 v[56:57], v16 offset:61952
    ds_read_b64_tr_b16 v[58:59], v16 offset:64000
    v_fma_f32 v216, v216, s44, -v20
    v_fma_f32 v217, v217, s44, -v20
    v_exp_f32 v216, v216
    v_exp_f32 v217, v217
    v_fma_f32 v218, v218, s44, -v20
    s_waitcnt lgkmcnt(10)
    v_mfma_f32_32x32x16_bf16 v[112:127], v[36:39], v[208:211], v[112:127]
    ds_read_b64_tr_b16 v[60:61], v16 offset:62208
    ds_read_b64_tr_b16 v[62:63], v16 offset:64256
    v_fma_f32 v219, v219, s44, -v20
    v_cvt_pk_bf16_f32 v216, v216, v217
    v_exp_f32 v218, v218
    v_exp_f32 v219, v219
    v_fma_f32 v220, v220, s44, -v20
    s_waitcnt lgkmcnt(10)
    v_mfma_f32_32x32x16_bf16 v[128:143], v[40:43], v[208:211], v[128:143]
    v_fma_f32 v221, v221, s44, -v20
    v_cvt_pk_bf16_f32 v217, v218, v219
    v_exp_f32 v220, v220
    v_exp_f32 v221, v221
    v_fma_f32 v222, v222, s44, -v20
    s_waitcnt lgkmcnt(8)
    v_mfma_f32_32x32x16_bf16 v[144:159], v[44:47], v[208:211], v[144:159]
    v_fma_f32 v223, v223, s44, -v20
    v_exp_f32 v222, v222
    v_exp_f32 v223, v223
    v_cvt_pk_bf16_f32 v218, v220, v221
    v_cvt_pk_bf16_f32 v219, v222, v223
    s_nop 1
    v_mfma_f32_16x16x32_bf16 v[24:27], v[28:31], v[216:219], v[24:27]
    s_waitcnt lgkmcnt(6)
    v_mfma_f32_32x32x16_bf16 v[96:111], v[48:51], v[216:219], v[96:111]
    s_waitcnt lgkmcnt(4)
    v_mfma_f32_32x32x16_bf16 v[112:127], v[52:55], v[216:219], v[112:127]
    s_waitcnt lgkmcnt(2)
    v_mfma_f32_32x32x16_bf16 v[128:143], v[56:59], v[216:219], v[128:143]
    s_waitcnt lgkmcnt(0)
    v_mfma_f32_32x32x16_bf16 v[144:159], v[60:63], v[216:219], v[144:159]
    s_waitcnt vmcnt(8)
    s_barrier
    ds_read_b128 v[32:35], v13 offset:0
    ds_read_b128 v[36:39], v14 offset:0
    ds_read_b128 v[40:43], v13 offset:256
    ds_read_b128 v[44:47], v14 offset:256
    ds_read_b128 v[48:51], v13 offset:512
    ds_read_b128 v[52:55], v14 offset:512
    s_waitcnt lgkmcnt(5)
    v_mfma_f32_32x32x16_bf16 v[160:175], v[32:35], v[64:67], 0
    ds_read_b128 v[56:59], v13 offset:768
    s_add_u32 m0, s69, 114688
    s_xor_b32 s41, s71, 7168
    buffer_load_dwordx4 v5, s[8:11], s41 offen offset:0 nt lds
    s_waitcnt lgkmcnt(5)
    v_mfma_f32_32x32x16_bf16 v[160:175], v[36:39], v[68:71], v[160:175]
    ds_read_b128 v[60:63], v14 offset:768
    s_waitcnt lgkmcnt(5)
    v_mfma_f32_32x32x16_bf16 v[160:175], v[40:43], v[72:75], v[160:175]
    ds_read_b128 v[32:35], v13 offset:8192
    s_add_u32 s41, s41, 7168
    buffer_load_dwordx4 v5, s[8:11], s41 offen offset:1024 nt lds
    s_waitcnt lgkmcnt(5)
    v_mfma_f32_32x32x16_bf16 v[160:175], v[44:47], v[76:79], v[160:175]
    ds_read_b128 v[36:39], v14 offset:8192
    s_waitcnt lgkmcnt(5)
    v_mfma_f32_32x32x16_bf16 v[160:175], v[48:51], v[80:83], v[160:175]
    ds_read_b128 v[40:43], v13 offset:8448
    s_add_u32 s41, s41, 7168
    buffer_load_dwordx4 v5, s[8:11], s41 offen offset:2048 nt lds
    s_waitcnt lgkmcnt(5)
    v_mfma_f32_32x32x16_bf16 v[160:175], v[52:55], v[84:87], v[160:175]
    ds_read_b128 v[44:47], v14 offset:8448
    s_waitcnt lgkmcnt(5)
    v_mfma_f32_32x32x16_bf16 v[160:175], v[56:59], v[88:91], v[160:175]
    ds_read_b128 v[48:51], v13 offset:8704
    s_add_u32 s41, s41, 7168
    buffer_load_dwordx4 v5, s[8:11], s41 offen offset:3072 nt lds
    s_waitcnt lgkmcnt(5)
    v_mfma_f32_32x32x16_bf16 v[160:175], v[60:63], v[92:95], v[160:175]
    ds_read_b128 v[52:55], v14 offset:8704
    s_waitcnt lgkmcnt(5)
    v_mfma_f32_32x32x16_bf16 v[176:191], v[32:35], v[64:67], 0
    ds_read_b128 v[56:59], v13 offset:8960
    s_waitcnt lgkmcnt(5)
    v_mfma_f32_32x32x16_bf16 v[176:191], v[36:39], v[68:71], v[176:191]
    ds_read_b128 v[60:63], v14 offset:8960
    s_waitcnt lgkmcnt(5)
    v_mfma_f32_32x32x16_bf16 v[176:191], v[40:43], v[72:75], v[176:191]
    s_nop 2
    v_max3_f32 v19, v160, v161, v18
    s_waitcnt lgkmcnt(4)
    v_mfma_f32_32x32x16_bf16 v[176:191], v[44:47], v[76:79], v[176:191]
    v_max3_f32 v19, v162, v163, v19
    s_waitcnt lgkmcnt(3)
    v_mfma_f32_32x32x16_bf16 v[176:191], v[48:51], v[80:83], v[176:191]
    v_max3_f32 v19, v164, v165, v19
    v_max3_f32 v19, v166, v167, v19
    s_waitcnt lgkmcnt(2)
    v_mfma_f32_32x32x16_bf16 v[176:191], v[52:55], v[84:87], v[176:191]
    v_max3_f32 v19, v168, v169, v19
    s_waitcnt lgkmcnt(1)
    v_mfma_f32_32x32x16_bf16 v[176:191], v[56:59], v[88:91], v[176:191]
    v_max3_f32 v19, v170, v171, v19
    s_waitcnt lgkmcnt(0)
    v_mfma_f32_32x32x16_bf16 v[176:191], v[60:63], v[92:95], v[176:191]
    v_max3_f32 v19, v172, v173, v19
    v_max3_f32 v19, v174, v175, v19
    s_waitcnt vmcnt(8)
    s_barrier
    ds_read_b128 v[32:35], v9 offset:0
    ds_read_b128 v[36:39], v10 offset:0
    ds_read_b128 v[40:43], v9 offset:256
    ds_read_b128 v[44:47], v10 offset:256
    ds_read_b128 v[48:51], v9 offset:512
    ds_read_b128 v[52:55], v10 offset:512
    s_waitcnt lgkmcnt(5)
    v_mfma_f32_32x32x16_bf16 v[192:207], v[32:35], v[64:67], 0
    ds_read_b128 v[56:59], v9 offset:768
    s_waitcnt lgkmcnt(5)
    v_mfma_f32_32x32x16_bf16 v[192:207], v[36:39], v[68:71], v[192:207]
    ds_read_b128 v[60:63], v10 offset:768
    v_max3_f32 v19, v176, v177, v19
    s_waitcnt lgkmcnt(5)
    v_mfma_f32_32x32x16_bf16 v[192:207], v[40:43], v[72:75], v[192:207]
    ds_read_b128 v[32:35], v9 offset:8192
    v_max3_f32 v19, v178, v179, v19
    s_waitcnt lgkmcnt(5)
    v_mfma_f32_32x32x16_bf16 v[192:207], v[44:47], v[76:79], v[192:207]
    ds_read_b128 v[36:39], v10 offset:8192
    v_max3_f32 v19, v180, v181, v19
    s_waitcnt lgkmcnt(5)
    v_mfma_f32_32x32x16_bf16 v[192:207], v[48:51], v[80:83], v[192:207]
    ds_read_b128 v[40:43], v9 offset:8448
    v_max3_f32 v19, v182, v183, v19
    s_waitcnt lgkmcnt(5)
    v_mfma_f32_32x32x16_bf16 v[192:207], v[52:55], v[84:87], v[192:207]
    ds_read_b128 v[44:47], v10 offset:8448
    s_waitcnt lgkmcnt(5)
    v_mfma_f32_32x32x16_bf16 v[192:207], v[56:59], v[88:91], v[192:207]
    ds_read_b128 v[48:51], v9 offset:8704
    v_max3_f32 v19, v184, v185, v19
    s_waitcnt lgkmcnt(5)
    v_mfma_f32_32x32x16_bf16 v[192:207], v[60:63], v[92:95], v[192:207]
    ds_read_b128 v[52:55], v10 offset:8704
    v_max3_f32 v19, v186, v187, v19
    s_waitcnt lgkmcnt(5)
    v_mfma_f32_32x32x16_bf16 v[208:223], v[32:35], v[64:67], 0
    ds_read_b128 v[56:59], v9 offset:8960
    v_max3_f32 v19, v188, v189, v19
    s_waitcnt lgkmcnt(5)
    v_mfma_f32_32x32x16_bf16 v[208:223], v[36:39], v[68:71], v[208:223]
    ds_read_b128 v[60:63], v10 offset:8960
    v_max3_f32 v19, v190, v191, v19
    s_waitcnt lgkmcnt(5)
    v_mfma_f32_32x32x16_bf16 v[208:223], v[40:43], v[72:75], v[208:223]
    v_max3_f32 v19, v192, v193, v19
    s_waitcnt lgkmcnt(4)
    v_mfma_f32_32x32x16_bf16 v[208:223], v[44:47], v[76:79], v[208:223]
    v_max3_f32 v19, v194, v195, v19
    s_waitcnt lgkmcnt(3)
    v_mfma_f32_32x32x16_bf16 v[208:223], v[48:51], v[80:83], v[208:223]
    v_max3_f32 v19, v196, v197, v19
    v_max3_f32 v19, v198, v199, v19
    s_waitcnt lgkmcnt(2)
    v_mfma_f32_32x32x16_bf16 v[208:223], v[52:55], v[84:87], v[208:223]
    v_max3_f32 v19, v200, v201, v19
    s_waitcnt lgkmcnt(1)
    v_mfma_f32_32x32x16_bf16 v[208:223], v[56:59], v[88:91], v[208:223]
    v_max3_f32 v19, v202, v203, v19
    s_waitcnt lgkmcnt(0)
    v_mfma_f32_32x32x16_bf16 v[208:223], v[60:63], v[92:95], v[208:223]
    v_max3_f32 v19, v204, v205, v19
    v_max3_f32 v19, v206, v207, v19
    s_nop 7
    s_nop 1
    v_max3_f32 v19, v208, v209, v19
    v_max3_f32 v19, v210, v211, v19
    v_max3_f32 v19, v212, v213, v19
    v_max3_f32 v19, v214, v215, v19
    v_max3_f32 v19, v216, v217, v19
    v_max3_f32 v19, v218, v219, v19
    v_max3_f32 v19, v220, v221, v19
    v_max3_f32 v19, v222, v223, v19
    v_mov_b32 v22, v19
    s_nop 1
    v_permlane32_swap_b32 v19, v22
    v_max_f32 v19, v19, v22
    v_mul_f32 v20, s44, v19
    v_fma_f32 v2, v18, s44, -v20
    v_exp_f32 v2, v2
    v_mov_b32 v18, v19
    v_fma_f32 v160, v160, s44, -v20
    v_fma_f32 v161, v161, s44, -v20
    v_exp_f32 v160, v160
    v_exp_f32 v161, v161
    v_fma_f32 v162, v162, s44, -v20
    v_fma_f32 v163, v163, s44, -v20
    v_cvt_pk_bf16_f32 v160, v160, v161
    v_exp_f32 v162, v162
    v_exp_f32 v163, v163
    v_fma_f32 v164, v164, s44, -v20
    v_fma_f32 v165, v165, s44, -v20
    v_cvt_pk_bf16_f32 v161, v162, v163
    v_exp_f32 v164, v164
    v_exp_f32 v165, v165
    v_fma_f32 v166, v166, s44, -v20
    v_fma_f32 v167, v167, s44, -v20
    v_exp_f32 v166, v166
    v_exp_f32 v167, v167
    v_cvt_pk_bf16_f32 v162, v164, v165
    v_cvt_pk_bf16_f32 v163, v166, v167
    v_mul_f32 v24, v24, v2
    v_mul_f32 v96, v96, v2
    v_mul_f32 v97, v97, v2
    v_mul_f32 v98, v98, v2
    v_mul_f32 v99, v99, v2
    v_mul_f32 v100, v100, v2
    v_mul_f32 v101, v101, v2
    v_mul_f32 v102, v102, v2
    v_mul_f32 v103, v103, v2
    v_mul_f32 v104, v104, v2
    v_mul_f32 v105, v105, v2
    v_mul_f32 v106, v106, v2
    v_mul_f32 v107, v107, v2
    v_mul_f32 v108, v108, v2
    v_mul_f32 v109, v109, v2
    v_mul_f32 v110, v110, v2
    v_mul_f32 v111, v111, v2
    s_waitcnt vmcnt(4)
    s_barrier
    ds_read_b64_tr_b16 v[32:33], v15 offset:32768
    ds_read_b64_tr_b16 v[34:35], v15 offset:34816
    ds_read_b64_tr_b16 v[36:37], v15 offset:33024
    ds_read_b64_tr_b16 v[38:39], v15 offset:35072
    ds_read_b64_tr_b16 v[40:41], v15 offset:33280
    ds_read_b64_tr_b16 v[42:43], v15 offset:35328
    ds_read_b64_tr_b16 v[44:45], v15 offset:33536
    ds_read_b64_tr_b16 v[46:47], v15 offset:35584
    ds_read_b64_tr_b16 v[48:49], v15 offset:36864
    ds_read_b64_tr_b16 v[50:51], v15 offset:38912
    ds_read_b64_tr_b16 v[52:53], v15 offset:37120
    ds_read_b64_tr_b16 v[54:55], v15 offset:39168
    v_mfma_f32_16x16x32_bf16 v[24:27], v[28:31], v[160:163], v[24:27]
    s_waitcnt lgkmcnt(10)
    v_mfma_f32_32x32x16_bf16 v[96:111], v[32:35], v[160:163], v[96:111]
    ds_read_b64_tr_b16 v[56:57], v15 offset:37376
    ds_read_b64_tr_b16 v[58:59], v15 offset:39424
    v_fma_f32 v168, v168, s44, -v20
    v_fma_f32 v169, v169, s44, -v20
    v_exp_f32 v168, v168
    v_exp_f32 v169, v169
    v_fma_f32 v170, v170, s44, -v20
    v_fma_f32 v171, v171, s44, -v20
    v_cvt_pk_bf16_f32 v168, v168, v169
    v_exp_f32 v170, v170
    v_exp_f32 v171, v171
    v_fma_f32 v172, v172, s44, -v20
    v_mul_f32 v112, v112, v2
    v_mul_f32 v113, v113, v2
    v_mul_f32 v114, v114, v2
    v_mul_f32 v115, v115, v2
    v_mul_f32 v116, v116, v2
    v_mul_f32 v117, v117, v2
    v_mul_f32 v118, v118, v2
    v_mul_f32 v119, v119, v2
    v_mul_f32 v120, v120, v2
    v_mul_f32 v121, v121, v2
    v_mul_f32 v122, v122, v2
    v_mul_f32 v123, v123, v2
    v_mul_f32 v124, v124, v2
    v_mul_f32 v125, v125, v2
    v_mul_f32 v126, v126, v2
    v_mul_f32 v127, v127, v2
    s_waitcnt lgkmcnt(10)
    s_nop 0
    v_mfma_f32_32x32x16_bf16 v[112:127], v[36:39], v[160:163], v[112:127]
    ds_read_b64_tr_b16 v[60:61], v15 offset:37632
    ds_read_b64_tr_b16 v[62:63], v15 offset:39680
    v_fma_f32 v173, v173, s44, -v20
    v_cvt_pk_bf16_f32 v169, v170, v171
    v_exp_f32 v172, v172
    v_exp_f32 v173, v173
    v_fma_f32 v174, v174, s44, -v20
    v_fma_f32 v175, v175, s44, -v20
    v_exp_f32 v174, v174
    v_exp_f32 v175, v175
    v_cvt_pk_bf16_f32 v170, v172, v173
    v_cvt_pk_bf16_f32 v171, v174, v175
    v_mul_f32 v128, v128, v2
    v_mul_f32 v129, v129, v2
    v_mul_f32 v130, v130, v2
    v_mul_f32 v131, v131, v2
    v_mul_f32 v132, v132, v2
    v_mul_f32 v133, v133, v2
    v_mul_f32 v134, v134, v2
    v_mul_f32 v135, v135, v2
    v_mul_f32 v136, v136, v2
    v_mul_f32 v137, v137, v2
    v_mul_f32 v138, v138, v2
    v_mul_f32 v139, v139, v2
    v_mul_f32 v140, v140, v2
    v_mul_f32 v141, v141, v2
    v_mul_f32 v142, v142, v2
    v_mul_f32 v143, v143, v2
    s_waitcnt lgkmcnt(10)
    s_nop 0
    v_mfma_f32_32x32x16_bf16 v[128:143], v[40:43], v[160:163], v[128:143]
    ds_read_b64_tr_b16 v[32:33], v15 offset:40960
    ds_read_b64_tr_b16 v[34:35], v15 offset:43008
    v_fma_f32 v176, v176, s44, -v20
    v_fma_f32 v177, v177, s44, -v20
    v_exp_f32 v176, v176
    v_exp_f32 v177, v177
    v_fma_f32 v178, v178, s44, -v20
    v_fma_f32 v179, v179, s44, -v20
    v_cvt_pk_bf16_f32 v176, v176, v177
    v_exp_f32 v178, v178
    v_exp_f32 v179, v179
    v_fma_f32 v180, v180, s44, -v20
    v_mul_f32 v144, v144, v2
    v_mul_f32 v145, v145, v2
    v_mul_f32 v146, v146, v2
    v_mul_f32 v147, v147, v2
    v_mul_f32 v148, v148, v2
    v_mul_f32 v149, v149, v2
    v_mul_f32 v150, v150, v2
    v_mul_f32 v151, v151, v2
    v_mul_f32 v152, v152, v2
    v_mul_f32 v153, v153, v2
    v_mul_f32 v154, v154, v2
    v_mul_f32 v155, v155, v2
    v_mul_f32 v156, v156, v2
    v_mul_f32 v157, v157, v2
    v_mul_f32 v158, v158, v2
    v_mul_f32 v159, v159, v2
    s_waitcnt lgkmcnt(10)
    s_nop 0
    v_mfma_f32_32x32x16_bf16 v[144:159], v[44:47], v[160:163], v[144:159]
    ds_read_b64_tr_b16 v[36:37], v15 offset:41216
    ds_read_b64_tr_b16 v[38:39], v15 offset:43264
    v_fma_f32 v181, v181, s44, -v20
    v_cvt_pk_bf16_f32 v177, v178, v179
    v_exp_f32 v180, v180
    v_exp_f32 v181, v181
    v_fma_f32 v182, v182, s44, -v20
    v_fma_f32 v183, v183, s44, -v20
    v_exp_f32 v182, v182
    v_exp_f32 v183, v183
    v_cvt_pk_bf16_f32 v178, v180, v181
    v_cvt_pk_bf16_f32 v179, v182, v183
    v_mfma_f32_16x16x32_bf16 v[24:27], v[28:31], v[168:171], v[24:27]
    s_waitcnt lgkmcnt(10)
    v_mfma_f32_32x32x16_bf16 v[96:111], v[48:51], v[168:171], v[96:111]
    ds_read_b64_tr_b16 v[40:41], v15 offset:41472
    ds_read_b64_tr_b16 v[42:43], v15 offset:43520
    v_fma_f32 v184, v184, s44, -v20
    v_fma_f32 v185, v185, s44, -v20
    v_exp_f32 v184, v184
    v_exp_f32 v185, v185
    v_fma_f32 v186, v186, s44, -v20
    v_fma_f32 v187, v187, s44, -v20
    v_cvt_pk_bf16_f32 v184, v184, v185
    v_exp_f32 v186, v186
    v_exp_f32 v187, v187
    v_fma_f32 v188, v188, s44, -v20
    s_waitcnt lgkmcnt(10)
    v_mfma_f32_32x32x16_bf16 v[112:127], v[52:55], v[168:171], v[112:127]
    ds_read_b64_tr_b16 v[44:45], v15 offset:41728
    ds_read_b64_tr_b16 v[46:47], v15 offset:43776
    v_fma_f32 v189, v189, s44, -v20
    v_cvt_pk_bf16_f32 v185, v186, v187
    v_exp_f32 v188, v188
    v_exp_f32 v189, v189
    v_fma_f32 v190, v190, s44, -v20
    v_fma_f32 v191, v191, s44, -v20
    v_exp_f32 v190, v190
    v_exp_f32 v191, v191
    v_cvt_pk_bf16_f32 v186, v188, v189
    v_cvt_pk_bf16_f32 v187, v190, v191
    s_waitcnt lgkmcnt(10)
    v_mfma_f32_32x32x16_bf16 v[128:143], v[56:59], v[168:171], v[128:143]
    ds_read_b64_tr_b16 v[48:49], v15 offset:45056
    ds_read_b64_tr_b16 v[50:51], v15 offset:47104
    v_fma_f32 v192, v192, s44, -v20
    v_fma_f32 v193, v193, s44, -v20
    v_exp_f32 v192, v192
    v_exp_f32 v193, v193
    v_fma_f32 v194, v194, s44, -v20
    v_fma_f32 v195, v195, s44, -v20
    v_cvt_pk_bf16_f32 v192, v192, v193
    v_exp_f32 v194, v194
    v_exp_f32 v195, v195
    v_fma_f32 v196, v196, s44, -v20
    s_waitcnt lgkmcnt(10)
    v_mfma_f32_32x32x16_bf16 v[144:159], v[60:63], v[168:171], v[144:159]
    ds_read_b64_tr_b16 v[52:53], v15 offset:45312
    ds_read_b64_tr_b16 v[54:55], v15 offset:47360
    v_fma_f32 v197, v197, s44, -v20
    v_cvt_pk_bf16_f32 v193, v194, v195
    v_exp_f32 v196, v196
    v_exp_f32 v197, v197
    v_fma_f32 v198, v198, s44, -v20
    v_fma_f32 v199, v199, s44, -v20
    v_exp_f32 v198, v198
    v_exp_f32 v199, v199
    v_cvt_pk_bf16_f32 v194, v196, v197
    v_cvt_pk_bf16_f32 v195, v198, v199
    v_mfma_f32_16x16x32_bf16 v[24:27], v[28:31], v[176:179], v[24:27]
    s_waitcnt lgkmcnt(10)
    v_mfma_f32_32x32x16_bf16 v[96:111], v[32:35], v[176:179], v[96:111]
    ds_read_b64_tr_b16 v[56:57], v15 offset:45568
    ds_read_b64_tr_b16 v[58:59], v15 offset:47616
    v_fma_f32 v200, v200, s44, -v20
    v_fma_f32 v201, v201, s44, -v20
    v_exp_f32 v200, v200
    v_exp_f32 v201, v201
    v_fma_f32 v202, v202, s44, -v20
    v_fma_f32 v203, v203, s44, -v20
    v_cvt_pk_bf16_f32 v200, v200, v201
    v_exp_f32 v202, v202
    v_exp_f32 v203, v203
    v_fma_f32 v204, v204, s44, -v20
    s_waitcnt lgkmcnt(10)
    v_mfma_f32_32x32x16_bf16 v[112:127], v[36:39], v[176:179], v[112:127]
    ds_read_b64_tr_b16 v[60:61], v15 offset:45824
    ds_read_b64_tr_b16 v[62:63], v15 offset:47872
    v_fma_f32 v205, v205, s44, -v20
    v_cvt_pk_bf16_f32 v201, v202, v203
    v_exp_f32 v204, v204
    v_exp_f32 v205, v205
    v_fma_f32 v206, v206, s44, -v20
    v_fma_f32 v207, v207, s44, -v20
    v_exp_f32 v206, v206
    v_exp_f32 v207, v207
    v_cvt_pk_bf16_f32 v202, v204, v205
    v_cvt_pk_bf16_f32 v203, v206, v207
    s_waitcnt lgkmcnt(10)
    v_mfma_f32_32x32x16_bf16 v[128:143], v[40:43], v[176:179], v[128:143]
    v_fma_f32 v208, v208, s44, -v20
    v_fma_f32 v209, v209, s44, -v20
    v_exp_f32 v208, v208
    v_exp_f32 v209, v209
    v_fma_f32 v210, v210, s44, -v20
    v_fma_f32 v211, v211, s44, -v20
    v_cvt_pk_bf16_f32 v208, v208, v209
    v_exp_f32 v210, v210
    v_exp_f32 v211, v211
    v_fma_f32 v212, v212, s44, -v20
    s_waitcnt lgkmcnt(8)
    v_mfma_f32_32x32x16_bf16 v[144:159], v[44:47], v[176:179], v[144:159]
    v_fma_f32 v213, v213, s44, -v20
    v_cvt_pk_bf16_f32 v209, v210, v211
    v_exp_f32 v212, v212
    v_exp_f32 v213, v213
    v_fma_f32 v214, v214, s44, -v20
    v_fma_f32 v215, v215, s44, -v20
    v_exp_f32 v214, v214
    v_exp_f32 v215, v215
    v_cvt_pk_bf16_f32 v210, v212, v213
    v_cvt_pk_bf16_f32 v211, v214, v215
    v_mfma_f32_16x16x32_bf16 v[24:27], v[28:31], v[184:187], v[24:27]
    s_waitcnt lgkmcnt(6)
    v_mfma_f32_32x32x16_bf16 v[96:111], v[48:51], v[184:187], v[96:111]
    v_fma_f32 v216, v216, s44, -v20
    v_fma_f32 v217, v217, s44, -v20
    v_exp_f32 v216, v216
    v_exp_f32 v217, v217
    v_fma_f32 v218, v218, s44, -v20
    s_waitcnt lgkmcnt(4)
    v_mfma_f32_32x32x16_bf16 v[112:127], v[52:55], v[184:187], v[112:127]
    v_fma_f32 v219, v219, s44, -v20
    v_cvt_pk_bf16_f32 v216, v216, v217
    v_exp_f32 v218, v218
    v_exp_f32 v219, v219
    v_fma_f32 v220, v220, s44, -v20
    s_waitcnt lgkmcnt(2)
    v_mfma_f32_32x32x16_bf16 v[128:143], v[56:59], v[184:187], v[128:143]
    v_fma_f32 v221, v221, s44, -v20
    v_cvt_pk_bf16_f32 v217, v218, v219
    v_exp_f32 v220, v220
    v_exp_f32 v221, v221
    v_fma_f32 v222, v222, s44, -v20
    s_waitcnt lgkmcnt(0)
    v_mfma_f32_32x32x16_bf16 v[144:159], v[60:63], v[184:187], v[144:159]
    v_fma_f32 v223, v223, s44, -v20
    v_exp_f32 v222, v222
    v_exp_f32 v223, v223
    v_cvt_pk_bf16_f32 v218, v220, v221
    v_cvt_pk_bf16_f32 v219, v222, v223
    s_waitcnt vmcnt(0)
    s_barrier
    ds_read_b64_tr_b16 v[32:33], v16 offset:49152
    ds_read_b64_tr_b16 v[34:35], v16 offset:51200
    ds_read_b64_tr_b16 v[36:37], v16 offset:53248
    ds_read_b64_tr_b16 v[38:39], v16 offset:55296
    ds_read_b64_tr_b16 v[40:41], v16 offset:57344
    ds_read_b64_tr_b16 v[42:43], v16 offset:59392
    ds_read_b64_tr_b16 v[44:45], v16 offset:61440
    ds_read_b64_tr_b16 v[46:47], v16 offset:63488
    ds_read_b64_tr_b16 v[48:49], v16 offset:49408
    ds_read_b64_tr_b16 v[50:51], v16 offset:51456
    ds_read_b64_tr_b16 v[52:53], v16 offset:53504
    ds_read_b64_tr_b16 v[54:55], v16 offset:55552
    v_mfma_f32_16x16x32_bf16 v[24:27], v[28:31], v[192:195], v[24:27]
    v_mfma_f32_16x16x32_bf16 v[24:27], v[28:31], v[200:203], v[24:27]
    v_mfma_f32_16x16x32_bf16 v[24:27], v[28:31], v[208:211], v[24:27]
    v_mfma_f32_16x16x32_bf16 v[24:27], v[28:31], v[216:219], v[24:27]
    s_waitcnt lgkmcnt(10)
    v_mfma_f32_32x32x16_bf16 v[96:111], v[32:35], v[192:195], v[96:111]
    ds_read_b64_tr_b16 v[56:57], v16 offset:57600
    ds_read_b64_tr_b16 v[58:59], v16 offset:59648
    s_waitcnt lgkmcnt(10)
    v_mfma_f32_32x32x16_bf16 v[96:111], v[36:39], v[200:203], v[96:111]
    ds_read_b64_tr_b16 v[60:61], v16 offset:61696
    ds_read_b64_tr_b16 v[62:63], v16 offset:63744
    s_waitcnt lgkmcnt(10)
    v_mfma_f32_32x32x16_bf16 v[96:111], v[40:43], v[208:211], v[96:111]
    ds_read_b64_tr_b16 v[32:33], v16 offset:49664
    ds_read_b64_tr_b16 v[34:35], v16 offset:51712
    v_rcp_f32 v2, v24
    s_cmp_lt_u32 s68, 2
    s_cselect_b32 s93, 0, 4
    s_and_b32 s74, s68, 1
    s_add_u32 s93, s93, s74
    s_lshl_b32 s93, s93, 13
    v_add_u32 v21, s93, v23
    s_waitcnt lgkmcnt(10)
    v_mfma_f32_32x32x16_bf16 v[96:111], v[44:47], v[216:219], v[96:111]
    ds_read_b64_tr_b16 v[36:37], v16 offset:53760
    ds_read_b64_tr_b16 v[38:39], v16 offset:55808
    s_waitcnt lgkmcnt(10)
    v_mfma_f32_32x32x16_bf16 v[112:127], v[48:51], v[192:195], v[112:127]
    ds_read_b64_tr_b16 v[40:41], v16 offset:57856
    ds_read_b64_tr_b16 v[42:43], v16 offset:59904
    s_waitcnt lgkmcnt(10)
    v_mfma_f32_32x32x16_bf16 v[112:127], v[52:55], v[200:203], v[112:127]
    ds_read_b64_tr_b16 v[44:45], v16 offset:61952
    ds_read_b64_tr_b16 v[46:47], v16 offset:64000
    s_nop 1
    v_mul_f32 v96, v96, v2
    v_mul_f32 v97, v97, v2
    v_mul_f32 v98, v98, v2
    v_mul_f32 v99, v99, v2
    v_mul_f32 v100, v100, v2
    v_mul_f32 v101, v101, v2
    v_mul_f32 v102, v102, v2
    v_mul_f32 v103, v103, v2
    v_mul_f32 v104, v104, v2
    v_mul_f32 v105, v105, v2
    s_waitcnt lgkmcnt(10)
    v_mfma_f32_32x32x16_bf16 v[112:127], v[56:59], v[208:211], v[112:127]
    ds_read_b64_tr_b16 v[48:49], v16 offset:49920
    ds_read_b64_tr_b16 v[50:51], v16 offset:51968
    v_mul_f32 v106, v106, v2
    v_mul_f32 v107, v107, v2
    v_mul_f32 v108, v108, v2
    v_mul_f32 v109, v109, v2
    v_mul_f32 v110, v110, v2
    v_mul_f32 v111, v111, v2
    v_cvt_pk_bf16_f32 v224, v96, v97
    v_cvt_pk_bf16_f32 v225, v98, v99
    v_cvt_pk_bf16_f32 v226, v100, v101
    v_cvt_pk_bf16_f32 v227, v102, v103
    v_cvt_pk_bf16_f32 v228, v104, v105
    s_waitcnt lgkmcnt(10)
    v_mfma_f32_32x32x16_bf16 v[112:127], v[60:63], v[216:219], v[112:127]
    ds_read_b64_tr_b16 v[52:53], v16 offset:54016
    ds_read_b64_tr_b16 v[54:55], v16 offset:56064
    v_cvt_pk_bf16_f32 v229, v106, v107
    v_cvt_pk_bf16_f32 v230, v108, v109
    v_cvt_pk_bf16_f32 v231, v110, v111
    v_permlane32_swap_b32 v224, v226
    v_permlane32_swap_b32 v225, v227
    v_permlane32_swap_b32 v228, v230
    v_permlane32_swap_b32 v229, v231
    s_mov_b64 exec, s[46:47]
    buffer_store_dwordx4 v[224:227], v23, s[20:23], s80 offen offset:0 sc1
    s_mov_b64 exec, -1
    s_mov_b64 exec, s[46:47]
    buffer_store_dwordx4 v[228:231], v23, s[20:23], s80 offen offset:1024 sc1
    s_mov_b64 exec, -1
    ds_write_b128 v21, v[224:227] offset:0
    ds_write_b128 v21, v[228:231] offset:1024
    s_waitcnt lgkmcnt(12)
    v_mfma_f32_32x32x16_bf16 v[128:143], v[32:35], v[192:195], v[128:143]
    ds_read_b64_tr_b16 v[56:57], v16 offset:58112
    ds_read_b64_tr_b16 v[58:59], v16 offset:60160
    s_waitcnt lgkmcnt(12)
    v_mfma_f32_32x32x16_bf16 v[128:143], v[36:39], v[200:203], v[128:143]
    ds_read_b64_tr_b16 v[60:61], v16 offset:62208
    ds_read_b64_tr_b16 v[62:63], v16 offset:64256
    v_mul_f32 v112, v112, v2
    v_mul_f32 v113, v113, v2
    v_mul_f32 v114, v114, v2
    v_mul_f32 v115, v115, v2
    v_mul_f32 v116, v116, v2
    v_mul_f32 v117, v117, v2
    v_mul_f32 v118, v118, v2
    v_mul_f32 v119, v119, v2
    v_mul_f32 v120, v120, v2
    v_mul_f32 v121, v121, v2
    s_waitcnt lgkmcnt(12)
    v_mfma_f32_32x32x16_bf16 v[128:143], v[40:43], v[208:211], v[128:143]
    v_mul_f32 v122, v122, v2
    v_mul_f32 v123, v123, v2
    v_mul_f32 v124, v124, v2
    v_mul_f32 v125, v125, v2
    v_mul_f32 v126, v126, v2
    v_mul_f32 v127, v127, v2
    v_cvt_pk_bf16_f32 v232, v112, v113
    v_cvt_pk_bf16_f32 v233, v114, v115
    v_cvt_pk_bf16_f32 v234, v116, v117
    v_cvt_pk_bf16_f32 v235, v118, v119
    v_cvt_pk_bf16_f32 v236, v120, v121
    s_waitcnt lgkmcnt(10)
    v_mfma_f32_32x32x16_bf16 v[128:143], v[44:47], v[216:219], v[128:143]
    v_cvt_pk_bf16_f32 v237, v122, v123
    v_cvt_pk_bf16_f32 v238, v124, v125
    v_cvt_pk_bf16_f32 v239, v126, v127
    v_permlane32_swap_b32 v232, v234
    v_permlane32_swap_b32 v233, v235
    v_permlane32_swap_b32 v236, v238
    v_permlane32_swap_b32 v237, v239
    s_mov_b64 exec, s[46:47]
    buffer_store_dwordx4 v[232:235], v23, s[20:23], s80 offen offset:2048 sc1
    s_mov_b64 exec, -1
    s_mov_b64 exec, s[46:47]
    buffer_store_dwordx4 v[236:239], v23, s[20:23], s80 offen offset:3072 sc1
    s_mov_b64 exec, -1
    ds_write_b128 v21, v[232:235] offset:2048
    ds_write_b128 v21, v[236:239] offset:3072
    s_waitcnt lgkmcnt(10)
    v_mfma_f32_32x32x16_bf16 v[144:159], v[48:51], v[192:195], v[144:159]
    s_waitcnt lgkmcnt(8)
    v_mfma_f32_32x32x16_bf16 v[144:159], v[52:55], v[200:203], v[144:159]
    v_mul_f32 v128, v128, v2
    v_mul_f32 v129, v129, v2
    v_mul_f32 v130, v130, v2
    v_mul_f32 v131, v131, v2
    v_mul_f32 v132, v132, v2
    v_mul_f32 v133, v133, v2
    v_mul_f32 v134, v134, v2
    v_mul_f32 v135, v135, v2
    v_mul_f32 v136, v136, v2
    v_mul_f32 v137, v137, v2
    s_waitcnt lgkmcnt(4)
    v_mfma_f32_32x32x16_bf16 v[144:159], v[56:59], v[208:211], v[144:159]
    v_mul_f32 v138, v138, v2
    v_mul_f32 v139, v139, v2
    v_mul_f32 v140, v140, v2
    v_mul_f32 v141, v141, v2
    v_mul_f32 v142, v142, v2
    v_mul_f32 v143, v143, v2
    v_cvt_pk_bf16_f32 v240, v128, v129
    v_cvt_pk_bf16_f32 v241, v130, v131
    v_cvt_pk_bf16_f32 v242, v132, v133
    v_cvt_pk_bf16_f32 v243, v134, v135
    v_cvt_pk_bf16_f32 v244, v136, v137
    s_waitcnt lgkmcnt(2)
    v_mfma_f32_32x32x16_bf16 v[144:159], v[60:63], v[216:219], v[144:159]
    v_cvt_pk_bf16_f32 v245, v138, v139
    v_cvt_pk_bf16_f32 v246, v140, v141
    v_cvt_pk_bf16_f32 v247, v142, v143
    v_permlane32_swap_b32 v240, v242
    v_permlane32_swap_b32 v241, v243
    v_permlane32_swap_b32 v244, v246
    v_permlane32_swap_b32 v245, v247
    s_mov_b64 exec, s[46:47]
    s_add_u32 s76, s80, 4096
    buffer_store_dwordx4 v[240:243], v23, s[20:23], s76 offen offset:0 sc1
    s_mov_b64 exec, -1
    s_mov_b64 exec, s[46:47]
    buffer_store_dwordx4 v[244:247], v23, s[20:23], s76 offen offset:1024 sc1
    s_mov_b64 exec, -1
    ds_write_b128 v21, v[240:243] offset:4096
    ds_write_b128 v21, v[244:247] offset:5120
    v_mul_f32 v144, v144, v2
    v_mul_f32 v145, v145, v2
    v_mul_f32 v146, v146, v2
    v_mul_f32 v147, v147, v2
    v_mul_f32 v148, v148, v2
    v_mul_f32 v149, v149, v2
    v_mul_f32 v150, v150, v2
    v_mul_f32 v151, v151, v2
    v_mul_f32 v152, v152, v2
    v_mul_f32 v153, v153, v2
    v_mul_f32 v154, v154, v2
    v_mul_f32 v155, v155, v2
    v_mul_f32 v156, v156, v2
    v_mul_f32 v157, v157, v2
    v_mul_f32 v158, v158, v2
    v_mul_f32 v159, v159, v2
    v_cvt_pk_bf16_f32 v248, v144, v145
    v_cvt_pk_bf16_f32 v249, v146, v147
    v_cvt_pk_bf16_f32 v250, v148, v149
    v_cvt_pk_bf16_f32 v251, v150, v151
    v_cvt_pk_bf16_f32 v252, v152, v153
    v_cvt_pk_bf16_f32 v253, v154, v155
    v_cvt_pk_bf16_f32 v254, v156, v157
    v_cvt_pk_bf16_f32 v255, v158, v159
    v_permlane32_swap_b32 v248, v250
    v_permlane32_swap_b32 v249, v251
    v_permlane32_swap_b32 v252, v254
    v_permlane32_swap_b32 v253, v255
    s_mov_b64 exec, s[46:47]
    buffer_store_dwordx4 v[248:251], v23, s[20:23], s76 offen offset:2048 sc1
    s_mov_b64 exec, -1
    s_mov_b64 exec, s[46:47]
    buffer_store_dwordx4 v[252:255], v23, s[20:23], s76 offen offset:3072 sc1
    s_mov_b64 exec, -1
    ds_write_b128 v21, v[248:251] offset:6144
    ds_write_b128 v21, v[252:255] offset:7168
    s_waitcnt lgkmcnt(0)
    s_barrier
    s_endpgm
code_end:
.section .rodata,"a"
.p2align 6
.amdhsa_kernel concat_heads__mha_block_cached__gqa_block_cached__near_ridge_kernel
  .amdhsa_next_free_vgpr 256
  .amdhsa_next_free_sgpr 102
  .amdhsa_accum_offset 256
  .amdhsa_group_segment_fixed_size 0
  .amdhsa_kernarg_size 104
  .amdhsa_user_sgpr_count 2
  .amdhsa_user_sgpr_kernarg_segment_ptr 1
  .amdhsa_system_sgpr_workgroup_id_x 1
.end_amdhsa_kernel
.text
```
